```python
import torch

def _softmax(x, axis=-1):
    return torch.softmax(x, dim=axis)
def _gelu(x):
    return torch.nn.functional.gelu(x, approximate="tanh")
def _silu(x):
    return torch.nn.functional.silu(x)
def _sigmoid(x):
    return torch.sigmoid(x)
def _layernorm(x, axis=-1, eps=1e-5):
    m = x.mean(dim=axis, keepdim=True)
    v = x.var(dim=axis, keepdim=True, unbiased=False)
    return (x - m) / torch.sqrt(v + eps)
def _scatter_add(tgt, idx, src, axis=0):
    return tgt.clone().index_add_(axis, idx, src)
def _segment_sum(src, seg, n):
    out = torch.zeros((n,) + src.shape[1:], dtype=src.dtype)
    return out.index_add_(0, seg, src)
def _pad(x, pw):
    flat = tuple(v for pair in reversed(pw) for v in pair)
    return torch.nn.functional.pad(x, flat)

kernel_name = 'concat_heads__mha_block_cached__mha_block_cached__near_ridge'

def setup_inputs():

    _w = (lambda a: (lambda t: t.to(torch.bfloat16) if t.is_floating_point() else t)(torch.as_tensor(a)))
    def _A_setup():
        B, Sq, D = 16, 96, 512
        H, Sk, Dh = 32, 96, 128
        return {
            "x": _w((lambda *s: torch.randn(*s, dtype=torch.bfloat16) * 0.8)(B, Sq, D)),
            "k_cache": _w((lambda *s: torch.randn(*s, dtype=torch.bfloat16) * 0.8)(B, H, Sk, Dh)),
            "v_cache": _w((lambda *s: torch.randn(*s, dtype=torch.bfloat16) * 0.05)(B, H, Sk, Dh)),
            "wq": _w((lambda *s: torch.randn(*s, dtype=torch.bfloat16) * 0.8)(D, H * Dh) * (D ** -0.5)),
            "wo": _w((lambda *s: torch.randn(*s, dtype=torch.bfloat16) * 0.05)(H * Dh, D) * ((H * Dh) ** -0.5)),
        }
    _A_in = _A_setup()

    def _B_setup():
        B, Sq, D = 16, 96, 512
        H, Sk, Dh = 32, 96, 128
        return {
            "x": _w((lambda *s: torch.randn(*s, dtype=torch.bfloat16) * 0.8)(B, Sq, D)),
            "k_cache": _w((lambda *s: torch.randn(*s, dtype=torch.bfloat16) * 0.8)(B, H, Sk, Dh)),
            "v_cache": _w((lambda *s: torch.randn(*s, dtype=torch.bfloat16) * 0.05)(B, H, Sk, Dh)),
            "wq": _w((lambda *s: torch.randn(*s, dtype=torch.bfloat16) * 0.8)(D, H * Dh) * (D ** -0.5)),
            "wo": _w((lambda *s: torch.randn(*s, dtype=torch.bfloat16) * 0.05)(H * Dh, D) * ((H * Dh) ** -0.5)),
        }
    _B_in = _B_setup()

    return {
        "A_x": _A_in["x"],
        "A_k_cache": _A_in["k_cache"],
        "A_v_cache": _A_in["v_cache"],
        "A_wq": _A_in["wq"],
        "A_wo": _A_in["wo"],
        "B_x": _B_in["x"],
        "B_k_cache": _B_in["k_cache"],
        "B_v_cache": _B_in["v_cache"],
        "B_wq": _B_in["wq"],
        "B_wo": _B_in["wo"],
    }

def reference(A_x, A_k_cache, A_v_cache, A_wq, A_wo, B_x, B_k_cache, B_v_cache, B_wq, B_wo):
    def _A_ref(x, k_cache, v_cache, wq, wo):
        B, Sq, D = x.shape
        H, Dh = 32, 128
        q = (lambda x, *d: x.permute(*d))((x @ wq).reshape(B, Sq, H, Dh), 0, 2, 1, 3)
        scores = torch.einsum("bhqd,bhkd->bhqk", q, k_cache) * (Dh ** -0.5)
        p = _softmax(scores, axis=-1)
        o = torch.einsum("bhqk,bhkd->bhqd", p, v_cache)
        return (lambda x, *d: x.permute(*d))(o, 0, 2, 1, 3).reshape(B, Sq, H * Dh) @ wo

    def _B_ref(x, k_cache, v_cache, wq, wo):
        B, Sq, D = x.shape
        H, Dh = 32, 128
        q = (lambda x, *d: x.permute(*d))((x @ wq).reshape(B, Sq, H, Dh), 0, 2, 1, 3)
        scores = torch.einsum("bhqd,bhkd->bhqk", q, k_cache) * (Dh ** -0.5)
        p = _softmax(scores, axis=-1)
        o = torch.einsum("bhqk,bhkd->bhqd", p, v_cache)
        return (lambda x, *d: x.permute(*d))(o, 0, 2, 1, 3).reshape(B, Sq, H * Dh) @ wo

    a = _A_ref(A_x, A_k_cache, A_v_cache, A_wq, A_wo)
    b = _B_ref(B_x, B_k_cache, B_v_cache, B_wq, B_wo)
    return torch.concatenate([a, b], axis=-1)
```

```asm
; @launch grid=(256,1,1) block=(256,1,1) lds=163840
.amdgcn_target "amdgcn-amd-amdhsa--gfx950"
.text
.globl concat_heads__mha_block_cached__mha_block_cached__near_ridge_kernel
.p2align 8
.type concat_heads__mha_block_cached__mha_block_cached__near_ridge_kernel,@function
concat_heads__mha_block_cached__mha_block_cached__near_ridge_kernel:
  s_cmp_ge_u32 s2, 256
  s_cbranch_scc1 L_done
  s_load_dwordx16 s[4:19], s[0:1], 0
  s_load_dwordx8 s[20:27], s[0:1], 64
  s_load_dwordx2 s[28:29], s[0:1], 96
  s_getreg_b32 s86, hwreg(HW_REG_XCC_ID)
  v_lshrrev_b32 v207, 6, v0
  v_and_b32 v211, 63, v0
  v_readfirstlane_b32 s68, v207
  v_mov_b32 v255, v0
  s_getpc_b64 s[98:99]
L_pc:
  s_lshr_b32 s75, s2, 3
  s_and_b32 s75, s75, 31
  v_lshrrev_b32 v208, 6, v0
  v_lshl_add_u32 v208, s75, 2, v208
  v_mul_u32_u24 v208, 384, v208
  v_min_u32 v209, 2, v211
  v_lshlrev_b32 v209, 7, v209
  v_add_u32 v208, v208, v209
  v_min_u32 v208, L_slow-L_pc-4, v208
  v_and_b32 v208, 0xfffffffc, v208
  v_mov_b32 v222, s98
  v_mov_b32 v223, s99
  v_add_co_u32 v222, vcc, v222, v208
  s_nop 1
  v_addc_co_u32 v223, vcc, 0, v223, vcc
  global_load_dword v221, v[222:223], off
  s_and_b32 s75, s2, 7
  s_lshr_b32 s76, s2, 3
  s_and_b32 s71, s75, 1
  s_lshr_b32 s77, s75, 1
  s_and_b32 s70, s76, 7
  s_lshr_b32 s30, s76, 3
  s_mov_b32 s88, s30
  s_lshl_b32 s69, s77, 2
  s_add_u32 s69, s69, s30
  s_lshl_b32 s77, s77, 1
  s_add_u32 s72, s70, s77
  s_and_b32 s72, s72, 7
  s_mov_b32 s73, s72
  s_lshl_b32 s74, s68, 14
  s_add_u32 s74, s74, 98304
  s_mul_i32 s85, s68, 24576
  v_lshrrev_b32 v207, 4, v211
  v_bfe_u32 v208, v211, 1, 3
  v_xor_b32 v208, v208, v207
  v_lshlrev_b32 v208, 5, v208
  v_and_b32 v209, 1, v211
  v_lshlrev_b32 v209, 4, v209
  v_add_u32 v208, v208, v209
  v_lshlrev_b32 v209, 13, v207
  v_add_u32 v192, v208, v209
  v_add_u32 v193, 31744, v192
  v_xor_b32 v208, 128, v208
  v_add_u32 v208, v208, v209
  v_add_u32 v194, 63488, v208
  v_add_u32 v195, 95232, v208
  v_lshrrev_b32 v207, 3, v211
  v_and_b32 v208, 7, v211
  v_lshrrev_b32 v209, 1, v207
  v_xor_b32 v209, v209, v208
  v_lshlrev_b32 v209, 4, v209
  v_lshlrev_b32 v210, 10, v207
  v_add_u32 v209, v209, v210
  s_add_u32 s75, s68, 0
  s_and_b32 s75, s75, 1
  s_lshl_b32 s75, s75, 6
  s_mul_i32 s76, s68, 24576
  s_add_u32 s76, s76, 0
  v_xor_b32 v210, s75, v209
  v_add_u32 v196, s76, v210
  s_add_u32 s75, s68, 1
  s_and_b32 s75, s75, 1
  s_lshl_b32 s75, s75, 6
  s_mul_i32 s76, s68, 24576
  s_add_u32 s76, s76, 7168
  v_xor_b32 v210, s75, v209
  v_add_u32 v197, s76, v210
  s_add_u32 s75, s68, 2
  s_and_b32 s75, s75, 1
  s_lshl_b32 s75, s75, 6
  s_mul_i32 s76, s68, 24576
  s_add_u32 s76, s76, 14336
  v_xor_b32 v210, s75, v209
  v_add_u32 v198, s76, v210
  s_waitcnt lgkmcnt(0)
  s_cmp_eq_u32 s71, 0
  s_cselect_b64 s[4:5], s[4:5], s[14:15]
  s_cselect_b64 s[10:11], s[10:11], s[20:21]
  s_cselect_b64 s[6:7], s[6:7], s[16:17]
  s_cselect_b64 s[8:9], s[8:9], s[18:19]
  s_cselect_b64 s[12:13], s[12:13], s[22:23]
  s_mul_i32 s75, s69, 98304
  s_add_u32 s32, s4, s75
  s_addc_u32 s33, s5, 0
  s_mov_b32 s34, 98304
  s_mov_b32 s35, 0x00020000
  s_lshl_b32 s76, s70, 2
  s_add_u32 s76, s76, s68
  s_lshl_b32 s76, s76, 8
  s_sub_u32 s77, 4194304, s76
  s_add_u32 s44, s10, s76
  s_addc_u32 s45, s11, 0
  s_mov_b32 s46, s77
  s_mov_b32 s47, 0x00020000
  s_lshr_b32 s75, s88, 1
  s_add_u32 s79, s72, s75
  s_and_b32 s79, s79, 7
  s_lshl_b32 s83, s79, 7
  s_mul_i32 s80, s68, 3072
  s_mul_i32 s75, s75, 12288
  s_add_u32 m0, s80, s75
  s_nop 0
  buffer_load_dwordx4 v196, s[32:35], s83 offen lds
  buffer_load_dwordx4 v197, s[32:35], s83 offen offset:1024 lds
  buffer_load_dwordx4 v198, s[32:35], s83 offen offset:2048 lds
  s_add_u32 s79, s88, 0
  s_and_b32 s79, s79, 3
  s_lshl_b32 s80, s72, 1
  s_add_u32 s79, s79, s80
  s_and_b32 s79, s79, 15
  s_lshl_b32 s82, s79, 18
  s_add_u32 m0, s74, 0
  s_nop 0
  buffer_load_dwordx4 v192, s[44:47], s82 offen lds
  buffer_load_dwordx4 v193, s[44:47], s82 offen offset:1024 lds
  buffer_load_dwordx4 v194, s[44:47], s82 offen offset:2048 lds
  buffer_load_dwordx4 v195, s[44:47], s82 offen offset:3072 lds
  s_lshl_b32 s75, s69, 5
  s_lshl_b32 s76, s70, 2
  s_add_u32 s75, s75, s76
  s_mul_i32 s75, s75, 24576
  s_add_u32 s36, s6, s75
  s_addc_u32 s37, s7, 0
  s_mov_b32 s38, 98304
  s_mov_b32 s39, 0x00020000
  s_add_u32 s75, s75, s85
  s_add_u32 s40, s8, s75
  s_addc_u32 s41, s9, 0
  s_mov_b32 s42, 24576
  s_mov_b32 s43, 0x00020000
  s_lshl_b32 s75, s70, 19
  s_add_u32 s48, s12, s75
  s_addc_u32 s49, s13, 0
  s_mov_b32 s50, 524288
  s_mov_b32 s51, 0x00020000
  s_add_u32 s75, s70, s68
  s_and_b32 s3, s75, 7
  s_add_u32 s75, s75, 4
  s_and_b32 s31, s75, 7
  s_lshl_b32 s87, s71, 4
  s_add_u32 s87, s87, s69
  s_mul_i32 s75, s87, 393216
  s_add_u32 s52, s28, s75
  s_addc_u32 s53, s29, 0
  s_mov_b32 s54, 393216
  s_mov_b32 s55, 0x00020000
  s_lshl_b32 s75, s87, 10
  s_add_u32 s75, s75, 33554432
  s_add_u32 s56, s28, s75
  s_addc_u32 s57, s29, 0
  s_mov_b32 s58, 1024
  s_mov_b32 s59, 0x00020000
  s_mov_b32 s60, s26
  s_mov_b32 s61, s27
  s_mov_b32 s62, 256
  s_mov_b32 s63, 0x00020000
  s_mov_b32 s64, s24
  s_mov_b32 s65, s25
  s_mov_b32 s66, 3145728
  s_mov_b32 s67, 0x00020000
  s_mov_b32 s81, 0x3e0293ee
  s_add_u32 s75, s88, 0
  s_and_b32 s75, s75, 3
  s_lshl_b32 s76, s72, 1
  s_add_u32 s20, s75, s76
  s_and_b32 s20, s20, 15
  s_lshr_b32 s76, s75, 1
  s_mul_i32 s76, s76, 12288
  s_and_b32 s75, s75, 1
  s_lshl_b32 s75, s75, 6
  s_add_u32 s24, s75, s76
  s_add_u32 s75, s88, 1
  s_and_b32 s75, s75, 3
  s_lshl_b32 s76, s72, 1
  s_add_u32 s21, s75, s76
  s_and_b32 s21, s21, 15
  s_lshr_b32 s76, s75, 1
  s_mul_i32 s76, s76, 12288
  s_and_b32 s75, s75, 1
  s_lshl_b32 s75, s75, 6
  s_add_u32 s25, s75, s76
  s_add_u32 s75, s88, 2
  s_and_b32 s75, s75, 3
  s_lshl_b32 s76, s72, 1
  s_add_u32 s22, s75, s76
  s_and_b32 s22, s22, 15
  s_lshr_b32 s76, s75, 1
  s_mul_i32 s76, s76, 12288
  s_and_b32 s75, s75, 1
  s_lshl_b32 s75, s75, 6
  s_add_u32 s26, s75, s76
  s_add_u32 s75, s88, 3
  s_and_b32 s75, s75, 3
  s_lshl_b32 s76, s72, 1
  s_add_u32 s23, s75, s76
  s_and_b32 s23, s23, 15
  s_lshr_b32 s76, s75, 1
  s_mul_i32 s76, s76, 12288
  s_and_b32 s75, s75, 1
  s_lshl_b32 s75, s75, 6
  s_add_u32 s27, s75, s76
  s_and_b32 s86, s86, 15
  s_or_b32 s86, s86, 128
  v_lshrrev_b32 v207, 3, v211
  v_lshrrev_b32 v208, 1, v211
  v_lshrrev_b32 v209, 4, v211
  v_xor_b32 v208, v208, v209
  v_and_b32 v208, 3, v208
  v_lshlrev_b32 v208, 5, v208
  v_and_b32 v209, 1, v211
  v_lshlrev_b32 v209, 4, v209
  v_lshlrev_b32 v207, 10, v207
  v_add3_u32 v232, v207, v208, v209
  v_add_u32 v233, 7168, v232
  v_add_u32 v234, 14336, v232
  v_add_u32 v235, 21504, v232
  v_lshrrev_b32 v207, 4, v211
  v_bfe_u32 v208, v211, 2, 2
  v_xor_b32 v208, v208, v207
  v_lshlrev_b32 v208, 6, v208
  v_and_b32 v209, 3, v211
  v_lshlrev_b32 v209, 4, v209
  v_add_u32 v208, v208, v209
  v_lshlrev_b32 v209, 8, v207
  v_add_u32 v224, v208, v209
  v_and_b32 v208, 15, v211
  v_xor_b32 v208, v208, v207
  v_lshlrev_b32 v208, 4, v208
  v_add_u32 v208, v208, v209
  s_mul_i32 s75, s68, 6
  s_add_u32 s75, s75, 0
  s_and_b32 s76, s75, 3
  s_lshl_b32 s76, s76, 6
  s_lshl_b32 s75, s75, 10
  s_sub_u32 s75, s75, 0
  v_xor_b32 v210, s76, v208
  v_add_u32 v199, s75, v210
  s_mul_i32 s75, s68, 6
  s_add_u32 s75, s75, 1
  s_and_b32 s76, s75, 3
  s_lshl_b32 s76, s76, 6
  s_lshl_b32 s75, s75, 10
  s_sub_u32 s75, s75, 1024
  v_xor_b32 v210, s76, v208
  v_add_u32 v200, s75, v210
  s_mul_i32 s75, s68, 6
  s_add_u32 s75, s75, 2
  s_and_b32 s76, s75, 3
  s_lshl_b32 s76, s76, 6
  s_lshl_b32 s75, s75, 10
  s_sub_u32 s75, s75, 2048
  v_xor_b32 v210, s76, v208
  v_add_u32 v201, s75, v210
  s_mul_i32 s75, s68, 6
  s_add_u32 s75, s75, 3
  s_and_b32 s76, s75, 3
  s_lshl_b32 s76, s76, 6
  s_lshl_b32 s75, s75, 10
  s_sub_u32 s75, s75, 3072
  v_xor_b32 v210, s76, v208
  v_add_u32 v202, s75, v210
  s_mul_i32 s75, s68, 6
  s_add_u32 s75, s75, 4
  s_and_b32 s76, s75, 3
  s_lshl_b32 s76, s76, 6
  s_lshl_b32 s75, s75, 10
  s_sub_u32 s75, s75, 0
  v_xor_b32 v210, s76, v208
  v_add_u32 v203, s75, v210
  s_mul_i32 s75, s68, 6
  s_add_u32 s75, s75, 5
  s_and_b32 s76, s75, 3
  s_lshl_b32 s76, s76, 6
  s_lshl_b32 s75, s75, 10
  s_sub_u32 s75, s75, 1024
  v_xor_b32 v210, s76, v208
  v_add_u32 v204, s75, v210
  v_bfe_u32 v207, v211, 2, 2
  v_and_b32 v208, 3, v211
  v_lshlrev_b32 v208, 3, v208
  v_lshrrev_b32 v209, 4, v211
  v_lshlrev_b32 v210, 3, v209
  v_add_u32 v210, v210, v207
  v_lshlrev_b32 v210, 8, v210
  v_add3_u32 v210, v210, v208, s74
  v_and_b32 v252, 1, v209
  v_lshlrev_b32 v252, 2, v252
  v_or_b32 v252, v252, v207
  v_lshlrev_b32 v252, 5, v252
  v_add_u32 v212, v210, v252
  v_xor_b32 v253, 32, v252
  v_add_u32 v213, v210, v253
  v_xor_b32 v253, 64, v252
  v_add_u32 v214, v210, v253
  v_xor_b32 v253, 96, v252
  v_add_u32 v215, v210, v253
  v_xor_b32 v253, 128, v252
  v_add_u32 v216, v210, v253
  v_xor_b32 v253, 160, v252
  v_add_u32 v217, v210, v253
  v_xor_b32 v253, 192, v252
  v_add_u32 v218, v210, v253
  v_xor_b32 v253, 224, v252
  v_add_u32 v219, v210, v253
  v_lshrrev_b32 v210, 1, v209
  v_lshlrev_b32 v210, 4, v210
  v_and_b32 v252, 1, v209
  v_lshlrev_b32 v253, 2, v252
  v_add3_u32 v210, v210, v253, v207
  v_lshlrev_b32 v210, 7, v210
  v_add3_u32 v210, v210, v208, s74
  v_lshlrev_b32 v252, 1, v252
  v_lshrrev_b32 v253, 1, v207
  v_or_b32 v252, v252, v253
  v_lshlrev_b32 v252, 5, v252
  v_add_u32 v236, v210, v252
  v_xor_b32 v253, 32, v252
  v_add_u32 v237, v210, v253
  v_xor_b32 v253, 64, v252
  v_add_u32 v238, v210, v253
  v_xor_b32 v253, 96, v252
  v_add_u32 v239, v210, v253
  v_bfe_u32 v209, v211, 4, 1
  v_lshlrev_b32 v209, 5, v209
  v_lshlrev_b32 v210, 8, v207
  v_add3_u32 v209, v209, v210, v208
  v_lshrrev_b32 v208, 5, v211
  v_lshlrev_b32 v210, 10, v208
  v_add3_u32 v252, v209, v210, s74
  v_xor_b32 v209, 0, v207
  v_lshlrev_b32 v209, 6, v209
  v_add_u32 v225, v252, v209
  v_xor_b32 v209, 1, v207
  v_lshlrev_b32 v209, 6, v209
  v_add_u32 v226, v252, v209
  v_xor_b32 v209, 2, v207
  v_lshlrev_b32 v209, 6, v209
  v_add_u32 v227, v252, v209
  v_xor_b32 v209, 3, v207
  v_lshlrev_b32 v209, 6, v209
  v_add_u32 v228, v252, v209
  v_and_b32 v207, 15, v211
  v_lshrrev_b32 v209, 4, v211
  v_lshrrev_b32 v210, 1, v207
  v_xor_b32 v209, v209, v210
  v_lshlrev_b32 v209, 4, v209
  v_lshlrev_b32 v210, 7, v207
  v_add_u32 v205, v209, v210
  v_and_b32 v207, 31, v211
  v_and_b32 v209, 15, v211
  v_xor_b32 v209, v209, v208
  v_lshlrev_b32 v209, 4, v209
  v_lshlrev_b32 v210, 8, v207
  v_add3_u32 v229, v209, v210, s85
  v_lshlrev_b32 v241, 4, v211
  v_add_u32 v231, s85, v241
  v_lshlrev_b32 v252, 2, v255
  s_lshl_b32 s75, s70, 7
  v_add_u32 v252, s75, v252
  v_cmp_gt_u32 vcc, 32, v255
  v_mov_b32 v253, 0
  v_mov_b32 v254, 0x7ffffff0
  v_cndmask_b32 v252, v254, v252, vcc
  s_or_b32 s82, s82, 131072
  s_add_u32 m0, s74, 4096
  s_nop 0
  buffer_load_dwordx4 v192, s[44:47], s82 offen lds
  buffer_load_dwordx4 v193, s[44:47], s82 offen offset:1024 lds
  buffer_load_dwordx4 v194, s[44:47], s82 offen offset:2048 lds
  buffer_load_dwordx4 v195, s[44:47], s82 offen offset:3072 lds
  buffer_store_dword v253, v252, s[56:59], 0 offen sc0 sc1
  s_lshr_b32 s75, s88, 1
  s_xor_b32 s75, s75, 1
  s_add_u32 s79, s72, s75
  s_and_b32 s79, s79, 7
  s_lshl_b32 s83, s79, 7
  s_mul_i32 s80, s68, 3072
  s_mul_i32 s75, s75, 12288
  s_add_u32 m0, s80, s75
  s_nop 0
  buffer_load_dwordx4 v196, s[32:35], s83 offen lds
  buffer_load_dwordx4 v197, s[32:35], s83 offen offset:1024 lds
  buffer_load_dwordx4 v198, s[32:35], s83 offen offset:2048 lds
  s_lshl_b32 s82, s21, 18
  s_add_u32 m0, s74, 8192
  s_nop 0
  buffer_load_dwordx4 v192, s[44:47], s82 offen lds
  buffer_load_dwordx4 v193, s[44:47], s82 offen offset:1024 lds
  buffer_load_dwordx4 v194, s[44:47], s82 offen offset:2048 lds
  buffer_load_dwordx4 v195, s[44:47], s82 offen offset:3072 lds
  s_or_b32 s82, s82, 131072
  s_add_u32 m0, s74, 12288
  s_nop 0
  buffer_load_dwordx4 v192, s[44:47], s82 offen lds
  buffer_load_dwordx4 v193, s[44:47], s82 offen offset:1024 lds
  buffer_load_dwordx4 v194, s[44:47], s82 offen offset:2048 lds
  buffer_load_dwordx4 v195, s[44:47], s82 offen offset:3072 lds
  s_waitcnt vmcnt(20)
  s_barrier
  v_xor_b32 v206, s24, v205
  ds_read_b128 a[64:67], v206
  ds_read_b128 a[68:71], v206 offset:2048
  ds_read_b128 a[72:75], v206 offset:4096
  ds_read_b128 a[76:79], v206 offset:6144
  ds_read_b128 a[80:83], v206 offset:8192
  ds_read_b128 a[84:87], v206 offset:10240
  s_waitcnt vmcnt(12)
  ds_read_b64_tr_b16 a[0:1], v212
  ds_read_b64_tr_b16 a[2:3], v212 offset:1024
  ds_read_b64_tr_b16 a[4:5], v213
  ds_read_b64_tr_b16 a[6:7], v213 offset:1024
  ds_read_b64_tr_b16 a[8:9], v214
  ds_read_b64_tr_b16 a[10:11], v214 offset:1024
  ds_read_b64_tr_b16 a[12:13], v215
  ds_read_b64_tr_b16 a[14:15], v215 offset:1024
  ds_read_b64_tr_b16 a[16:17], v216
  ds_read_b64_tr_b16 a[18:19], v216 offset:1024
  ds_read_b64_tr_b16 a[20:21], v217
  ds_read_b64_tr_b16 a[22:23], v217 offset:1024
  ds_read_b64_tr_b16 a[24:25], v218
  ds_read_b64_tr_b16 a[26:27], v218 offset:1024
  ds_read_b64_tr_b16 a[28:29], v219
  ds_read_b64_tr_b16 a[30:31], v219 offset:1024
  s_waitcnt lgkmcnt(14)
  v_mfma_f32_16x16x32_bf16 v[0:3], a[0:3], a[64:67], 0
  s_lshl_b32 s82, s22, 18
  s_add_u32 m0, s74, 0
  s_waitcnt lgkmcnt(12)
  v_mfma_f32_16x16x32_bf16 v[8:11], a[4:7], a[64:67], 0
  s_waitcnt lgkmcnt(0)
  buffer_load_dwordx4 v192, s[44:47], s82 offen lds
  v_mfma_f32_16x16x32_bf16 v[16:19], a[8:11], a[64:67], 0
  v_mfma_f32_16x16x32_bf16 v[24:27], a[12:15], a[64:67], 0
  v_mfma_f32_16x16x32_bf16 v[32:35], a[16:19], a[64:67], 0
  v_mfma_f32_16x16x32_bf16 v[40:43], a[20:23], a[64:67], 0
  buffer_load_dwordx4 v193, s[44:47], s82 offen offset:1024 lds
  v_mfma_f32_16x16x32_bf16 v[48:51], a[24:27], a[64:67], 0
  v_mfma_f32_16x16x32_bf16 v[56:59], a[28:31], a[64:67], 0
  v_mfma_f32_16x16x32_bf16 v[4:7], a[0:3], a[68:71], 0
  buffer_load_dwordx4 v194, s[44:47], s82 offen offset:2048 lds
  v_mfma_f32_16x16x32_bf16 v[12:15], a[4:7], a[68:71], 0
  v_mfma_f32_16x16x32_bf16 v[20:23], a[8:11], a[68:71], 0
  v_mfma_f32_16x16x32_bf16 v[28:31], a[12:15], a[68:71], 0
  v_mfma_f32_16x16x32_bf16 v[36:39], a[16:19], a[68:71], 0
  buffer_load_dwordx4 v195, s[44:47], s82 offen offset:3072 lds
  v_mfma_f32_16x16x32_bf16 v[44:47], a[20:23], a[68:71], 0
  v_mfma_f32_16x16x32_bf16 v[52:55], a[24:27], a[68:71], 0
  v_mfma_f32_16x16x32_bf16 v[60:63], a[28:31], a[68:71], 0
  s_or_b32 s82, s82, 131072
  v_mfma_f32_16x16x32_bf16 v[64:67], a[0:3], a[72:75], 0
  s_add_u32 m0, s74, 4096
  v_mfma_f32_16x16x32_bf16 v[72:75], a[4:7], a[72:75], 0
  buffer_load_dwordx4 v192, s[44:47], s82 offen lds
  v_mfma_f32_16x16x32_bf16 v[80:83], a[8:11], a[72:75], 0
  s_waitcnt vmcnt(13)
  s_barrier
  v_mfma_f32_16x16x32_bf16 v[88:91], a[12:15], a[72:75], 0
  v_xor_b32 v206, s25, v205
  v_mfma_f32_16x16x32_bf16 v[96:99], a[16:19], a[72:75], 0
  buffer_load_dwordx4 v193, s[44:47], s82 offen offset:1024 lds
  v_mfma_f32_16x16x32_bf16 v[104:107], a[20:23], a[72:75], 0
  ds_read_b128 a[88:91], v206
  v_mfma_f32_16x16x32_bf16 v[112:115], a[24:27], a[72:75], 0
  v_mfma_f32_16x16x32_bf16 v[120:123], a[28:31], a[72:75], 0
  ds_read_b128 a[92:95], v206 offset:2048
  v_mfma_f32_16x16x32_bf16 v[68:71], a[0:3], a[76:79], 0
  buffer_load_dwordx4 v194, s[44:47], s82 offen offset:2048 lds
  v_mfma_f32_16x16x32_bf16 v[76:79], a[4:7], a[76:79], 0
  ds_read_b128 a[96:99], v206 offset:4096
  v_mfma_f32_16x16x32_bf16 v[84:87], a[8:11], a[76:79], 0
  v_mfma_f32_16x16x32_bf16 v[92:95], a[12:15], a[76:79], 0
  ds_read_b128 a[100:103], v206 offset:6144
  v_mfma_f32_16x16x32_bf16 v[100:103], a[16:19], a[76:79], 0
  s_waitcnt vmcnt(7)
  ds_read_b64_tr_b16 a[32:33], v212 offset:8192
  v_mfma_f32_16x16x32_bf16 v[108:111], a[20:23], a[76:79], 0
  buffer_load_dwordx4 v195, s[44:47], s82 offen offset:3072 lds
  v_mfma_f32_16x16x32_bf16 v[116:119], a[24:27], a[76:79], 0
  ds_read_b64_tr_b16 a[34:35], v212 offset:9216
  ds_read_b128 a[104:107], v206 offset:8192
  v_mfma_f32_16x16x32_bf16 v[124:127], a[28:31], a[76:79], 0
  ds_read_b64_tr_b16 a[36:37], v213 offset:8192
  s_add_u32 s79, s72, 2
  v_mfma_f32_16x16x32_bf16 v[128:131], a[0:3], a[80:83], 0
  ds_read_b64_tr_b16 a[38:39], v213 offset:9216
  s_and_b32 s79, s79, 7
  v_mfma_f32_16x16x32_bf16 v[136:139], a[4:7], a[80:83], 0
  ds_read_b128 a[108:111], v206 offset:10240
  s_lshl_b32 s83, s79, 7
  v_mfma_f32_16x16x32_bf16 v[144:147], a[8:11], a[80:83], 0
  ds_read_b64_tr_b16 a[40:41], v214 offset:8192
  s_mul_i32 s80, s68, 3072
  v_mfma_f32_16x16x32_bf16 v[152:155], a[12:15], a[80:83], 0
  s_add_u32 m0, s80, 24576
  ds_read_b64_tr_b16 a[42:43], v214 offset:9216
  v_mfma_f32_16x16x32_bf16 v[160:163], a[16:19], a[80:83], 0
  buffer_load_dwordx4 v196, s[32:35], s83 offen lds
  v_mfma_f32_16x16x32_bf16 v[168:171], a[20:23], a[80:83], 0
  ds_read_b64_tr_b16 a[44:45], v215 offset:8192
  ds_read_b64_tr_b16 a[46:47], v215 offset:9216
  v_mfma_f32_16x16x32_bf16 v[176:179], a[24:27], a[80:83], 0
  buffer_load_dwordx4 v197, s[32:35], s83 offen offset:1024 lds
  v_mfma_f32_16x16x32_bf16 v[184:187], a[28:31], a[80:83], 0
  ds_read_b64_tr_b16 a[48:49], v216 offset:8192
  ds_read_b64_tr_b16 a[50:51], v216 offset:9216
  v_mfma_f32_16x16x32_bf16 v[132:135], a[0:3], a[84:87], 0
  buffer_load_dwordx4 v198, s[32:35], s83 offen offset:2048 lds
  v_mfma_f32_16x16x32_bf16 v[140:143], a[4:7], a[84:87], 0
  ds_read_b64_tr_b16 a[52:53], v217 offset:8192
  s_add_u32 s79, s72, 3
  v_mfma_f32_16x16x32_bf16 v[148:151], a[8:11], a[84:87], 0
  s_and_b32 s79, s79, 7
  ds_read_b64_tr_b16 a[54:55], v217 offset:9216
  v_mfma_f32_16x16x32_bf16 v[156:159], a[12:15], a[84:87], 0
  s_lshl_b32 s83, s79, 7
  s_mul_i32 s80, s68, 3072
  v_mfma_f32_16x16x32_bf16 v[164:167], a[16:19], a[84:87], 0
  s_add_u32 m0, s80, 36864
  ds_read_b64_tr_b16 a[56:57], v218 offset:8192
  v_mfma_f32_16x16x32_bf16 v[172:175], a[20:23], a[84:87], 0
  buffer_load_dwordx4 v196, s[32:35], s83 offen lds
  ds_read_b64_tr_b16 a[58:59], v218 offset:9216
  ds_read_b64_tr_b16 a[60:61], v219 offset:8192
  ds_read_b64_tr_b16 a[62:63], v219 offset:9216
  v_mfma_f32_16x16x32_bf16 v[180:183], a[24:27], a[84:87], 0
  buffer_load_dwordx4 v197, s[32:35], s83 offen offset:1024 lds
  v_mfma_f32_16x16x32_bf16 v[188:191], a[28:31], a[84:87], 0
  buffer_load_dwordx4 v198, s[32:35], s83 offen offset:2048 lds
  s_waitcnt lgkmcnt(15)
  v_mfma_f32_16x16x32_bf16 v[0:3], a[32:35], a[88:91], v[0:3]
  s_lshl_b32 s82, s23, 18
  s_add_u32 m0, s74, 8192
  s_waitcnt lgkmcnt(13)
  v_mfma_f32_16x16x32_bf16 v[8:11], a[36:39], a[88:91], v[8:11]
  s_waitcnt lgkmcnt(0)
  buffer_load_dwordx4 v192, s[44:47], s82 offen lds
  v_mfma_f32_16x16x32_bf16 v[16:19], a[40:43], a[88:91], v[16:19]
  v_mfma_f32_16x16x32_bf16 v[24:27], a[44:47], a[88:91], v[24:27]
  v_mfma_f32_16x16x32_bf16 v[32:35], a[48:51], a[88:91], v[32:35]
  v_mfma_f32_16x16x32_bf16 v[40:43], a[52:55], a[88:91], v[40:43]
  buffer_load_dwordx4 v193, s[44:47], s82 offen offset:1024 lds
  v_mfma_f32_16x16x32_bf16 v[48:51], a[56:59], a[88:91], v[48:51]
  v_mfma_f32_16x16x32_bf16 v[56:59], a[60:63], a[88:91], v[56:59]
  v_mfma_f32_16x16x32_bf16 v[4:7], a[32:35], a[92:95], v[4:7]
  v_xor_b32 v206, s26, v205
  v_mfma_f32_16x16x32_bf16 v[12:15], a[36:39], a[92:95], v[12:15]
  buffer_load_dwordx4 v194, s[44:47], s82 offen offset:2048 lds
  v_mfma_f32_16x16x32_bf16 v[20:23], a[40:43], a[92:95], v[20:23]
  ds_read_b128 a[64:67], v206
  v_mfma_f32_16x16x32_bf16 v[28:31], a[44:47], a[92:95], v[28:31]
  ds_read_b128 a[68:71], v206 offset:2048
  v_mfma_f32_16x16x32_bf16 v[36:39], a[48:51], a[92:95], v[36:39]
  buffer_load_dwordx4 v195, s[44:47], s82 offen offset:3072 lds
  v_mfma_f32_16x16x32_bf16 v[44:47], a[52:55], a[92:95], v[44:47]
  ds_read_b128 a[72:75], v206 offset:4096
  v_mfma_f32_16x16x32_bf16 v[52:55], a[56:59], a[92:95], v[52:55]
  v_mfma_f32_16x16x32_bf16 v[60:63], a[60:63], a[92:95], v[60:63]
  s_or_b32 s82, s82, 131072
  ds_read_b128 a[76:79], v206 offset:6144
  v_mfma_f32_16x16x32_bf16 v[64:67], a[32:35], a[96:99], v[64:67]
  s_add_u32 m0, s74, 12288
  v_mfma_f32_16x16x32_bf16 v[72:75], a[36:39], a[96:99], v[72:75]
  buffer_load_dwordx4 v192, s[44:47], s82 offen lds
  v_mfma_f32_16x16x32_bf16 v[80:83], a[40:43], a[96:99], v[80:83]
  ds_read_b128 a[80:83], v206 offset:8192
  v_mfma_f32_16x16x32_bf16 v[88:91], a[44:47], a[96:99], v[88:91]
  ds_read_b128 a[84:87], v206 offset:10240
  v_mfma_f32_16x16x32_bf16 v[96:99], a[48:51], a[96:99], v[96:99]
  buffer_load_dwordx4 v193, s[44:47], s82 offen offset:1024 lds
  v_mfma_f32_16x16x32_bf16 v[104:107], a[52:55], a[96:99], v[104:107]
  v_mfma_f32_16x16x32_bf16 v[112:115], a[56:59], a[96:99], v[112:115]
  v_mfma_f32_16x16x32_bf16 v[120:123], a[60:63], a[96:99], v[120:123]
  v_mfma_f32_16x16x32_bf16 v[68:71], a[32:35], a[100:103], v[68:71]
  buffer_load_dwordx4 v194, s[44:47], s82 offen offset:2048 lds
  v_mfma_f32_16x16x32_bf16 v[76:79], a[36:39], a[100:103], v[76:79]
  v_mfma_f32_16x16x32_bf16 v[84:87], a[40:43], a[100:103], v[84:87]
  v_mfma_f32_16x16x32_bf16 v[92:95], a[44:47], a[100:103], v[92:95]
  buffer_load_dwordx4 v195, s[44:47], s82 offen offset:3072 lds
  v_mfma_f32_16x16x32_bf16 v[100:103], a[48:51], a[100:103], v[100:103]
  s_waitcnt vmcnt(14)
  ds_read_b64_tr_b16 a[0:1], v212
  v_mfma_f32_16x16x32_bf16 v[108:111], a[52:55], a[100:103], v[108:111]
  ds_read_b64_tr_b16 a[2:3], v212 offset:1024
  v_mfma_f32_16x16x32_bf16 v[116:119], a[56:59], a[100:103], v[116:119]
  ds_read_b64_tr_b16 a[4:5], v213
  v_mfma_f32_16x16x32_bf16 v[124:127], a[60:63], a[100:103], v[124:127]
  ds_read_b64_tr_b16 a[6:7], v213 offset:1024
  v_mfma_f32_16x16x32_bf16 v[128:131], a[32:35], a[104:107], v[128:131]
  ds_read_b64_tr_b16 a[8:9], v214
  v_mfma_f32_16x16x32_bf16 v[136:139], a[36:39], a[104:107], v[136:139]
  ds_read_b64_tr_b16 a[10:11], v214 offset:1024
  v_mfma_f32_16x16x32_bf16 v[144:147], a[40:43], a[104:107], v[144:147]
  ds_read_b64_tr_b16 a[12:13], v215
  v_mfma_f32_16x16x32_bf16 v[152:155], a[44:47], a[104:107], v[152:155]
  ds_read_b64_tr_b16 a[14:15], v215 offset:1024
  v_mfma_f32_16x16x32_bf16 v[160:163], a[48:51], a[104:107], v[160:163]
  v_mfma_f32_16x16x32_bf16 v[168:171], a[52:55], a[104:107], v[168:171]
  ds_read_b64_tr_b16 a[16:17], v216
  v_mfma_f32_16x16x32_bf16 v[176:179], a[56:59], a[104:107], v[176:179]
  ds_read_b64_tr_b16 a[18:19], v216 offset:1024
  v_mfma_f32_16x16x32_bf16 v[184:187], a[60:63], a[104:107], v[184:187]
  ds_read_b64_tr_b16 a[20:21], v217
  v_mfma_f32_16x16x32_bf16 v[132:135], a[32:35], a[108:111], v[132:135]
  ds_read_b64_tr_b16 a[22:23], v217 offset:1024
  v_mfma_f32_16x16x32_bf16 v[140:143], a[36:39], a[108:111], v[140:143]
  ds_read_b64_tr_b16 a[24:25], v218
  v_mfma_f32_16x16x32_bf16 v[148:151], a[40:43], a[108:111], v[148:151]
  ds_read_b64_tr_b16 a[26:27], v218 offset:1024
  v_mfma_f32_16x16x32_bf16 v[156:159], a[44:47], a[108:111], v[156:159]
  ds_read_b64_tr_b16 a[28:29], v219
  v_mfma_f32_16x16x32_bf16 v[164:167], a[48:51], a[108:111], v[164:167]
  ds_read_b64_tr_b16 a[30:31], v219 offset:1024
  v_mfma_f32_16x16x32_bf16 v[172:175], a[52:55], a[108:111], v[172:175]
  v_mfma_f32_16x16x32_bf16 v[180:183], a[56:59], a[108:111], v[180:183]
  v_mfma_f32_16x16x32_bf16 v[188:191], a[60:63], a[108:111], v[188:191]
  s_waitcnt lgkmcnt(14)
  v_mfma_f32_16x16x32_bf16 v[0:3], a[0:3], a[64:67], v[0:3]
  s_add_u32 s20, s20, 4
  s_and_b32 s20, s20, 15
  s_waitcnt lgkmcnt(12)
  v_mfma_f32_16x16x32_bf16 v[8:11], a[4:7], a[64:67], v[8:11]
  s_lshl_b32 s82, s20, 18
  s_waitcnt lgkmcnt(10)
  v_mfma_f32_16x16x32_bf16 v[16:19], a[8:11], a[64:67], v[16:19]
  s_add_u32 m0, s74, 0
  s_waitcnt lgkmcnt(8)
  v_mfma_f32_16x16x32_bf16 v[24:27], a[12:15], a[64:67], v[24:27]
  s_waitcnt lgkmcnt(0)
  buffer_load_dwordx4 v192, s[44:47], s82 offen lds
  v_mfma_f32_16x16x32_bf16 v[32:35], a[16:19], a[64:67], v[32:35]
  v_mfma_f32_16x16x32_bf16 v[40:43], a[20:23], a[64:67], v[40:43]
  v_mfma_f32_16x16x32_bf16 v[48:51], a[24:27], a[64:67], v[48:51]
  buffer_load_dwordx4 v193, s[44:47], s82 offen offset:1024 lds
  v_mfma_f32_16x16x32_bf16 v[56:59], a[28:31], a[64:67], v[56:59]
  v_mfma_f32_16x16x32_bf16 v[4:7], a[0:3], a[68:71], v[4:7]
  v_xor_b32 v206, s27, v205
  v_mfma_f32_16x16x32_bf16 v[12:15], a[4:7], a[68:71], v[12:15]
  ds_read_b128 a[88:91], v206
  v_mfma_f32_16x16x32_bf16 v[20:23], a[8:11], a[68:71], v[20:23]
  buffer_load_dwordx4 v194, s[44:47], s82 offen offset:2048 lds
  v_mfma_f32_16x16x32_bf16 v[28:31], a[12:15], a[68:71], v[28:31]
  ds_read_b128 a[92:95], v206 offset:2048
  v_mfma_f32_16x16x32_bf16 v[36:39], a[16:19], a[68:71], v[36:39]
  v_mfma_f32_16x16x32_bf16 v[44:47], a[20:23], a[68:71], v[44:47]
  buffer_load_dwordx4 v195, s[44:47], s82 offen offset:3072 lds
  v_mfma_f32_16x16x32_bf16 v[52:55], a[24:27], a[68:71], v[52:55]
  ds_read_b128 a[96:99], v206 offset:4096
  v_mfma_f32_16x16x32_bf16 v[60:63], a[28:31], a[68:71], v[60:63]
  ds_read_b128 a[100:103], v206 offset:6144
  v_mfma_f32_16x16x32_bf16 v[64:67], a[0:3], a[72:75], v[64:67]
  s_or_b32 s82, s82, 131072
  v_mfma_f32_16x16x32_bf16 v[72:75], a[4:7], a[72:75], v[72:75]
  s_add_u32 m0, s74, 4096
  ds_read_b128 a[104:107], v206 offset:8192
  v_mfma_f32_16x16x32_bf16 v[80:83], a[8:11], a[72:75], v[80:83]
  buffer_load_dwordx4 v192, s[44:47], s82 offen lds
  v_mfma_f32_16x16x32_bf16 v[88:91], a[12:15], a[72:75], v[88:91]
  ds_read_b128 a[108:111], v206 offset:10240
  v_mfma_f32_16x16x32_bf16 v[96:99], a[16:19], a[72:75], v[96:99]
  v_mfma_f32_16x16x32_bf16 v[104:107], a[20:23], a[72:75], v[104:107]
  buffer_load_dwordx4 v193, s[44:47], s82 offen offset:1024 lds
  v_mfma_f32_16x16x32_bf16 v[112:115], a[24:27], a[72:75], v[112:115]
  v_mfma_f32_16x16x32_bf16 v[120:123], a[28:31], a[72:75], v[120:123]
  v_mfma_f32_16x16x32_bf16 v[68:71], a[0:3], a[76:79], v[68:71]
  buffer_load_dwordx4 v194, s[44:47], s82 offen offset:2048 lds
  v_mfma_f32_16x16x32_bf16 v[76:79], a[4:7], a[76:79], v[76:79]
  v_mfma_f32_16x16x32_bf16 v[84:87], a[8:11], a[76:79], v[84:87]
  v_mfma_f32_16x16x32_bf16 v[92:95], a[12:15], a[76:79], v[92:95]
  buffer_load_dwordx4 v195, s[44:47], s82 offen offset:3072 lds
  v_mfma_f32_16x16x32_bf16 v[100:103], a[16:19], a[76:79], v[100:103]
  s_waitcnt vmcnt(8)
  ds_read_b64_tr_b16 a[32:33], v212 offset:8192
  v_mfma_f32_16x16x32_bf16 v[108:111], a[20:23], a[76:79], v[108:111]
  ds_read_b64_tr_b16 a[34:35], v212 offset:9216
  v_mfma_f32_16x16x32_bf16 v[116:119], a[24:27], a[76:79], v[116:119]
  ds_read_b64_tr_b16 a[36:37], v213 offset:8192
  v_mfma_f32_16x16x32_bf16 v[124:127], a[28:31], a[76:79], v[124:127]
  ds_read_b64_tr_b16 a[38:39], v213 offset:9216
  v_mfma_f32_16x16x32_bf16 v[128:131], a[0:3], a[80:83], v[128:131]
  ds_read_b64_tr_b16 a[40:41], v214 offset:8192
  v_mfma_f32_16x16x32_bf16 v[136:139], a[4:7], a[80:83], v[136:139]
  ds_read_b64_tr_b16 a[42:43], v214 offset:9216
  v_mfma_f32_16x16x32_bf16 v[144:147], a[8:11], a[80:83], v[144:147]
  ds_read_b64_tr_b16 a[44:45], v215 offset:8192
  v_mfma_f32_16x16x32_bf16 v[152:155], a[12:15], a[80:83], v[152:155]
  ds_read_b64_tr_b16 a[46:47], v215 offset:9216
  v_mfma_f32_16x16x32_bf16 v[160:163], a[16:19], a[80:83], v[160:163]
  v_mfma_f32_16x16x32_bf16 v[168:171], a[20:23], a[80:83], v[168:171]
  ds_read_b64_tr_b16 a[48:49], v216 offset:8192
  v_mfma_f32_16x16x32_bf16 v[176:179], a[24:27], a[80:83], v[176:179]
  ds_read_b64_tr_b16 a[50:51], v216 offset:9216
  v_mfma_f32_16x16x32_bf16 v[184:187], a[28:31], a[80:83], v[184:187]
  ds_read_b64_tr_b16 a[52:53], v217 offset:8192
  v_mfma_f32_16x16x32_bf16 v[132:135], a[0:3], a[84:87], v[132:135]
  ds_read_b64_tr_b16 a[54:55], v217 offset:9216
  v_mfma_f32_16x16x32_bf16 v[140:143], a[4:7], a[84:87], v[140:143]
  ds_read_b64_tr_b16 a[56:57], v218 offset:8192
  v_mfma_f32_16x16x32_bf16 v[148:151], a[8:11], a[84:87], v[148:151]
  ds_read_b64_tr_b16 a[58:59], v218 offset:9216
  v_mfma_f32_16x16x32_bf16 v[156:159], a[12:15], a[84:87], v[156:159]
  ds_read_b64_tr_b16 a[60:61], v219 offset:8192
  v_mfma_f32_16x16x32_bf16 v[164:167], a[16:19], a[84:87], v[164:167]
  ds_read_b64_tr_b16 a[62:63], v219 offset:9216
  v_mfma_f32_16x16x32_bf16 v[172:175], a[20:23], a[84:87], v[172:175]
  v_mfma_f32_16x16x32_bf16 v[180:183], a[24:27], a[84:87], v[180:183]
  v_mfma_f32_16x16x32_bf16 v[188:191], a[28:31], a[84:87], v[188:191]
  s_waitcnt lgkmcnt(14)
  v_mfma_f32_16x16x32_bf16 v[0:3], a[32:35], a[88:91], v[0:3]
  s_add_u32 s21, s21, 4
  s_and_b32 s21, s21, 15
  s_waitcnt lgkmcnt(12)
  v_mfma_f32_16x16x32_bf16 v[8:11], a[36:39], a[88:91], v[8:11]
  s_lshl_b32 s82, s21, 18
  s_waitcnt lgkmcnt(10)
  v_mfma_f32_16x16x32_bf16 v[16:19], a[40:43], a[88:91], v[16:19]
  s_add_u32 m0, s74, 8192
  s_waitcnt lgkmcnt(8)
  v_mfma_f32_16x16x32_bf16 v[24:27], a[44:47], a[88:91], v[24:27]
  s_waitcnt lgkmcnt(0)
  buffer_load_dwordx4 v192, s[44:47], s82 offen lds
  v_mfma_f32_16x16x32_bf16 v[32:35], a[48:51], a[88:91], v[32:35]
  v_mfma_f32_16x16x32_bf16 v[40:43], a[52:55], a[88:91], v[40:43]
  v_mfma_f32_16x16x32_bf16 v[48:51], a[56:59], a[88:91], v[48:51]
  buffer_load_dwordx4 v193, s[44:47], s82 offen offset:1024 lds
  v_mfma_f32_16x16x32_bf16 v[56:59], a[60:63], a[88:91], v[56:59]
  v_mfma_f32_16x16x32_bf16 v[4:7], a[32:35], a[92:95], v[4:7]
  v_mfma_f32_16x16x32_bf16 v[12:15], a[36:39], a[92:95], v[12:15]
  v_mfma_f32_16x16x32_bf16 v[20:23], a[40:43], a[92:95], v[20:23]
  buffer_load_dwordx4 v194, s[44:47], s82 offen offset:2048 lds
  v_mfma_f32_16x16x32_bf16 v[28:31], a[44:47], a[92:95], v[28:31]
  v_mfma_f32_16x16x32_bf16 v[36:39], a[48:51], a[92:95], v[36:39]
  v_mfma_f32_16x16x32_bf16 v[44:47], a[52:55], a[92:95], v[44:47]
  buffer_load_dwordx4 v195, s[44:47], s82 offen offset:3072 lds
  v_mfma_f32_16x16x32_bf16 v[52:55], a[56:59], a[92:95], v[52:55]
  v_mfma_f32_16x16x32_bf16 v[60:63], a[60:63], a[92:95], v[60:63]
  v_mfma_f32_16x16x32_bf16 v[64:67], a[32:35], a[96:99], v[64:67]
  s_or_b32 s82, s82, 131072
  v_mfma_f32_16x16x32_bf16 v[72:75], a[36:39], a[96:99], v[72:75]
  s_add_u32 m0, s74, 12288
  v_mfma_f32_16x16x32_bf16 v[80:83], a[40:43], a[96:99], v[80:83]
  s_barrier
  v_mfma_f32_16x16x32_bf16 v[88:91], a[44:47], a[96:99], v[88:91]
  buffer_load_dwordx4 v192, s[44:47], s82 offen lds
  v_mfma_f32_16x16x32_bf16 v[96:99], a[48:51], a[96:99], v[96:99]
  s_add_u32 s77, s24, 24576
  v_mfma_f32_16x16x32_bf16 v[104:107], a[52:55], a[96:99], v[104:107]
  v_xor_b32 v206, s77, v205
  v_mfma_f32_16x16x32_bf16 v[112:115], a[56:59], a[96:99], v[112:115]
  buffer_load_dwordx4 v193, s[44:47], s82 offen offset:1024 lds
  v_mfma_f32_16x16x32_bf16 v[120:123], a[60:63], a[96:99], v[120:123]
  ds_read_b128 a[64:67], v206
  v_mfma_f32_16x16x32_bf16 v[68:71], a[32:35], a[100:103], v[68:71]
  ds_read_b128 a[68:71], v206 offset:2048
  v_mfma_f32_16x16x32_bf16 v[76:79], a[36:39], a[100:103], v[76:79]
  buffer_load_dwordx4 v194, s[44:47], s82 offen offset:2048 lds
  v_mfma_f32_16x16x32_bf16 v[84:87], a[40:43], a[100:103], v[84:87]
  ds_read_b128 a[72:75], v206 offset:4096
  v_mfma_f32_16x16x32_bf16 v[92:95], a[44:47], a[100:103], v[92:95]
  buffer_load_dwordx4 v195, s[44:47], s82 offen offset:3072 lds
  v_mfma_f32_16x16x32_bf16 v[100:103], a[48:51], a[100:103], v[100:103]
  s_waitcnt vmcnt(8)
  ds_read_b64_tr_b16 a[0:1], v212
  ds_read_b128 a[76:79], v206 offset:6144
  v_mfma_f32_16x16x32_bf16 v[108:111], a[52:55], a[100:103], v[108:111]
  ds_read_b64_tr_b16 a[2:3], v212 offset:1024
  v_mfma_f32_16x16x32_bf16 v[116:119], a[56:59], a[100:103], v[116:119]
  ds_read_b128 a[80:83], v206 offset:8192
  ds_read_b64_tr_b16 a[4:5], v213
  v_mfma_f32_16x16x32_bf16 v[124:127], a[60:63], a[100:103], v[124:127]
  s_add_u32 s79, s72, 4
  ds_read_b64_tr_b16 a[6:7], v213 offset:1024
  v_mfma_f32_16x16x32_bf16 v[128:131], a[32:35], a[104:107], v[128:131]
  ds_read_b128 a[84:87], v206 offset:10240
  s_and_b32 s79, s79, 7
  v_mfma_f32_16x16x32_bf16 v[136:139], a[36:39], a[104:107], v[136:139]
  ds_read_b64_tr_b16 a[8:9], v214
  s_lshl_b32 s83, s79, 7
  v_mfma_f32_16x16x32_bf16 v[144:147], a[40:43], a[104:107], v[144:147]
  ds_read_b64_tr_b16 a[10:11], v214 offset:1024
  s_mul_i32 s80, s68, 3072
  v_mfma_f32_16x16x32_bf16 v[152:155], a[44:47], a[104:107], v[152:155]
  ds_read_b64_tr_b16 a[12:13], v215
  s_add_u32 m0, s80, 49152
  v_mfma_f32_16x16x32_bf16 v[160:163], a[48:51], a[104:107], v[160:163]
  ds_read_b64_tr_b16 a[14:15], v215 offset:1024
  v_mfma_f32_16x16x32_bf16 v[168:171], a[52:55], a[104:107], v[168:171]
  buffer_load_dwordx4 v196, s[32:35], s83 offen lds
  v_mfma_f32_16x16x32_bf16 v[176:179], a[56:59], a[104:107], v[176:179]
  ds_read_b64_tr_b16 a[16:17], v216
  ds_read_b64_tr_b16 a[18:19], v216 offset:1024
  v_mfma_f32_16x16x32_bf16 v[184:187], a[60:63], a[104:107], v[184:187]
  ds_read_b64_tr_b16 a[20:21], v217
  v_mfma_f32_16x16x32_bf16 v[132:135], a[32:35], a[108:111], v[132:135]
  buffer_load_dwordx4 v197, s[32:35], s83 offen offset:1024 lds
  v_mfma_f32_16x16x32_bf16 v[140:143], a[36:39], a[108:111], v[140:143]
  ds_read_b64_tr_b16 a[22:23], v217 offset:1024
  ds_read_b64_tr_b16 a[24:25], v218
  v_mfma_f32_16x16x32_bf16 v[148:151], a[40:43], a[108:111], v[148:151]
  ds_read_b64_tr_b16 a[26:27], v218 offset:1024
  v_mfma_f32_16x16x32_bf16 v[156:159], a[44:47], a[108:111], v[156:159]
  ds_read_b64_tr_b16 a[28:29], v219
  v_mfma_f32_16x16x32_bf16 v[164:167], a[48:51], a[108:111], v[164:167]
  buffer_load_dwordx4 v198, s[32:35], s83 offen offset:2048 lds
  v_mfma_f32_16x16x32_bf16 v[172:175], a[52:55], a[108:111], v[172:175]
  ds_read_b64_tr_b16 a[30:31], v219 offset:1024
  v_mfma_f32_16x16x32_bf16 v[180:183], a[56:59], a[108:111], v[180:183]
  v_mfma_f32_16x16x32_bf16 v[188:191], a[60:63], a[108:111], v[188:191]
  s_waitcnt lgkmcnt(15)
  v_mfma_f32_16x16x32_bf16 v[0:3], a[0:3], a[64:67], v[0:3]
  s_add_u32 s22, s22, 4
  s_and_b32 s22, s22, 15
  s_waitcnt lgkmcnt(13)
  v_mfma_f32_16x16x32_bf16 v[8:11], a[4:7], a[64:67], v[8:11]
  s_lshl_b32 s82, s22, 18
  s_waitcnt lgkmcnt(10)
  v_mfma_f32_16x16x32_bf16 v[16:19], a[8:11], a[64:67], v[16:19]
  s_add_u32 m0, s74, 0
  s_waitcnt lgkmcnt(8)
  v_mfma_f32_16x16x32_bf16 v[24:27], a[12:15], a[64:67], v[24:27]
  s_waitcnt lgkmcnt(0)
  buffer_load_dwordx4 v192, s[44:47], s82 offen lds
  v_mfma_f32_16x16x32_bf16 v[32:35], a[16:19], a[64:67], v[32:35]
  v_mfma_f32_16x16x32_bf16 v[40:43], a[20:23], a[64:67], v[40:43]
  v_mfma_f32_16x16x32_bf16 v[48:51], a[24:27], a[64:67], v[48:51]
  buffer_load_dwordx4 v193, s[44:47], s82 offen offset:1024 lds
  v_mfma_f32_16x16x32_bf16 v[56:59], a[28:31], a[64:67], v[56:59]
  v_mfma_f32_16x16x32_bf16 v[4:7], a[0:3], a[68:71], v[4:7]
  s_add_u32 s77, s25, 24576
  v_mfma_f32_16x16x32_bf16 v[12:15], a[4:7], a[68:71], v[12:15]
  v_xor_b32 v206, s77, v205
  v_mfma_f32_16x16x32_bf16 v[20:23], a[8:11], a[68:71], v[20:23]
  buffer_load_dwordx4 v194, s[44:47], s82 offen offset:2048 lds
  v_mfma_f32_16x16x32_bf16 v[28:31], a[12:15], a[68:71], v[28:31]
  ds_read_b128 a[88:91], v206
  v_mfma_f32_16x16x32_bf16 v[36:39], a[16:19], a[68:71], v[36:39]
  ds_read_b128 a[92:95], v206 offset:2048
  v_mfma_f32_16x16x32_bf16 v[44:47], a[20:23], a[68:71], v[44:47]
  buffer_load_dwordx4 v195, s[44:47], s82 offen offset:3072 lds
  v_mfma_f32_16x16x32_bf16 v[52:55], a[24:27], a[68:71], v[52:55]
  ds_read_b128 a[96:99], v206 offset:4096
  v_mfma_f32_16x16x32_bf16 v[60:63], a[28:31], a[68:71], v[60:63]
  v_mfma_f32_16x16x32_bf16 v[64:67], a[0:3], a[72:75], v[64:67]
  ds_read_b128 a[100:103], v206 offset:6144
  s_or_b32 s82, s82, 131072
  v_mfma_f32_16x16x32_bf16 v[72:75], a[4:7], a[72:75], v[72:75]
  s_add_u32 m0, s74, 4096
  v_mfma_f32_16x16x32_bf16 v[80:83], a[8:11], a[72:75], v[80:83]
  ds_read_b128 a[104:107], v206 offset:8192
  v_mfma_f32_16x16x32_bf16 v[88:91], a[12:15], a[72:75], v[88:91]
  buffer_load_dwordx4 v192, s[44:47], s82 offen lds
  v_mfma_f32_16x16x32_bf16 v[96:99], a[16:19], a[72:75], v[96:99]
  ds_read_b128 a[108:111], v206 offset:10240
  v_mfma_f32_16x16x32_bf16 v[104:107], a[20:23], a[72:75], v[104:107]
  buffer_load_dwordx4 v193, s[44:47], s82 offen offset:1024 lds
  v_mfma_f32_16x16x32_bf16 v[112:115], a[24:27], a[72:75], v[112:115]
  v_mfma_f32_16x16x32_bf16 v[120:123], a[28:31], a[72:75], v[120:123]
  v_mfma_f32_16x16x32_bf16 v[68:71], a[0:3], a[76:79], v[68:71]
  buffer_load_dwordx4 v194, s[44:47], s82 offen offset:2048 lds
  v_mfma_f32_16x16x32_bf16 v[76:79], a[4:7], a[76:79], v[76:79]
  v_mfma_f32_16x16x32_bf16 v[84:87], a[8:11], a[76:79], v[84:87]
  v_mfma_f32_16x16x32_bf16 v[92:95], a[12:15], a[76:79], v[92:95]
  buffer_load_dwordx4 v195, s[44:47], s82 offen offset:3072 lds
  v_mfma_f32_16x16x32_bf16 v[100:103], a[16:19], a[76:79], v[100:103]
  s_waitcnt vmcnt(11)
  ds_read_b64_tr_b16 a[32:33], v212 offset:8192
  v_mfma_f32_16x16x32_bf16 v[108:111], a[20:23], a[76:79], v[108:111]
  ds_read_b64_tr_b16 a[34:35], v212 offset:9216
  v_mfma_f32_16x16x32_bf16 v[116:119], a[24:27], a[76:79], v[116:119]
  ds_read_b64_tr_b16 a[36:37], v213 offset:8192
  v_mfma_f32_16x16x32_bf16 v[124:127], a[28:31], a[76:79], v[124:127]
  s_add_u32 s79, s72, 5
  ds_read_b64_tr_b16 a[38:39], v213 offset:9216
  v_mfma_f32_16x16x32_bf16 v[128:131], a[0:3], a[80:83], v[128:131]
  s_and_b32 s79, s79, 7
  s_lshl_b32 s83, s79, 7
  v_mfma_f32_16x16x32_bf16 v[136:139], a[4:7], a[80:83], v[136:139]
  s_mul_i32 s80, s68, 3072
  ds_read_b64_tr_b16 a[40:41], v214 offset:8192
  v_mfma_f32_16x16x32_bf16 v[144:147], a[8:11], a[80:83], v[144:147]
  s_add_u32 m0, s80, 61440
  ds_read_b64_tr_b16 a[42:43], v214 offset:9216
  v_mfma_f32_16x16x32_bf16 v[152:155], a[12:15], a[80:83], v[152:155]
  buffer_load_dwordx4 v196, s[32:35], s83 offen lds
  v_mfma_f32_16x16x32_bf16 v[160:163], a[16:19], a[80:83], v[160:163]
  buffer_load_dwordx4 v197, s[32:35], s83 offen offset:1024 lds
  v_mfma_f32_16x16x32_bf16 v[168:171], a[20:23], a[80:83], v[168:171]
  ds_read_b64_tr_b16 a[44:45], v215 offset:8192
  ds_read_b64_tr_b16 a[46:47], v215 offset:9216
  v_mfma_f32_16x16x32_bf16 v[176:179], a[24:27], a[80:83], v[176:179]
  buffer_load_dwordx4 v198, s[32:35], s83 offen offset:2048 lds
  v_mfma_f32_16x16x32_bf16 v[184:187], a[28:31], a[80:83], v[184:187]
  ds_read_b64_tr_b16 a[48:49], v216 offset:8192
  s_mov_b32 s84, 0
  v_mfma_f32_16x16x32_bf16 v[132:135], a[0:3], a[84:87], v[132:135]
  s_mul_i32 s80, s68, 6144
  ds_read_b64_tr_b16 a[50:51], v216 offset:9216
  v_mfma_f32_16x16x32_bf16 v[140:143], a[4:7], a[84:87], v[140:143]
  s_add_u32 m0, s80, 0
  ds_read_b64_tr_b16 a[52:53], v217 offset:8192
  v_mfma_f32_16x16x32_bf16 v[148:151], a[8:11], a[84:87], v[148:151]
  buffer_load_dwordx4 v199, s[36:39], s84 offen nt lds
  v_mfma_f32_16x16x32_bf16 v[156:159], a[12:15], a[84:87], v[156:159]
  buffer_load_dwordx4 v200, s[36:39], s84 offen offset:1024 nt lds
  v_mfma_f32_16x16x32_bf16 v[164:167], a[16:19], a[84:87], v[164:167]
  ds_read_b64_tr_b16 a[54:55], v217 offset:9216
  ds_read_b64_tr_b16 a[56:57], v218 offset:8192
  v_mfma_f32_16x16x32_bf16 v[172:175], a[20:23], a[84:87], v[172:175]
  buffer_load_dwordx4 v201, s[36:39], s84 offen offset:2048 nt lds
  ds_read_b64_tr_b16 a[58:59], v218 offset:9216
  ds_read_b64_tr_b16 a[60:61], v219 offset:8192
  ds_read_b64_tr_b16 a[62:63], v219 offset:9216
  v_mfma_f32_16x16x32_bf16 v[180:183], a[24:27], a[84:87], v[180:183]
  buffer_load_dwordx4 v202, s[36:39], s84 offen offset:3072 nt lds
  v_mfma_f32_16x16x32_bf16 v[188:191], a[28:31], a[84:87], v[188:191]
  s_add_u32 m0, s80, 4096
  s_nop 0
  buffer_load_dwordx4 v203, s[36:39], s84 offen nt lds
  buffer_load_dwordx4 v204, s[36:39], s84 offen offset:1024 nt lds
  s_waitcnt lgkmcnt(14)
  v_mfma_f32_16x16x32_bf16 v[0:3], a[32:35], a[88:91], v[0:3]
  s_add_u32 s23, s23, 4
  s_and_b32 s23, s23, 15
  s_waitcnt lgkmcnt(12)
  v_mfma_f32_16x16x32_bf16 v[8:11], a[36:39], a[88:91], v[8:11]
  s_lshl_b32 s82, s23, 18
  s_waitcnt lgkmcnt(10)
  v_mfma_f32_16x16x32_bf16 v[16:19], a[40:43], a[88:91], v[16:19]
  s_add_u32 m0, s74, 8192
  s_waitcnt lgkmcnt(8)
  v_mfma_f32_16x16x32_bf16 v[24:27], a[44:47], a[88:91], v[24:27]
  s_waitcnt lgkmcnt(0)
  buffer_load_dwordx4 v192, s[44:47], s82 offen lds
  v_mfma_f32_16x16x32_bf16 v[32:35], a[48:51], a[88:91], v[32:35]
  v_mfma_f32_16x16x32_bf16 v[40:43], a[52:55], a[88:91], v[40:43]
  v_mfma_f32_16x16x32_bf16 v[48:51], a[56:59], a[88:91], v[48:51]
  buffer_load_dwordx4 v193, s[44:47], s82 offen offset:1024 lds
  v_mfma_f32_16x16x32_bf16 v[56:59], a[60:63], a[88:91], v[56:59]
  v_mfma_f32_16x16x32_bf16 v[4:7], a[32:35], a[92:95], v[4:7]
  s_add_u32 s77, s26, 24576
  v_mfma_f32_16x16x32_bf16 v[12:15], a[36:39], a[92:95], v[12:15]
  v_xor_b32 v206, s77, v205
  v_mfma_f32_16x16x32_bf16 v[20:23], a[40:43], a[92:95], v[20:23]
  buffer_load_dwordx4 v194, s[44:47], s82 offen offset:2048 lds
  v_mfma_f32_16x16x32_bf16 v[28:31], a[44:47], a[92:95], v[28:31]
  ds_read_b128 a[64:67], v206
  v_mfma_f32_16x16x32_bf16 v[36:39], a[48:51], a[92:95], v[36:39]
  ds_read_b128 a[68:71], v206 offset:2048
  v_mfma_f32_16x16x32_bf16 v[44:47], a[52:55], a[92:95], v[44:47]
  buffer_load_dwordx4 v195, s[44:47], s82 offen offset:3072 lds
  v_mfma_f32_16x16x32_bf16 v[52:55], a[56:59], a[92:95], v[52:55]
  ds_read_b128 a[72:75], v206 offset:4096
  v_mfma_f32_16x16x32_bf16 v[60:63], a[60:63], a[92:95], v[60:63]
  v_mfma_f32_16x16x32_bf16 v[64:67], a[32:35], a[96:99], v[64:67]
  ds_read_b128 a[76:79], v206 offset:6144
  s_or_b32 s82, s82, 131072
  v_mfma_f32_16x16x32_bf16 v[72:75], a[36:39], a[96:99], v[72:75]
  s_add_u32 m0, s74, 12288
  v_mfma_f32_16x16x32_bf16 v[80:83], a[40:43], a[96:99], v[80:83]
  ds_read_b128 a[80:83], v206 offset:8192
  v_mfma_f32_16x16x32_bf16 v[88:91], a[44:47], a[96:99], v[88:91]
  buffer_load_dwordx4 v192, s[44:47], s82 offen lds
  v_mfma_f32_16x16x32_bf16 v[96:99], a[48:51], a[96:99], v[96:99]
  ds_read_b128 a[84:87], v206 offset:10240
  v_mfma_f32_16x16x32_bf16 v[104:107], a[52:55], a[96:99], v[104:107]
  buffer_load_dwordx4 v193, s[44:47], s82 offen offset:1024 lds
  v_mfma_f32_16x16x32_bf16 v[112:115], a[56:59], a[96:99], v[112:115]
  v_mfma_f32_16x16x32_bf16 v[120:123], a[60:63], a[96:99], v[120:123]
  v_mfma_f32_16x16x32_bf16 v[68:71], a[32:35], a[100:103], v[68:71]
  buffer_load_dwordx4 v194, s[44:47], s82 offen offset:2048 lds
  v_mfma_f32_16x16x32_bf16 v[76:79], a[36:39], a[100:103], v[76:79]
  v_mfma_f32_16x16x32_bf16 v[84:87], a[40:43], a[100:103], v[84:87]
  v_mfma_f32_16x16x32_bf16 v[92:95], a[44:47], a[100:103], v[92:95]
  buffer_load_dwordx4 v195, s[44:47], s82 offen offset:3072 lds
  v_mfma_f32_16x16x32_bf16 v[100:103], a[48:51], a[100:103], v[100:103]
  s_waitcnt vmcnt(17)
  ds_read_b64_tr_b16 a[0:1], v212
  v_mfma_f32_16x16x32_bf16 v[108:111], a[52:55], a[100:103], v[108:111]
  ds_read_b64_tr_b16 a[2:3], v212 offset:1024
  v_mfma_f32_16x16x32_bf16 v[116:119], a[56:59], a[100:103], v[116:119]
  ds_read_b64_tr_b16 a[4:5], v213
  v_mfma_f32_16x16x32_bf16 v[124:127], a[60:63], a[100:103], v[124:127]
  s_add_u32 s79, s72, 6
  ds_read_b64_tr_b16 a[6:7], v213 offset:1024
  v_mfma_f32_16x16x32_bf16 v[128:131], a[32:35], a[104:107], v[128:131]
  s_and_b32 s79, s79, 7
  ds_read_b64_tr_b16 a[8:9], v214
  v_mfma_f32_16x16x32_bf16 v[136:139], a[36:39], a[104:107], v[136:139]
  s_lshl_b32 s83, s79, 7
  ds_read_b64_tr_b16 a[10:11], v214 offset:1024
  v_mfma_f32_16x16x32_bf16 v[144:147], a[40:43], a[104:107], v[144:147]
  s_mul_i32 s80, s68, 3072
  ds_read_b64_tr_b16 a[12:13], v215
  v_mfma_f32_16x16x32_bf16 v[152:155], a[44:47], a[104:107], v[152:155]
  s_add_u32 m0, s80, 73728
  ds_read_b64_tr_b16 a[14:15], v215 offset:1024
  v_mfma_f32_16x16x32_bf16 v[160:163], a[48:51], a[104:107], v[160:163]
  buffer_load_dwordx4 v196, s[32:35], s83 offen lds
  v_mfma_f32_16x16x32_bf16 v[168:171], a[52:55], a[104:107], v[168:171]
  ds_read_b64_tr_b16 a[16:17], v216
  v_mfma_f32_16x16x32_bf16 v[176:179], a[56:59], a[104:107], v[176:179]
  ds_read_b64_tr_b16 a[18:19], v216 offset:1024
  v_mfma_f32_16x16x32_bf16 v[184:187], a[60:63], a[104:107], v[184:187]
  ds_read_b64_tr_b16 a[20:21], v217
  v_mfma_f32_16x16x32_bf16 v[132:135], a[32:35], a[108:111], v[132:135]
  buffer_load_dwordx4 v197, s[32:35], s83 offen offset:1024 lds
  v_mfma_f32_16x16x32_bf16 v[140:143], a[36:39], a[108:111], v[140:143]
  ds_read_b64_tr_b16 a[22:23], v217 offset:1024
  ds_read_b64_tr_b16 a[24:25], v218
  v_mfma_f32_16x16x32_bf16 v[148:151], a[40:43], a[108:111], v[148:151]
  ds_read_b64_tr_b16 a[26:27], v218 offset:1024
  v_mfma_f32_16x16x32_bf16 v[156:159], a[44:47], a[108:111], v[156:159]
  ds_read_b64_tr_b16 a[28:29], v219
  v_mfma_f32_16x16x32_bf16 v[164:167], a[48:51], a[108:111], v[164:167]
  buffer_load_dwordx4 v198, s[32:35], s83 offen offset:2048 lds
  v_mfma_f32_16x16x32_bf16 v[172:175], a[52:55], a[108:111], v[172:175]
  ds_read_b64_tr_b16 a[30:31], v219 offset:1024
  v_mfma_f32_16x16x32_bf16 v[180:183], a[56:59], a[108:111], v[180:183]
  v_mfma_f32_16x16x32_bf16 v[188:191], a[60:63], a[108:111], v[188:191]
  s_waitcnt lgkmcnt(14)
  v_mfma_f32_16x16x32_bf16 v[0:3], a[0:3], a[64:67], v[0:3]
  s_add_u32 s20, s20, 4
  s_and_b32 s20, s20, 15
  s_waitcnt lgkmcnt(12)
  v_mfma_f32_16x16x32_bf16 v[8:11], a[4:7], a[64:67], v[8:11]
  s_lshl_b32 s82, s20, 18
  s_waitcnt lgkmcnt(10)
  v_mfma_f32_16x16x32_bf16 v[16:19], a[8:11], a[64:67], v[16:19]
  s_add_u32 m0, s74, 0
  s_waitcnt lgkmcnt(8)
  v_mfma_f32_16x16x32_bf16 v[24:27], a[12:15], a[64:67], v[24:27]
  s_waitcnt lgkmcnt(0)
  buffer_load_dwordx4 v192, s[44:47], s82 offen lds
  v_mfma_f32_16x16x32_bf16 v[32:35], a[16:19], a[64:67], v[32:35]
  v_mfma_f32_16x16x32_bf16 v[40:43], a[20:23], a[64:67], v[40:43]
  v_mfma_f32_16x16x32_bf16 v[48:51], a[24:27], a[64:67], v[48:51]
  buffer_load_dwordx4 v193, s[44:47], s82 offen offset:1024 lds
  v_mfma_f32_16x16x32_bf16 v[56:59], a[28:31], a[64:67], v[56:59]
  v_mfma_f32_16x16x32_bf16 v[4:7], a[0:3], a[68:71], v[4:7]
  s_add_u32 s77, s27, 24576
  v_mfma_f32_16x16x32_bf16 v[12:15], a[4:7], a[68:71], v[12:15]
  v_xor_b32 v206, s77, v205
  v_mfma_f32_16x16x32_bf16 v[20:23], a[8:11], a[68:71], v[20:23]
  buffer_load_dwordx4 v194, s[44:47], s82 offen offset:2048 lds
  v_mfma_f32_16x16x32_bf16 v[28:31], a[12:15], a[68:71], v[28:31]
  ds_read_b128 a[88:91], v206
  v_mfma_f32_16x16x32_bf16 v[36:39], a[16:19], a[68:71], v[36:39]
  ds_read_b128 a[92:95], v206 offset:2048
  v_mfma_f32_16x16x32_bf16 v[44:47], a[20:23], a[68:71], v[44:47]
  buffer_load_dwordx4 v195, s[44:47], s82 offen offset:3072 lds
  v_mfma_f32_16x16x32_bf16 v[52:55], a[24:27], a[68:71], v[52:55]
  ds_read_b128 a[96:99], v206 offset:4096
  v_mfma_f32_16x16x32_bf16 v[60:63], a[28:31], a[68:71], v[60:63]
  v_mfma_f32_16x16x32_bf16 v[64:67], a[0:3], a[72:75], v[64:67]
  ds_read_b128 a[100:103], v206 offset:6144
  s_or_b32 s82, s82, 131072
  v_mfma_f32_16x16x32_bf16 v[72:75], a[4:7], a[72:75], v[72:75]
  s_add_u32 m0, s74, 4096
  v_mfma_f32_16x16x32_bf16 v[80:83], a[8:11], a[72:75], v[80:83]
  ds_read_b128 a[104:107], v206 offset:8192
  v_mfma_f32_16x16x32_bf16 v[88:91], a[12:15], a[72:75], v[88:91]
  buffer_load_dwordx4 v192, s[44:47], s82 offen lds
  v_mfma_f32_16x16x32_bf16 v[96:99], a[16:19], a[72:75], v[96:99]
  ds_read_b128 a[108:111], v206 offset:10240
  v_mfma_f32_16x16x32_bf16 v[104:107], a[20:23], a[72:75], v[104:107]
  buffer_load_dwordx4 v193, s[44:47], s82 offen offset:1024 lds
  v_mfma_f32_16x16x32_bf16 v[112:115], a[24:27], a[72:75], v[112:115]
  v_mfma_f32_16x16x32_bf16 v[120:123], a[28:31], a[72:75], v[120:123]
  v_mfma_f32_16x16x32_bf16 v[68:71], a[0:3], a[76:79], v[68:71]
  buffer_load_dwordx4 v194, s[44:47], s82 offen offset:2048 lds
  v_mfma_f32_16x16x32_bf16 v[76:79], a[4:7], a[76:79], v[76:79]
  v_mfma_f32_16x16x32_bf16 v[84:87], a[8:11], a[76:79], v[84:87]
  v_mfma_f32_16x16x32_bf16 v[92:95], a[12:15], a[76:79], v[92:95]
  buffer_load_dwordx4 v195, s[44:47], s82 offen offset:3072 lds
  v_mfma_f32_16x16x32_bf16 v[100:103], a[16:19], a[76:79], v[100:103]
  s_waitcnt vmcnt(11)
  ds_read_b64_tr_b16 a[32:33], v212 offset:8192
  v_mfma_f32_16x16x32_bf16 v[108:111], a[20:23], a[76:79], v[108:111]
  ds_read_b64_tr_b16 a[34:35], v212 offset:9216
  v_mfma_f32_16x16x32_bf16 v[116:119], a[24:27], a[76:79], v[116:119]
  ds_read_b64_tr_b16 a[36:37], v213 offset:8192
  v_mfma_f32_16x16x32_bf16 v[124:127], a[28:31], a[76:79], v[124:127]
  s_add_u32 s79, s72, 7
  ds_read_b64_tr_b16 a[38:39], v213 offset:9216
  v_mfma_f32_16x16x32_bf16 v[128:131], a[0:3], a[80:83], v[128:131]
  s_and_b32 s79, s79, 7
  ds_read_b64_tr_b16 a[40:41], v214 offset:8192
  v_mfma_f32_16x16x32_bf16 v[136:139], a[4:7], a[80:83], v[136:139]
  s_lshl_b32 s83, s79, 7
  ds_read_b64_tr_b16 a[42:43], v214 offset:9216
  v_mfma_f32_16x16x32_bf16 v[144:147], a[8:11], a[80:83], v[144:147]
  s_mul_i32 s80, s68, 3072
  ds_read_b64_tr_b16 a[44:45], v215 offset:8192
  v_mfma_f32_16x16x32_bf16 v[152:155], a[12:15], a[80:83], v[152:155]
  s_add_u32 m0, s80, 86016
  ds_read_b64_tr_b16 a[46:47], v215 offset:9216
  v_mfma_f32_16x16x32_bf16 v[160:163], a[16:19], a[80:83], v[160:163]
  buffer_load_dwordx4 v196, s[32:35], s83 offen lds
  v_mfma_f32_16x16x32_bf16 v[168:171], a[20:23], a[80:83], v[168:171]
  ds_read_b64_tr_b16 a[48:49], v216 offset:8192
  v_mfma_f32_16x16x32_bf16 v[176:179], a[24:27], a[80:83], v[176:179]
  ds_read_b64_tr_b16 a[50:51], v216 offset:9216
  v_mfma_f32_16x16x32_bf16 v[184:187], a[28:31], a[80:83], v[184:187]
  ds_read_b64_tr_b16 a[52:53], v217 offset:8192
  v_mfma_f32_16x16x32_bf16 v[132:135], a[0:3], a[84:87], v[132:135]
  buffer_load_dwordx4 v197, s[32:35], s83 offen offset:1024 lds
  v_mfma_f32_16x16x32_bf16 v[140:143], a[4:7], a[84:87], v[140:143]
  ds_read_b64_tr_b16 a[54:55], v217 offset:9216
  ds_read_b64_tr_b16 a[56:57], v218 offset:8192
  v_mfma_f32_16x16x32_bf16 v[148:151], a[8:11], a[84:87], v[148:151]
  ds_read_b64_tr_b16 a[58:59], v218 offset:9216
  v_mfma_f32_16x16x32_bf16 v[156:159], a[12:15], a[84:87], v[156:159]
  ds_read_b64_tr_b16 a[60:61], v219 offset:8192
  v_mfma_f32_16x16x32_bf16 v[164:167], a[16:19], a[84:87], v[164:167]
  buffer_load_dwordx4 v198, s[32:35], s83 offen offset:2048 lds
  v_mfma_f32_16x16x32_bf16 v[172:175], a[20:23], a[84:87], v[172:175]
  ds_read_b64_tr_b16 a[62:63], v219 offset:9216
  v_mfma_f32_16x16x32_bf16 v[180:183], a[24:27], a[84:87], v[180:183]
  v_mfma_f32_16x16x32_bf16 v[188:191], a[28:31], a[84:87], v[188:191]
  s_waitcnt lgkmcnt(14)
  v_mfma_f32_16x16x32_bf16 v[0:3], a[32:35], a[88:91], v[0:3]
  s_add_u32 s21, s21, 4
  s_and_b32 s21, s21, 15
  s_waitcnt lgkmcnt(12)
  v_mfma_f32_16x16x32_bf16 v[8:11], a[36:39], a[88:91], v[8:11]
  s_lshl_b32 s82, s21, 18
  s_waitcnt lgkmcnt(10)
  v_mfma_f32_16x16x32_bf16 v[16:19], a[40:43], a[88:91], v[16:19]
  s_add_u32 m0, s74, 8192
  s_waitcnt lgkmcnt(8)
  v_mfma_f32_16x16x32_bf16 v[24:27], a[44:47], a[88:91], v[24:27]
  s_waitcnt lgkmcnt(0)
  buffer_load_dwordx4 v192, s[44:47], s82 offen lds
  v_mfma_f32_16x16x32_bf16 v[32:35], a[48:51], a[88:91], v[32:35]
  v_mfma_f32_16x16x32_bf16 v[40:43], a[52:55], a[88:91], v[40:43]
  v_mfma_f32_16x16x32_bf16 v[48:51], a[56:59], a[88:91], v[48:51]
  buffer_load_dwordx4 v193, s[44:47], s82 offen offset:1024 lds
  v_mfma_f32_16x16x32_bf16 v[56:59], a[60:63], a[88:91], v[56:59]
  v_mfma_f32_16x16x32_bf16 v[4:7], a[32:35], a[92:95], v[4:7]
  v_mfma_f32_16x16x32_bf16 v[12:15], a[36:39], a[92:95], v[12:15]
  v_mfma_f32_16x16x32_bf16 v[20:23], a[40:43], a[92:95], v[20:23]
  buffer_load_dwordx4 v194, s[44:47], s82 offen offset:2048 lds
  v_mfma_f32_16x16x32_bf16 v[28:31], a[44:47], a[92:95], v[28:31]
  v_mfma_f32_16x16x32_bf16 v[36:39], a[48:51], a[92:95], v[36:39]
  v_mfma_f32_16x16x32_bf16 v[44:47], a[52:55], a[92:95], v[44:47]
  buffer_load_dwordx4 v195, s[44:47], s82 offen offset:3072 lds
  v_mfma_f32_16x16x32_bf16 v[52:55], a[56:59], a[92:95], v[52:55]
  v_mfma_f32_16x16x32_bf16 v[60:63], a[60:63], a[92:95], v[60:63]
  v_mfma_f32_16x16x32_bf16 v[64:67], a[32:35], a[96:99], v[64:67]
  s_or_b32 s82, s82, 131072
  v_mfma_f32_16x16x32_bf16 v[72:75], a[36:39], a[96:99], v[72:75]
  s_add_u32 m0, s74, 12288
  v_mfma_f32_16x16x32_bf16 v[80:83], a[40:43], a[96:99], v[80:83]
  s_barrier
  v_mfma_f32_16x16x32_bf16 v[88:91], a[44:47], a[96:99], v[88:91]
  buffer_load_dwordx4 v192, s[44:47], s82 offen lds
  v_mfma_f32_16x16x32_bf16 v[96:99], a[48:51], a[96:99], v[96:99]
  s_add_u32 s77, s24, 49152
  v_mfma_f32_16x16x32_bf16 v[104:107], a[52:55], a[96:99], v[104:107]
  v_xor_b32 v206, s77, v205
  v_mfma_f32_16x16x32_bf16 v[112:115], a[56:59], a[96:99], v[112:115]
  buffer_load_dwordx4 v193, s[44:47], s82 offen offset:1024 lds
  v_mfma_f32_16x16x32_bf16 v[120:123], a[60:63], a[96:99], v[120:123]
  ds_read_b128 a[64:67], v206
  v_mfma_f32_16x16x32_bf16 v[68:71], a[32:35], a[100:103], v[68:71]
  ds_read_b128 a[68:71], v206 offset:2048
  v_mfma_f32_16x16x32_bf16 v[76:79], a[36:39], a[100:103], v[76:79]
  buffer_load_dwordx4 v194, s[44:47], s82 offen offset:2048 lds
  v_mfma_f32_16x16x32_bf16 v[84:87], a[40:43], a[100:103], v[84:87]
  ds_read_b128 a[72:75], v206 offset:4096
  v_mfma_f32_16x16x32_bf16 v[92:95], a[44:47], a[100:103], v[92:95]
  buffer_load_dwordx4 v195, s[44:47], s82 offen offset:3072 lds
  v_mfma_f32_16x16x32_bf16 v[100:103], a[48:51], a[100:103], v[100:103]
  s_waitcnt vmcnt(11)
  ds_read_b64_tr_b16 a[0:1], v212
  ds_read_b128 a[76:79], v206 offset:6144
  v_mfma_f32_16x16x32_bf16 v[108:111], a[52:55], a[100:103], v[108:111]
  ds_read_b64_tr_b16 a[2:3], v212 offset:1024
  v_mfma_f32_16x16x32_bf16 v[116:119], a[56:59], a[100:103], v[116:119]
  ds_read_b128 a[80:83], v206 offset:8192
  ds_read_b64_tr_b16 a[4:5], v213
  v_mfma_f32_16x16x32_bf16 v[124:127], a[60:63], a[100:103], v[124:127]
  ds_read_b64_tr_b16 a[6:7], v213 offset:1024
  v_mfma_f32_16x16x32_bf16 v[128:131], a[32:35], a[104:107], v[128:131]
  ds_read_b128 a[84:87], v206 offset:10240
  ds_read_b64_tr_b16 a[8:9], v214
  v_mfma_f32_16x16x32_bf16 v[136:139], a[36:39], a[104:107], v[136:139]
  ds_read_b64_tr_b16 a[10:11], v214 offset:1024
  v_mfma_f32_16x16x32_bf16 v[144:147], a[40:43], a[104:107], v[144:147]
  ds_read_b64_tr_b16 a[12:13], v215
  v_mfma_f32_16x16x32_bf16 v[152:155], a[44:47], a[104:107], v[152:155]
  ds_read_b64_tr_b16 a[14:15], v215 offset:1024
  v_mfma_f32_16x16x32_bf16 v[160:163], a[48:51], a[104:107], v[160:163]
  v_mfma_f32_16x16x32_bf16 v[168:171], a[52:55], a[104:107], v[168:171]
  ds_read_b64_tr_b16 a[16:17], v216
  v_mfma_f32_16x16x32_bf16 v[176:179], a[56:59], a[104:107], v[176:179]
  ds_read_b64_tr_b16 a[18:19], v216 offset:1024
  v_mfma_f32_16x16x32_bf16 v[184:187], a[60:63], a[104:107], v[184:187]
  ds_read_b64_tr_b16 a[20:21], v217
  v_mfma_f32_16x16x32_bf16 v[132:135], a[32:35], a[108:111], v[132:135]
  ds_read_b64_tr_b16 a[22:23], v217 offset:1024
  v_mfma_f32_16x16x32_bf16 v[140:143], a[36:39], a[108:111], v[140:143]
  ds_read_b64_tr_b16 a[24:25], v218
  v_mfma_f32_16x16x32_bf16 v[148:151], a[40:43], a[108:111], v[148:151]
  ds_read_b64_tr_b16 a[26:27], v218 offset:1024
  v_mfma_f32_16x16x32_bf16 v[156:159], a[44:47], a[108:111], v[156:159]
  ds_read_b64_tr_b16 a[28:29], v219
  v_mfma_f32_16x16x32_bf16 v[164:167], a[48:51], a[108:111], v[164:167]
  ds_read_b64_tr_b16 a[30:31], v219 offset:1024
  v_mfma_f32_16x16x32_bf16 v[172:175], a[52:55], a[108:111], v[172:175]
  v_mfma_f32_16x16x32_bf16 v[180:183], a[56:59], a[108:111], v[180:183]
  v_mfma_f32_16x16x32_bf16 v[188:191], a[60:63], a[108:111], v[188:191]
  s_waitcnt lgkmcnt(15)
  v_mfma_f32_16x16x32_bf16 v[0:3], a[0:3], a[64:67], v[0:3]
  s_add_u32 s22, s22, 4
  s_and_b32 s22, s22, 15
  s_waitcnt lgkmcnt(13)
  v_mfma_f32_16x16x32_bf16 v[8:11], a[4:7], a[64:67], v[8:11]
  s_lshl_b32 s82, s22, 18
  s_waitcnt lgkmcnt(10)
  v_mfma_f32_16x16x32_bf16 v[16:19], a[8:11], a[64:67], v[16:19]
  s_add_u32 m0, s74, 0
  s_waitcnt lgkmcnt(8)
  v_mfma_f32_16x16x32_bf16 v[24:27], a[12:15], a[64:67], v[24:27]
  s_waitcnt lgkmcnt(0)
  buffer_load_dwordx4 v192, s[44:47], s82 offen lds
  v_mfma_f32_16x16x32_bf16 v[32:35], a[16:19], a[64:67], v[32:35]
  v_mfma_f32_16x16x32_bf16 v[40:43], a[20:23], a[64:67], v[40:43]
  v_mfma_f32_16x16x32_bf16 v[48:51], a[24:27], a[64:67], v[48:51]
  buffer_load_dwordx4 v193, s[44:47], s82 offen offset:1024 lds
  v_mfma_f32_16x16x32_bf16 v[56:59], a[28:31], a[64:67], v[56:59]
  v_mfma_f32_16x16x32_bf16 v[4:7], a[0:3], a[68:71], v[4:7]
  s_add_u32 s77, s25, 49152
  v_mfma_f32_16x16x32_bf16 v[12:15], a[4:7], a[68:71], v[12:15]
  v_xor_b32 v206, s77, v205
  v_mfma_f32_16x16x32_bf16 v[20:23], a[8:11], a[68:71], v[20:23]
  buffer_load_dwordx4 v194, s[44:47], s82 offen offset:2048 lds
  v_mfma_f32_16x16x32_bf16 v[28:31], a[12:15], a[68:71], v[28:31]
  ds_read_b128 a[88:91], v206
  v_mfma_f32_16x16x32_bf16 v[36:39], a[16:19], a[68:71], v[36:39]
  ds_read_b128 a[92:95], v206 offset:2048
  v_mfma_f32_16x16x32_bf16 v[44:47], a[20:23], a[68:71], v[44:47]
  buffer_load_dwordx4 v195, s[44:47], s82 offen offset:3072 lds
  v_mfma_f32_16x16x32_bf16 v[52:55], a[24:27], a[68:71], v[52:55]
  ds_read_b128 a[96:99], v206 offset:4096
  v_mfma_f32_16x16x32_bf16 v[60:63], a[28:31], a[68:71], v[60:63]
  v_mfma_f32_16x16x32_bf16 v[64:67], a[0:3], a[72:75], v[64:67]
  ds_read_b128 a[100:103], v206 offset:6144
  s_or_b32 s82, s82, 131072
  v_mfma_f32_16x16x32_bf16 v[72:75], a[4:7], a[72:75], v[72:75]
  s_add_u32 m0, s74, 4096
  v_mfma_f32_16x16x32_bf16 v[80:83], a[8:11], a[72:75], v[80:83]
  ds_read_b128 a[104:107], v206 offset:8192
  v_mfma_f32_16x16x32_bf16 v[88:91], a[12:15], a[72:75], v[88:91]
  buffer_load_dwordx4 v192, s[44:47], s82 offen lds
  v_mfma_f32_16x16x32_bf16 v[96:99], a[16:19], a[72:75], v[96:99]
  ds_read_b128 a[108:111], v206 offset:10240
  v_mfma_f32_16x16x32_bf16 v[104:107], a[20:23], a[72:75], v[104:107]
  buffer_load_dwordx4 v193, s[44:47], s82 offen offset:1024 lds
  v_mfma_f32_16x16x32_bf16 v[112:115], a[24:27], a[72:75], v[112:115]
  v_mfma_f32_16x16x32_bf16 v[120:123], a[28:31], a[72:75], v[120:123]
  v_mfma_f32_16x16x32_bf16 v[68:71], a[0:3], a[76:79], v[68:71]
  buffer_load_dwordx4 v194, s[44:47], s82 offen offset:2048 lds
  v_mfma_f32_16x16x32_bf16 v[76:79], a[4:7], a[76:79], v[76:79]
  v_mfma_f32_16x16x32_bf16 v[84:87], a[8:11], a[76:79], v[84:87]
  v_mfma_f32_16x16x32_bf16 v[92:95], a[12:15], a[76:79], v[92:95]
  buffer_load_dwordx4 v195, s[44:47], s82 offen offset:3072 lds
  v_mfma_f32_16x16x32_bf16 v[100:103], a[16:19], a[76:79], v[100:103]
  s_waitcnt vmcnt(8)
  ds_read_b64_tr_b16 a[32:33], v212 offset:8192
  v_mfma_f32_16x16x32_bf16 v[108:111], a[20:23], a[76:79], v[108:111]
  ds_read_b64_tr_b16 a[34:35], v212 offset:9216
  v_mfma_f32_16x16x32_bf16 v[116:119], a[24:27], a[76:79], v[116:119]
  ds_read_b64_tr_b16 a[36:37], v213 offset:8192
  v_mfma_f32_16x16x32_bf16 v[124:127], a[28:31], a[76:79], v[124:127]
  s_mov_b32 s84, 24576
  ds_read_b64_tr_b16 a[38:39], v213 offset:9216
  v_mfma_f32_16x16x32_bf16 v[128:131], a[0:3], a[80:83], v[128:131]
  s_mul_i32 s80, s68, 6144
  s_add_u32 m0, s80, 24576
  v_mfma_f32_16x16x32_bf16 v[136:139], a[4:7], a[80:83], v[136:139]
  ds_read_b64_tr_b16 a[40:41], v214 offset:8192
  ds_read_b64_tr_b16 a[42:43], v214 offset:9216
  v_mfma_f32_16x16x32_bf16 v[144:147], a[8:11], a[80:83], v[144:147]
  buffer_load_dwordx4 v199, s[36:39], s84 offen nt lds
  v_mfma_f32_16x16x32_bf16 v[152:155], a[12:15], a[80:83], v[152:155]
  ds_read_b64_tr_b16 a[44:45], v215 offset:8192
  ds_read_b64_tr_b16 a[46:47], v215 offset:9216
  v_mfma_f32_16x16x32_bf16 v[160:163], a[16:19], a[80:83], v[160:163]
  buffer_load_dwordx4 v200, s[36:39], s84 offen offset:1024 nt lds
  v_mfma_f32_16x16x32_bf16 v[168:171], a[20:23], a[80:83], v[168:171]
  ds_read_b64_tr_b16 a[48:49], v216 offset:8192
  v_mfma_f32_16x16x32_bf16 v[176:179], a[24:27], a[80:83], v[176:179]
  buffer_load_dwordx4 v201, s[36:39], s84 offen offset:2048 nt lds
  v_mfma_f32_16x16x32_bf16 v[184:187], a[28:31], a[80:83], v[184:187]
  ds_read_b64_tr_b16 a[50:51], v216 offset:9216
  ds_read_b64_tr_b16 a[52:53], v217 offset:8192
  v_mfma_f32_16x16x32_bf16 v[132:135], a[0:3], a[84:87], v[132:135]
  buffer_load_dwordx4 v202, s[36:39], s84 offen offset:3072 nt lds
  v_mfma_f32_16x16x32_bf16 v[140:143], a[4:7], a[84:87], v[140:143]
  ds_read_b64_tr_b16 a[54:55], v217 offset:9216
  ds_read_b64_tr_b16 a[56:57], v218 offset:8192
  v_mfma_f32_16x16x32_bf16 v[148:151], a[8:11], a[84:87], v[148:151]
  s_add_u32 m0, s80, 28672
  ds_read_b64_tr_b16 a[58:59], v218 offset:9216
  v_mfma_f32_16x16x32_bf16 v[156:159], a[12:15], a[84:87], v[156:159]
  buffer_load_dwordx4 v203, s[36:39], s84 offen nt lds
  v_mfma_f32_16x16x32_bf16 v[164:167], a[16:19], a[84:87], v[164:167]
  ds_read_b64_tr_b16 a[60:61], v219 offset:8192
  ds_read_b64_tr_b16 a[62:63], v219 offset:9216
  v_mfma_f32_16x16x32_bf16 v[172:175], a[20:23], a[84:87], v[172:175]
  buffer_load_dwordx4 v204, s[36:39], s84 offen offset:1024 nt lds
  v_mfma_f32_16x16x32_bf16 v[180:183], a[24:27], a[84:87], v[180:183]
  v_mfma_f32_16x16x32_bf16 v[188:191], a[28:31], a[84:87], v[188:191]
  s_waitcnt lgkmcnt(14)
  v_mfma_f32_16x16x32_bf16 v[0:3], a[32:35], a[88:91], v[0:3]
  s_add_u32 s23, s23, 4
  s_and_b32 s23, s23, 15
  s_waitcnt lgkmcnt(12)
  v_mfma_f32_16x16x32_bf16 v[8:11], a[36:39], a[88:91], v[8:11]
  s_lshl_b32 s82, s23, 18
  s_waitcnt lgkmcnt(10)
  v_mfma_f32_16x16x32_bf16 v[16:19], a[40:43], a[88:91], v[16:19]
  s_add_u32 m0, s74, 8192
  s_waitcnt lgkmcnt(8)
  v_mfma_f32_16x16x32_bf16 v[24:27], a[44:47], a[88:91], v[24:27]
  s_waitcnt lgkmcnt(0)
  buffer_load_dwordx4 v192, s[44:47], s82 offen lds
  v_mfma_f32_16x16x32_bf16 v[32:35], a[48:51], a[88:91], v[32:35]
  v_mfma_f32_16x16x32_bf16 v[40:43], a[52:55], a[88:91], v[40:43]
  v_mfma_f32_16x16x32_bf16 v[48:51], a[56:59], a[88:91], v[48:51]
  buffer_load_dwordx4 v193, s[44:47], s82 offen offset:1024 lds
  v_mfma_f32_16x16x32_bf16 v[56:59], a[60:63], a[88:91], v[56:59]
  v_mfma_f32_16x16x32_bf16 v[4:7], a[32:35], a[92:95], v[4:7]
  v_mfma_f32_16x16x32_bf16 v[12:15], a[36:39], a[92:95], v[12:15]
  v_mfma_f32_16x16x32_bf16 v[20:23], a[40:43], a[92:95], v[20:23]
  buffer_load_dwordx4 v194, s[44:47], s82 offen offset:2048 lds
  v_mfma_f32_16x16x32_bf16 v[28:31], a[44:47], a[92:95], v[28:31]
  v_mfma_f32_16x16x32_bf16 v[36:39], a[48:51], a[92:95], v[36:39]
  v_mfma_f32_16x16x32_bf16 v[44:47], a[52:55], a[92:95], v[44:47]
  buffer_load_dwordx4 v195, s[44:47], s82 offen offset:3072 lds
  v_mfma_f32_16x16x32_bf16 v[52:55], a[56:59], a[92:95], v[52:55]
  v_mfma_f32_16x16x32_bf16 v[60:63], a[60:63], a[92:95], v[60:63]
  v_mfma_f32_16x16x32_bf16 v[64:67], a[32:35], a[96:99], v[64:67]
  s_or_b32 s82, s82, 131072
  v_mfma_f32_16x16x32_bf16 v[72:75], a[36:39], a[96:99], v[72:75]
  s_add_u32 m0, s74, 12288
  v_mfma_f32_16x16x32_bf16 v[80:83], a[40:43], a[96:99], v[80:83]
  s_barrier
  s_add_u32 s77, s26, 49152
  v_mfma_f32_16x16x32_bf16 v[88:91], a[44:47], a[96:99], v[88:91]
  buffer_load_dwordx4 v192, s[44:47], s82 offen lds
  v_mfma_f32_16x16x32_bf16 v[96:99], a[48:51], a[96:99], v[96:99]
  v_xor_b32 v206, s77, v205
  ds_read_b128 a[64:67], v206
  v_mfma_f32_16x16x32_bf16 v[104:107], a[52:55], a[96:99], v[104:107]
  buffer_load_dwordx4 v193, s[44:47], s82 offen offset:1024 lds
  v_mfma_f32_16x16x32_bf16 v[112:115], a[56:59], a[96:99], v[112:115]
  ds_read_b128 a[68:71], v206 offset:2048
  v_mfma_f32_16x16x32_bf16 v[120:123], a[60:63], a[96:99], v[120:123]
  ds_read_b128 a[72:75], v206 offset:4096
  v_mfma_f32_16x16x32_bf16 v[68:71], a[32:35], a[100:103], v[68:71]
  ds_read_b128 a[76:79], v206 offset:6144
  v_mfma_f32_16x16x32_bf16 v[76:79], a[36:39], a[100:103], v[76:79]
  buffer_load_dwordx4 v194, s[44:47], s82 offen offset:2048 lds
  v_mfma_f32_16x16x32_bf16 v[84:87], a[40:43], a[100:103], v[84:87]
  ds_read_b128 a[80:83], v206 offset:8192
  ds_read_b128 a[84:87], v206 offset:10240
  v_mfma_f32_16x16x32_bf16 v[92:95], a[44:47], a[100:103], v[92:95]
  s_add_u32 s77, s24, 73728
  v_mfma_f32_16x16x32_bf16 v[100:103], a[48:51], a[100:103], v[100:103]
  s_waitcnt vmcnt(13)
  ds_read_b64_tr_b16 a[0:1], v212
  v_xor_b32 v206, s77, v205
  v_mfma_f32_16x16x32_bf16 v[108:111], a[52:55], a[100:103], v[108:111]
  buffer_load_dwordx4 v195, s[44:47], s82 offen offset:3072 lds
  v_mfma_f32_16x16x32_bf16 v[116:119], a[56:59], a[100:103], v[116:119]
  ds_read_b64_tr_b16 a[2:3], v212 offset:1024
  ds_read_b128 a[112:115], v206
  v_mfma_f32_16x16x32_bf16 v[124:127], a[60:63], a[100:103], v[124:127]
  ds_read_b64_tr_b16 a[4:5], v213
  ds_read_b128 a[116:119], v206 offset:2048
  v_mfma_f32_16x16x32_bf16 v[128:131], a[32:35], a[104:107], v[128:131]
  ds_read_b64_tr_b16 a[6:7], v213 offset:1024
  ds_read_b128 a[120:123], v206 offset:4096
  v_mfma_f32_16x16x32_bf16 v[136:139], a[36:39], a[104:107], v[136:139]
  ds_read_b64_tr_b16 a[8:9], v214
  ds_read_b128 a[124:127], v206 offset:6144
  v_mfma_f32_16x16x32_bf16 v[144:147], a[40:43], a[104:107], v[144:147]
  ds_read_b64_tr_b16 a[10:11], v214 offset:1024
  ds_read_b128 a[128:131], v206 offset:8192
  v_mfma_f32_16x16x32_bf16 v[152:155], a[44:47], a[104:107], v[152:155]
  ds_read_b64_tr_b16 a[12:13], v215
  ds_read_b128 a[132:135], v206 offset:10240
  v_mfma_f32_16x16x32_bf16 v[160:163], a[48:51], a[104:107], v[160:163]
  ds_read_b64_tr_b16 a[14:15], v215 offset:1024
  s_add_u32 s77, s25, 73728
  v_mfma_f32_16x16x32_bf16 v[168:171], a[52:55], a[104:107], v[168:171]
  ds_read_b64_tr_b16 a[16:17], v216
  v_xor_b32 v206, s77, v205
  v_mfma_f32_16x16x32_bf16 v[176:179], a[56:59], a[104:107], v[176:179]
  ds_read_b64_tr_b16 a[18:19], v216 offset:1024
  ds_read_b128 a[136:139], v206
  v_mfma_f32_16x16x32_bf16 v[184:187], a[60:63], a[104:107], v[184:187]
  ds_read_b64_tr_b16 a[20:21], v217
  ds_read_b128 a[140:143], v206 offset:2048
  v_mfma_f32_16x16x32_bf16 v[132:135], a[32:35], a[108:111], v[132:135]
  ds_read_b64_tr_b16 a[22:23], v217 offset:1024
  ds_read_b128 a[144:147], v206 offset:4096
  v_mfma_f32_16x16x32_bf16 v[140:143], a[36:39], a[108:111], v[140:143]
  ds_read_b64_tr_b16 a[24:25], v218
  ds_read_b128 a[148:151], v206 offset:6144
  v_mfma_f32_16x16x32_bf16 v[148:151], a[40:43], a[108:111], v[148:151]
  ds_read_b64_tr_b16 a[26:27], v218 offset:1024
  ds_read_b128 a[152:155], v206 offset:8192
  v_mfma_f32_16x16x32_bf16 v[156:159], a[44:47], a[108:111], v[156:159]
  ds_read_b64_tr_b16 a[28:29], v219
  ds_read_b128 a[156:159], v206 offset:10240
  v_mfma_f32_16x16x32_bf16 v[164:167], a[48:51], a[108:111], v[164:167]
  ds_read_b64_tr_b16 a[30:31], v219 offset:1024
  v_mfma_f32_16x16x32_bf16 v[172:175], a[52:55], a[108:111], v[172:175]
  v_mfma_f32_16x16x32_bf16 v[180:183], a[56:59], a[108:111], v[180:183]
  v_mfma_f32_16x16x32_bf16 v[188:191], a[60:63], a[108:111], v[188:191]
  s_waitcnt lgkmcnt(15)
  v_mfma_f32_16x16x32_bf16 v[0:3], a[0:3], a[64:67], v[0:3]
  s_add_u32 s20, s20, 4
  s_and_b32 s20, s20, 15
  v_mfma_f32_16x16x32_bf16 v[8:11], a[4:7], a[64:67], v[8:11]
  s_lshl_b32 s82, s20, 18
  v_mfma_f32_16x16x32_bf16 v[16:19], a[8:11], a[64:67], v[16:19]
  s_add_u32 m0, s74, 0
  s_waitcnt lgkmcnt(14)
  v_mfma_f32_16x16x32_bf16 v[24:27], a[12:15], a[64:67], v[24:27]
  s_waitcnt lgkmcnt(0)
  buffer_load_dwordx4 v192, s[44:47], s82 offen lds
  v_mfma_f32_16x16x32_bf16 v[32:35], a[16:19], a[64:67], v[32:35]
  v_mfma_f32_16x16x32_bf16 v[40:43], a[20:23], a[64:67], v[40:43]
  v_mfma_f32_16x16x32_bf16 v[48:51], a[24:27], a[64:67], v[48:51]
  buffer_load_dwordx4 v193, s[44:47], s82 offen offset:1024 lds
  v_mfma_f32_16x16x32_bf16 v[56:59], a[28:31], a[64:67], v[56:59]
  v_mfma_f32_16x16x32_bf16 v[4:7], a[0:3], a[68:71], v[4:7]
  s_add_u32 s77, s27, 49152
  v_xor_b32 v206, s77, v205
  v_mfma_f32_16x16x32_bf16 v[12:15], a[4:7], a[68:71], v[12:15]
  ds_read_b128 a[88:91], v206
  v_mfma_f32_16x16x32_bf16 v[20:23], a[8:11], a[68:71], v[20:23]
  buffer_load_dwordx4 v194, s[44:47], s82 offen offset:2048 lds
  v_mfma_f32_16x16x32_bf16 v[28:31], a[12:15], a[68:71], v[28:31]
  ds_read_b128 a[92:95], v206 offset:2048
  v_mfma_f32_16x16x32_bf16 v[36:39], a[16:19], a[68:71], v[36:39]
  ds_read_b128 a[96:99], v206 offset:4096
  v_mfma_f32_16x16x32_bf16 v[44:47], a[20:23], a[68:71], v[44:47]
  ds_read_b128 a[100:103], v206 offset:6144
  v_mfma_f32_16x16x32_bf16 v[52:55], a[24:27], a[68:71], v[52:55]
  buffer_load_dwordx4 v195, s[44:47], s82 offen offset:3072 lds
  v_mfma_f32_16x16x32_bf16 v[60:63], a[28:31], a[68:71], v[60:63]
  ds_read_b128 a[104:107], v206 offset:8192
  ds_read_b128 a[108:111], v206 offset:10240
  v_mfma_f32_16x16x32_bf16 v[64:67], a[0:3], a[72:75], v[64:67]
  s_or_b32 s82, s82, 131072
  s_add_u32 s77, s26, 73728
  v_mfma_f32_16x16x32_bf16 v[72:75], a[4:7], a[72:75], v[72:75]
  s_add_u32 m0, s74, 4096
  v_xor_b32 v206, s77, v205
  v_mfma_f32_16x16x32_bf16 v[80:83], a[8:11], a[72:75], v[80:83]
  buffer_load_dwordx4 v192, s[44:47], s82 offen lds
  v_mfma_f32_16x16x32_bf16 v[88:91], a[12:15], a[72:75], v[88:91]
  ds_read_b128 a[160:163], v206
  ds_read_b128 a[164:167], v206 offset:2048
  v_mfma_f32_16x16x32_bf16 v[96:99], a[16:19], a[72:75], v[96:99]
  ds_read_b128 a[168:171], v206 offset:4096
  v_mfma_f32_16x16x32_bf16 v[104:107], a[20:23], a[72:75], v[104:107]
  buffer_load_dwordx4 v193, s[44:47], s82 offen offset:1024 lds
  v_mfma_f32_16x16x32_bf16 v[112:115], a[24:27], a[72:75], v[112:115]
  ds_read_b128 a[172:175], v206 offset:6144
  v_mfma_f32_16x16x32_bf16 v[120:123], a[28:31], a[72:75], v[120:123]
  ds_read_b128 a[176:179], v206 offset:8192
  v_mfma_f32_16x16x32_bf16 v[68:71], a[0:3], a[76:79], v[68:71]
  ds_read_b128 a[180:183], v206 offset:10240
  v_mfma_f32_16x16x32_bf16 v[76:79], a[4:7], a[76:79], v[76:79]
  buffer_load_dwordx4 v194, s[44:47], s82 offen offset:2048 lds
  v_mfma_f32_16x16x32_bf16 v[84:87], a[8:11], a[76:79], v[84:87]
  s_add_u32 s77, s27, 73728
  v_xor_b32 v206, s77, v205
  v_mfma_f32_16x16x32_bf16 v[92:95], a[12:15], a[76:79], v[92:95]
  ds_read_b128 a[184:187], v206
  v_mfma_f32_16x16x32_bf16 v[100:103], a[16:19], a[76:79], v[100:103]
  s_waitcnt vmcnt(7)
  ds_read_b64_tr_b16 a[32:33], v212 offset:8192
  ds_read_b128 a[188:191], v206 offset:2048
  v_mfma_f32_16x16x32_bf16 v[108:111], a[20:23], a[76:79], v[108:111]
  buffer_load_dwordx4 v195, s[44:47], s82 offen offset:3072 lds
  v_mfma_f32_16x16x32_bf16 v[116:119], a[24:27], a[76:79], v[116:119]
  ds_read_b64_tr_b16 a[34:35], v212 offset:9216
  ds_read_b128 a[192:195], v206 offset:4096
  v_mfma_f32_16x16x32_bf16 v[124:127], a[28:31], a[76:79], v[124:127]
  ds_read_b64_tr_b16 a[36:37], v213 offset:8192
  ds_read_b128 a[196:199], v206 offset:6144
  v_mfma_f32_16x16x32_bf16 v[128:131], a[0:3], a[80:83], v[128:131]
  ds_read_b64_tr_b16 a[38:39], v213 offset:9216
  ds_read_b128 a[200:203], v206 offset:8192
  v_mfma_f32_16x16x32_bf16 v[136:139], a[4:7], a[80:83], v[136:139]
  ds_read_b64_tr_b16 a[40:41], v214 offset:8192
  ds_read_b128 a[204:207], v206 offset:10240
  v_mfma_f32_16x16x32_bf16 v[144:147], a[8:11], a[80:83], v[144:147]
  ds_read_b64_tr_b16 a[42:43], v214 offset:9216
  ds_read_b64_tr_b16 a[44:45], v215 offset:8192
  v_mfma_f32_16x16x32_bf16 v[152:155], a[12:15], a[80:83], v[152:155]
  ds_read_b64_tr_b16 a[46:47], v215 offset:9216
  v_mfma_f32_16x16x32_bf16 v[160:163], a[16:19], a[80:83], v[160:163]
  v_mfma_f32_16x16x32_bf16 v[168:171], a[20:23], a[80:83], v[168:171]
  ds_read_b64_tr_b16 a[48:49], v216 offset:8192
  v_mfma_f32_16x16x32_bf16 v[176:179], a[24:27], a[80:83], v[176:179]
  ds_read_b64_tr_b16 a[50:51], v216 offset:9216
  v_mfma_f32_16x16x32_bf16 v[184:187], a[28:31], a[80:83], v[184:187]
  ds_read_b64_tr_b16 a[52:53], v217 offset:8192
  v_mfma_f32_16x16x32_bf16 v[132:135], a[0:3], a[84:87], v[132:135]
  ds_read_b64_tr_b16 a[54:55], v217 offset:9216
  v_mfma_f32_16x16x32_bf16 v[140:143], a[4:7], a[84:87], v[140:143]
  ds_read_b64_tr_b16 a[56:57], v218 offset:8192
  v_mfma_f32_16x16x32_bf16 v[148:151], a[8:11], a[84:87], v[148:151]
  ds_read_b64_tr_b16 a[58:59], v218 offset:9216
  v_mfma_f32_16x16x32_bf16 v[156:159], a[12:15], a[84:87], v[156:159]
  ds_read_b64_tr_b16 a[60:61], v219 offset:8192
  v_mfma_f32_16x16x32_bf16 v[164:167], a[16:19], a[84:87], v[164:167]
  ds_read_b64_tr_b16 a[62:63], v219 offset:9216
  v_mfma_f32_16x16x32_bf16 v[172:175], a[20:23], a[84:87], v[172:175]
  v_mfma_f32_16x16x32_bf16 v[180:183], a[24:27], a[84:87], v[180:183]
  v_mfma_f32_16x16x32_bf16 v[188:191], a[28:31], a[84:87], v[188:191]
  s_waitcnt lgkmcnt(15)
  v_mfma_f32_16x16x32_bf16 v[0:3], a[32:35], a[88:91], v[0:3]
  s_add_u32 s21, s21, 4
  s_and_b32 s21, s21, 15
  s_waitcnt lgkmcnt(14)
  v_mfma_f32_16x16x32_bf16 v[8:11], a[36:39], a[88:91], v[8:11]
  s_lshl_b32 s82, s21, 18
  s_waitcnt lgkmcnt(10)
  v_mfma_f32_16x16x32_bf16 v[16:19], a[40:43], a[88:91], v[16:19]
  s_add_u32 m0, s74, 8192
  s_waitcnt lgkmcnt(8)
  v_mfma_f32_16x16x32_bf16 v[24:27], a[44:47], a[88:91], v[24:27]
  s_waitcnt lgkmcnt(0)
  buffer_load_dwordx4 v192, s[44:47], s82 offen lds
  v_mfma_f32_16x16x32_bf16 v[32:35], a[48:51], a[88:91], v[32:35]
  v_mfma_f32_16x16x32_bf16 v[40:43], a[52:55], a[88:91], v[40:43]
  v_mfma_f32_16x16x32_bf16 v[48:51], a[56:59], a[88:91], v[48:51]
  buffer_load_dwordx4 v193, s[44:47], s82 offen offset:1024 lds
  v_mfma_f32_16x16x32_bf16 v[56:59], a[60:63], a[88:91], v[56:59]
  v_mfma_f32_16x16x32_bf16 v[4:7], a[32:35], a[92:95], v[4:7]
  v_mfma_f32_16x16x32_bf16 v[12:15], a[36:39], a[92:95], v[12:15]
  v_mfma_f32_16x16x32_bf16 v[20:23], a[40:43], a[92:95], v[20:23]
  buffer_load_dwordx4 v194, s[44:47], s82 offen offset:2048 lds
  v_mfma_f32_16x16x32_bf16 v[28:31], a[44:47], a[92:95], v[28:31]
  v_mfma_f32_16x16x32_bf16 v[36:39], a[48:51], a[92:95], v[36:39]
  v_mfma_f32_16x16x32_bf16 v[44:47], a[52:55], a[92:95], v[44:47]
  buffer_load_dwordx4 v195, s[44:47], s82 offen offset:3072 lds
  v_mfma_f32_16x16x32_bf16 v[52:55], a[56:59], a[92:95], v[52:55]
  v_mfma_f32_16x16x32_bf16 v[60:63], a[60:63], a[92:95], v[60:63]
  v_mfma_f32_16x16x32_bf16 v[64:67], a[32:35], a[96:99], v[64:67]
  s_or_b32 s82, s82, 131072
  v_mfma_f32_16x16x32_bf16 v[72:75], a[36:39], a[96:99], v[72:75]
  s_add_u32 m0, s74, 12288
  v_mfma_f32_16x16x32_bf16 v[80:83], a[40:43], a[96:99], v[80:83]
  s_barrier
  v_mfma_f32_16x16x32_bf16 v[88:91], a[44:47], a[96:99], v[88:91]
  buffer_load_dwordx4 v192, s[44:47], s82 offen lds
  v_mfma_f32_16x16x32_bf16 v[96:99], a[48:51], a[96:99], v[96:99]
  v_mfma_f32_16x16x32_bf16 v[104:107], a[52:55], a[96:99], v[104:107]
  buffer_load_dwordx4 v193, s[44:47], s82 offen offset:1024 lds
  v_mfma_f32_16x16x32_bf16 v[112:115], a[56:59], a[96:99], v[112:115]
  v_mfma_f32_16x16x32_bf16 v[120:123], a[60:63], a[96:99], v[120:123]
  v_mfma_f32_16x16x32_bf16 v[68:71], a[32:35], a[100:103], v[68:71]
  buffer_load_dwordx4 v194, s[44:47], s82 offen offset:2048 lds
  v_mfma_f32_16x16x32_bf16 v[76:79], a[36:39], a[100:103], v[76:79]
  v_mfma_f32_16x16x32_bf16 v[84:87], a[40:43], a[100:103], v[84:87]
  v_mfma_f32_16x16x32_bf16 v[92:95], a[44:47], a[100:103], v[92:95]
  buffer_load_dwordx4 v195, s[44:47], s82 offen offset:3072 lds
  v_mfma_f32_16x16x32_bf16 v[100:103], a[48:51], a[100:103], v[100:103]
  s_waitcnt vmcnt(8)
  ds_read_b64_tr_b16 a[0:1], v212
  v_mfma_f32_16x16x32_bf16 v[108:111], a[52:55], a[100:103], v[108:111]
  ds_read_b64_tr_b16 a[2:3], v212 offset:1024
  v_mfma_f32_16x16x32_bf16 v[116:119], a[56:59], a[100:103], v[116:119]
  ds_read_b64_tr_b16 a[4:5], v213
  v_mfma_f32_16x16x32_bf16 v[124:127], a[60:63], a[100:103], v[124:127]
  s_mov_b32 s84, 49152
  ds_read_b64_tr_b16 a[6:7], v213 offset:1024
  v_mfma_f32_16x16x32_bf16 v[128:131], a[32:35], a[104:107], v[128:131]
  s_mul_i32 s80, s68, 6144
  s_add_u32 m0, s80, 49152
  v_mfma_f32_16x16x32_bf16 v[136:139], a[36:39], a[104:107], v[136:139]
  ds_read_b64_tr_b16 a[8:9], v214
  ds_read_b64_tr_b16 a[10:11], v214 offset:1024
  v_mfma_f32_16x16x32_bf16 v[144:147], a[40:43], a[104:107], v[144:147]
  buffer_load_dwordx4 v199, s[36:39], s84 offen nt lds
  v_mfma_f32_16x16x32_bf16 v[152:155], a[44:47], a[104:107], v[152:155]
  ds_read_b64_tr_b16 a[12:13], v215
  ds_read_b64_tr_b16 a[14:15], v215 offset:1024
  v_mfma_f32_16x16x32_bf16 v[160:163], a[48:51], a[104:107], v[160:163]
  buffer_load_dwordx4 v200, s[36:39], s84 offen offset:1024 nt lds
  v_mfma_f32_16x16x32_bf16 v[168:171], a[52:55], a[104:107], v[168:171]
  ds_read_b64_tr_b16 a[16:17], v216
  v_mfma_f32_16x16x32_bf16 v[176:179], a[56:59], a[104:107], v[176:179]
  buffer_load_dwordx4 v201, s[36:39], s84 offen offset:2048 nt lds
  v_mfma_f32_16x16x32_bf16 v[184:187], a[60:63], a[104:107], v[184:187]
  ds_read_b64_tr_b16 a[18:19], v216 offset:1024
  ds_read_b64_tr_b16 a[20:21], v217
  v_mfma_f32_16x16x32_bf16 v[132:135], a[32:35], a[108:111], v[132:135]
  buffer_load_dwordx4 v202, s[36:39], s84 offen offset:3072 nt lds
  v_mfma_f32_16x16x32_bf16 v[140:143], a[36:39], a[108:111], v[140:143]
  ds_read_b64_tr_b16 a[22:23], v217 offset:1024
  ds_read_b64_tr_b16 a[24:25], v218
  v_mfma_f32_16x16x32_bf16 v[148:151], a[40:43], a[108:111], v[148:151]
  s_add_u32 m0, s80, 53248
  ds_read_b64_tr_b16 a[26:27], v218 offset:1024
  v_mfma_f32_16x16x32_bf16 v[156:159], a[44:47], a[108:111], v[156:159]
  buffer_load_dwordx4 v203, s[36:39], s84 offen nt lds
  v_mfma_f32_16x16x32_bf16 v[164:167], a[48:51], a[108:111], v[164:167]
  ds_read_b64_tr_b16 a[28:29], v219
  ds_read_b64_tr_b16 a[30:31], v219 offset:1024
  v_mfma_f32_16x16x32_bf16 v[172:175], a[52:55], a[108:111], v[172:175]
  buffer_load_dwordx4 v204, s[36:39], s84 offen offset:1024 nt lds
  v_mfma_f32_16x16x32_bf16 v[180:183], a[56:59], a[108:111], v[180:183]
  v_mfma_f32_16x16x32_bf16 v[188:191], a[60:63], a[108:111], v[188:191]
  s_waitcnt lgkmcnt(14)
  v_mfma_f32_16x16x32_bf16 v[0:3], a[0:3], a[112:115], v[0:3]
  s_add_u32 s22, s22, 4
  s_and_b32 s22, s22, 15
  s_waitcnt lgkmcnt(12)
  v_mfma_f32_16x16x32_bf16 v[8:11], a[4:7], a[112:115], v[8:11]
  s_lshl_b32 s82, s22, 18
  s_waitcnt lgkmcnt(10)
  v_mfma_f32_16x16x32_bf16 v[16:19], a[8:11], a[112:115], v[16:19]
  s_add_u32 m0, s74, 0
  s_waitcnt lgkmcnt(8)
  v_mfma_f32_16x16x32_bf16 v[24:27], a[12:15], a[112:115], v[24:27]
  s_waitcnt lgkmcnt(0)
  buffer_load_dwordx4 v192, s[44:47], s82 offen lds
  v_mfma_f32_16x16x32_bf16 v[32:35], a[16:19], a[112:115], v[32:35]
  v_mfma_f32_16x16x32_bf16 v[40:43], a[20:23], a[112:115], v[40:43]
  v_mfma_f32_16x16x32_bf16 v[48:51], a[24:27], a[112:115], v[48:51]
  buffer_load_dwordx4 v193, s[44:47], s82 offen offset:1024 lds
  v_mfma_f32_16x16x32_bf16 v[56:59], a[28:31], a[112:115], v[56:59]
  v_mfma_f32_16x16x32_bf16 v[4:7], a[0:3], a[116:119], v[4:7]
  v_mfma_f32_16x16x32_bf16 v[12:15], a[4:7], a[116:119], v[12:15]
  v_mfma_f32_16x16x32_bf16 v[20:23], a[8:11], a[116:119], v[20:23]
  buffer_load_dwordx4 v194, s[44:47], s82 offen offset:2048 lds
  v_mfma_f32_16x16x32_bf16 v[28:31], a[12:15], a[116:119], v[28:31]
  v_mfma_f32_16x16x32_bf16 v[36:39], a[16:19], a[116:119], v[36:39]
  v_mfma_f32_16x16x32_bf16 v[44:47], a[20:23], a[116:119], v[44:47]
  buffer_load_dwordx4 v195, s[44:47], s82 offen offset:3072 lds
  v_mfma_f32_16x16x32_bf16 v[52:55], a[24:27], a[116:119], v[52:55]
  v_mfma_f32_16x16x32_bf16 v[60:63], a[28:31], a[116:119], v[60:63]
  v_mfma_f32_16x16x32_bf16 v[64:67], a[0:3], a[120:123], v[64:67]
  s_or_b32 s82, s82, 131072
  v_mfma_f32_16x16x32_bf16 v[72:75], a[4:7], a[120:123], v[72:75]
  s_add_u32 m0, s74, 4096
  v_mfma_f32_16x16x32_bf16 v[80:83], a[8:11], a[120:123], v[80:83]
  buffer_load_dwordx4 v192, s[44:47], s82 offen lds
  v_mfma_f32_16x16x32_bf16 v[88:91], a[12:15], a[120:123], v[88:91]
  v_mfma_f32_16x16x32_bf16 v[96:99], a[16:19], a[120:123], v[96:99]
  v_mfma_f32_16x16x32_bf16 v[104:107], a[20:23], a[120:123], v[104:107]
  buffer_load_dwordx4 v193, s[44:47], s82 offen offset:1024 lds
  v_mfma_f32_16x16x32_bf16 v[112:115], a[24:27], a[120:123], v[112:115]
  v_mfma_f32_16x16x32_bf16 v[120:123], a[28:31], a[120:123], v[120:123]
  v_mfma_f32_16x16x32_bf16 v[68:71], a[0:3], a[124:127], v[68:71]
  buffer_load_dwordx4 v194, s[44:47], s82 offen offset:2048 lds
  v_mfma_f32_16x16x32_bf16 v[76:79], a[4:7], a[124:127], v[76:79]
  v_mfma_f32_16x16x32_bf16 v[84:87], a[8:11], a[124:127], v[84:87]
  v_mfma_f32_16x16x32_bf16 v[92:95], a[12:15], a[124:127], v[92:95]
  buffer_load_dwordx4 v195, s[44:47], s82 offen offset:3072 lds
  v_mfma_f32_16x16x32_bf16 v[100:103], a[16:19], a[124:127], v[100:103]
  s_waitcnt vmcnt(14)
  ds_read_b64_tr_b16 a[32:33], v212 offset:8192
  v_mfma_f32_16x16x32_bf16 v[108:111], a[20:23], a[124:127], v[108:111]
  ds_read_b64_tr_b16 a[34:35], v212 offset:9216
  v_mfma_f32_16x16x32_bf16 v[116:119], a[24:27], a[124:127], v[116:119]
  ds_read_b64_tr_b16 a[36:37], v213 offset:8192
  v_mfma_f32_16x16x32_bf16 v[124:127], a[28:31], a[124:127], v[124:127]
  s_mov_b32 s84, 73728
  ds_read_b64_tr_b16 a[38:39], v213 offset:9216
  v_mfma_f32_16x16x32_bf16 v[128:131], a[0:3], a[128:131], v[128:131]
  s_mul_i32 s80, s68, 6144
  s_add_u32 m0, s80, 73728
  v_mfma_f32_16x16x32_bf16 v[136:139], a[4:7], a[128:131], v[136:139]
  ds_read_b64_tr_b16 a[40:41], v214 offset:8192
  ds_read_b64_tr_b16 a[42:43], v214 offset:9216
  v_mfma_f32_16x16x32_bf16 v[144:147], a[8:11], a[128:131], v[144:147]
  buffer_load_dwordx4 v199, s[36:39], s84 offen nt lds
  v_mfma_f32_16x16x32_bf16 v[152:155], a[12:15], a[128:131], v[152:155]
  ds_read_b64_tr_b16 a[44:45], v215 offset:8192
  ds_read_b64_tr_b16 a[46:47], v215 offset:9216
  v_mfma_f32_16x16x32_bf16 v[160:163], a[16:19], a[128:131], v[160:163]
  buffer_load_dwordx4 v200, s[36:39], s84 offen offset:1024 nt lds
  v_mfma_f32_16x16x32_bf16 v[168:171], a[20:23], a[128:131], v[168:171]
  ds_read_b64_tr_b16 a[48:49], v216 offset:8192
  v_mfma_f32_16x16x32_bf16 v[176:179], a[24:27], a[128:131], v[176:179]
  buffer_load_dwordx4 v201, s[36:39], s84 offen offset:2048 nt lds
  v_mfma_f32_16x16x32_bf16 v[184:187], a[28:31], a[128:131], v[184:187]
  ds_read_b64_tr_b16 a[50:51], v216 offset:9216
  ds_read_b64_tr_b16 a[52:53], v217 offset:8192
  v_mfma_f32_16x16x32_bf16 v[132:135], a[0:3], a[132:135], v[132:135]
  buffer_load_dwordx4 v202, s[36:39], s84 offen offset:3072 nt lds
  v_mfma_f32_16x16x32_bf16 v[140:143], a[4:7], a[132:135], v[140:143]
  ds_read_b64_tr_b16 a[54:55], v217 offset:9216
  ds_read_b64_tr_b16 a[56:57], v218 offset:8192
  v_mfma_f32_16x16x32_bf16 v[148:151], a[8:11], a[132:135], v[148:151]
  s_add_u32 m0, s80, 77824
  ds_read_b64_tr_b16 a[58:59], v218 offset:9216
  v_mfma_f32_16x16x32_bf16 v[156:159], a[12:15], a[132:135], v[156:159]
  buffer_load_dwordx4 v203, s[36:39], s84 offen nt lds
  v_mfma_f32_16x16x32_bf16 v[164:167], a[16:19], a[132:135], v[164:167]
  ds_read_b64_tr_b16 a[60:61], v219 offset:8192
  ds_read_b64_tr_b16 a[62:63], v219 offset:9216
  v_mfma_f32_16x16x32_bf16 v[172:175], a[20:23], a[132:135], v[172:175]
  buffer_load_dwordx4 v204, s[36:39], s84 offen offset:1024 nt lds
  v_mfma_f32_16x16x32_bf16 v[180:183], a[24:27], a[132:135], v[180:183]
  v_mfma_f32_16x16x32_bf16 v[188:191], a[28:31], a[132:135], v[188:191]
  s_waitcnt lgkmcnt(14)
  v_mfma_f32_16x16x32_bf16 v[0:3], a[32:35], a[136:139], v[0:3]
  s_add_u32 s23, s23, 4
  s_and_b32 s23, s23, 15
  s_waitcnt lgkmcnt(12)
  v_mfma_f32_16x16x32_bf16 v[8:11], a[36:39], a[136:139], v[8:11]
  s_lshl_b32 s82, s23, 18
  s_waitcnt lgkmcnt(10)
  v_mfma_f32_16x16x32_bf16 v[16:19], a[40:43], a[136:139], v[16:19]
  s_add_u32 m0, s74, 8192
  s_waitcnt lgkmcnt(8)
  v_mfma_f32_16x16x32_bf16 v[24:27], a[44:47], a[136:139], v[24:27]
  s_waitcnt lgkmcnt(0)
  buffer_load_dwordx4 v192, s[44:47], s82 offen lds
  v_mfma_f32_16x16x32_bf16 v[32:35], a[48:51], a[136:139], v[32:35]
  v_mfma_f32_16x16x32_bf16 v[40:43], a[52:55], a[136:139], v[40:43]
  v_mfma_f32_16x16x32_bf16 v[48:51], a[56:59], a[136:139], v[48:51]
  buffer_load_dwordx4 v193, s[44:47], s82 offen offset:1024 lds
  v_mfma_f32_16x16x32_bf16 v[56:59], a[60:63], a[136:139], v[56:59]
  v_mfma_f32_16x16x32_bf16 v[4:7], a[32:35], a[140:143], v[4:7]
  v_mfma_f32_16x16x32_bf16 v[12:15], a[36:39], a[140:143], v[12:15]
  v_mfma_f32_16x16x32_bf16 v[20:23], a[40:43], a[140:143], v[20:23]
  buffer_load_dwordx4 v194, s[44:47], s82 offen offset:2048 lds
  v_mfma_f32_16x16x32_bf16 v[28:31], a[44:47], a[140:143], v[28:31]
  v_mfma_f32_16x16x32_bf16 v[36:39], a[48:51], a[140:143], v[36:39]
  v_mfma_f32_16x16x32_bf16 v[44:47], a[52:55], a[140:143], v[44:47]
  buffer_load_dwordx4 v195, s[44:47], s82 offen offset:3072 lds
  v_mfma_f32_16x16x32_bf16 v[52:55], a[56:59], a[140:143], v[52:55]
  v_mfma_f32_16x16x32_bf16 v[60:63], a[60:63], a[140:143], v[60:63]
  v_mfma_f32_16x16x32_bf16 v[64:67], a[32:35], a[144:147], v[64:67]
  s_or_b32 s82, s82, 131072
  v_mfma_f32_16x16x32_bf16 v[72:75], a[36:39], a[144:147], v[72:75]
  s_add_u32 m0, s74, 12288
  v_mfma_f32_16x16x32_bf16 v[80:83], a[40:43], a[144:147], v[80:83]
  buffer_load_dwordx4 v192, s[44:47], s82 offen lds
  v_mfma_f32_16x16x32_bf16 v[88:91], a[44:47], a[144:147], v[88:91]
  v_mfma_f32_16x16x32_bf16 v[96:99], a[48:51], a[144:147], v[96:99]
  v_mfma_f32_16x16x32_bf16 v[104:107], a[52:55], a[144:147], v[104:107]
  buffer_load_dwordx4 v193, s[44:47], s82 offen offset:1024 lds
  v_mfma_f32_16x16x32_bf16 v[112:115], a[56:59], a[144:147], v[112:115]
  v_mfma_f32_16x16x32_bf16 v[120:123], a[60:63], a[144:147], v[120:123]
  v_mfma_f32_16x16x32_bf16 v[68:71], a[32:35], a[148:151], v[68:71]
  buffer_load_dwordx4 v194, s[44:47], s82 offen offset:2048 lds
  v_mfma_f32_16x16x32_bf16 v[76:79], a[36:39], a[148:151], v[76:79]
  v_mfma_f32_16x16x32_bf16 v[84:87], a[40:43], a[148:151], v[84:87]
  v_mfma_f32_16x16x32_bf16 v[92:95], a[44:47], a[148:151], v[92:95]
  buffer_load_dwordx4 v195, s[44:47], s82 offen offset:3072 lds
  v_mfma_f32_16x16x32_bf16 v[100:103], a[48:51], a[148:151], v[100:103]
  s_waitcnt vmcnt(14)
  ds_read_b64_tr_b16 a[0:1], v212
  v_mfma_f32_16x16x32_bf16 v[108:111], a[52:55], a[148:151], v[108:111]
  ds_read_b64_tr_b16 a[2:3], v212 offset:1024
  v_mfma_f32_16x16x32_bf16 v[116:119], a[56:59], a[148:151], v[116:119]
  ds_read_b64_tr_b16 a[4:5], v213
  v_mfma_f32_16x16x32_bf16 v[124:127], a[60:63], a[148:151], v[124:127]
  ds_read_b64_tr_b16 a[6:7], v213 offset:1024
  v_mfma_f32_16x16x32_bf16 v[128:131], a[32:35], a[152:155], v[128:131]
  ds_read_b64_tr_b16 a[8:9], v214
  v_mfma_f32_16x16x32_bf16 v[136:139], a[36:39], a[152:155], v[136:139]
  ds_read_b64_tr_b16 a[10:11], v214 offset:1024
  v_mfma_f32_16x16x32_bf16 v[144:147], a[40:43], a[152:155], v[144:147]
  ds_read_b64_tr_b16 a[12:13], v215
  v_mfma_f32_16x16x32_bf16 v[152:155], a[44:47], a[152:155], v[152:155]
  ds_read_b64_tr_b16 a[14:15], v215 offset:1024
  v_mfma_f32_16x16x32_bf16 v[160:163], a[48:51], a[152:155], v[160:163]
  v_mfma_f32_16x16x32_bf16 v[168:171], a[52:55], a[152:155], v[168:171]
  ds_read_b64_tr_b16 a[16:17], v216
  v_mfma_f32_16x16x32_bf16 v[176:179], a[56:59], a[152:155], v[176:179]
  ds_read_b64_tr_b16 a[18:19], v216 offset:1024
  v_mfma_f32_16x16x32_bf16 v[184:187], a[60:63], a[152:155], v[184:187]
  ds_read_b64_tr_b16 a[20:21], v217
  v_mfma_f32_16x16x32_bf16 v[132:135], a[32:35], a[156:159], v[132:135]
  ds_read_b64_tr_b16 a[22:23], v217 offset:1024
  v_mfma_f32_16x16x32_bf16 v[140:143], a[36:39], a[156:159], v[140:143]
  ds_read_b64_tr_b16 a[24:25], v218
  v_mfma_f32_16x16x32_bf16 v[148:151], a[40:43], a[156:159], v[148:151]
  ds_read_b64_tr_b16 a[26:27], v218 offset:1024
  v_mfma_f32_16x16x32_bf16 v[156:159], a[44:47], a[156:159], v[156:159]
  ds_read_b64_tr_b16 a[28:29], v219
  v_mfma_f32_16x16x32_bf16 v[164:167], a[48:51], a[156:159], v[164:167]
  ds_read_b64_tr_b16 a[30:31], v219 offset:1024
  v_mfma_f32_16x16x32_bf16 v[172:175], a[52:55], a[156:159], v[172:175]
  v_mfma_f32_16x16x32_bf16 v[180:183], a[56:59], a[156:159], v[180:183]
  v_mfma_f32_16x16x32_bf16 v[188:191], a[60:63], a[156:159], v[188:191]
  s_waitcnt lgkmcnt(14)
  v_mfma_f32_16x16x32_bf16 v[0:3], a[0:3], a[160:163], v[0:3]
  s_mov_b32 s84, 0
  s_waitcnt lgkmcnt(12)
  v_mfma_f32_16x16x32_bf16 v[8:11], a[4:7], a[160:163], v[8:11]
  s_add_u32 m0, s74, 0
  s_waitcnt lgkmcnt(10)
  v_mfma_f32_16x16x32_bf16 v[16:19], a[8:11], a[160:163], v[16:19]
  s_waitcnt lgkmcnt(8)
  v_mfma_f32_16x16x32_bf16 v[24:27], a[12:15], a[160:163], v[24:27]
  s_waitcnt lgkmcnt(0)
  buffer_load_dwordx4 v224, s[40:43], s84 offen nt lds
  v_mfma_f32_16x16x32_bf16 v[32:35], a[16:19], a[160:163], v[32:35]
  v_mfma_f32_16x16x32_bf16 v[40:43], a[20:23], a[160:163], v[40:43]
  v_mfma_f32_16x16x32_bf16 v[48:51], a[24:27], a[160:163], v[48:51]
  v_mfma_f32_16x16x32_bf16 v[56:59], a[28:31], a[160:163], v[56:59]
  v_mfma_f32_16x16x32_bf16 v[4:7], a[0:3], a[164:167], v[4:7]
  s_waitcnt vmcnt(9)
  s_barrier
  ds_read_b128 a[64:67], v229
  v_mfma_f32_16x16x32_bf16 v[12:15], a[4:7], a[164:167], v[12:15]
  buffer_load_dwordx4 v224, s[40:43], s84 offen offset:1024 nt lds
  v_mfma_f32_16x16x32_bf16 v[20:23], a[8:11], a[164:167], v[20:23]
  ds_read_b128 a[96:99], v229 offset:8192
  v_mfma_f32_16x16x32_bf16 v[28:31], a[12:15], a[164:167], v[28:31]
  ds_read_b128 a[128:131], v229 offset:16384
  v_mfma_f32_16x16x32_bf16 v[36:39], a[16:19], a[164:167], v[36:39]
  v_xor_b32 v250, 32, v229
  v_mfma_f32_16x16x32_bf16 v[44:47], a[20:23], a[164:167], v[44:47]
  ds_read_b128 a[68:71], v250
  v_mfma_f32_16x16x32_bf16 v[52:55], a[24:27], a[164:167], v[52:55]
  buffer_load_dwordx4 v224, s[40:43], s84 offen offset:2048 nt lds
  v_mfma_f32_16x16x32_bf16 v[60:63], a[28:31], a[164:167], v[60:63]
  ds_read_b128 a[100:103], v250 offset:8192
  ds_read_b128 a[132:135], v250 offset:16384
  v_mfma_f32_16x16x32_bf16 v[64:67], a[0:3], a[168:171], v[64:67]
  v_xor_b32 v230, 64, v229
  v_mfma_f32_16x16x32_bf16 v[72:75], a[4:7], a[168:171], v[72:75]
  ds_read_b128 a[72:75], v230
  v_mfma_f32_16x16x32_bf16 v[80:83], a[8:11], a[168:171], v[80:83]
  buffer_load_dwordx4 v224, s[40:43], s84 offen offset:3072 nt lds
  v_mfma_f32_16x16x32_bf16 v[88:91], a[12:15], a[168:171], v[88:91]
  ds_read_b128 a[104:107], v230 offset:8192
  v_mfma_f32_16x16x32_bf16 v[96:99], a[16:19], a[168:171], v[96:99]
  ds_read_b128 a[136:139], v230 offset:16384
  v_mfma_f32_16x16x32_bf16 v[104:107], a[20:23], a[168:171], v[104:107]
  v_xor_b32 v250, 96, v229
  v_mfma_f32_16x16x32_bf16 v[112:115], a[24:27], a[168:171], v[112:115]
  ds_read_b128 a[76:79], v250
  v_mfma_f32_16x16x32_bf16 v[120:123], a[28:31], a[168:171], v[120:123]
  ds_read_b128 a[108:111], v250 offset:8192
  v_mfma_f32_16x16x32_bf16 v[68:71], a[0:3], a[172:175], v[68:71]
  s_mov_b32 s84, 4096
  ds_read_b128 a[140:143], v250 offset:16384
  v_mfma_f32_16x16x32_bf16 v[76:79], a[4:7], a[172:175], v[76:79]
  s_add_u32 m0, s74, 4096
  v_mfma_f32_16x16x32_bf16 v[84:87], a[8:11], a[172:175], v[84:87]
  v_xor_b32 v230, 128, v229
  v_mfma_f32_16x16x32_bf16 v[92:95], a[12:15], a[172:175], v[92:95]
  buffer_load_dwordx4 v224, s[40:43], s84 offen nt lds
  v_mfma_f32_16x16x32_bf16 v[100:103], a[16:19], a[172:175], v[100:103]
  s_waitcnt vmcnt(5)
  ds_read_b64_tr_b16 a[32:33], v212 offset:8192
  ds_read_b128 a[80:83], v230
  v_mfma_f32_16x16x32_bf16 v[108:111], a[20:23], a[172:175], v[108:111]
  ds_read_b64_tr_b16 a[34:35], v212 offset:9216
  ds_read_b128 a[112:115], v230 offset:8192
  v_mfma_f32_16x16x32_bf16 v[116:119], a[24:27], a[172:175], v[116:119]
  ds_read_b64_tr_b16 a[36:37], v213 offset:8192
  ds_read_b128 a[144:147], v230 offset:16384
  v_mfma_f32_16x16x32_bf16 v[124:127], a[28:31], a[172:175], v[124:127]
  ds_read_b64_tr_b16 a[38:39], v213 offset:9216
  v_xor_b32 v250, 160, v229
  v_mfma_f32_16x16x32_bf16 v[128:131], a[0:3], a[176:179], v[128:131]
  ds_read_b64_tr_b16 a[40:41], v214 offset:8192
  ds_read_b128 a[84:87], v250
  v_mfma_f32_16x16x32_bf16 v[136:139], a[4:7], a[176:179], v[136:139]
  buffer_load_dwordx4 v224, s[40:43], s84 offen offset:1024 nt lds
  v_mfma_f32_16x16x32_bf16 v[144:147], a[8:11], a[176:179], v[144:147]
  ds_read_b64_tr_b16 a[42:43], v214 offset:9216
  ds_read_b128 a[116:119], v250 offset:8192
  v_mfma_f32_16x16x32_bf16 v[152:155], a[12:15], a[176:179], v[152:155]
  ds_read_b64_tr_b16 a[44:45], v215 offset:8192
  ds_read_b128 a[148:151], v250 offset:16384
  v_mfma_f32_16x16x32_bf16 v[160:163], a[16:19], a[176:179], v[160:163]
  ds_read_b64_tr_b16 a[46:47], v215 offset:9216
  v_xor_b32 v230, 192, v229
  v_mfma_f32_16x16x32_bf16 v[168:171], a[20:23], a[176:179], v[168:171]
  ds_read_b64_tr_b16 a[48:49], v216 offset:8192
  ds_read_b128 a[88:91], v230
  v_mfma_f32_16x16x32_bf16 v[176:179], a[24:27], a[176:179], v[176:179]
  ds_read_b64_tr_b16 a[50:51], v216 offset:9216
  ds_read_b128 a[120:123], v230 offset:8192
  v_mfma_f32_16x16x32_bf16 v[184:187], a[28:31], a[176:179], v[184:187]
  buffer_load_dwordx4 v224, s[40:43], s84 offen offset:2048 nt lds
  v_mfma_f32_16x16x32_bf16 v[132:135], a[0:3], a[180:183], v[132:135]
  ds_read_b64_tr_b16 a[52:53], v217 offset:8192
  ds_read_b128 a[152:155], v230 offset:16384
  v_mfma_f32_16x16x32_bf16 v[140:143], a[4:7], a[180:183], v[140:143]
  ds_read_b64_tr_b16 a[54:55], v217 offset:9216
  v_xor_b32 v250, 224, v229
  v_mfma_f32_16x16x32_bf16 v[148:151], a[8:11], a[180:183], v[148:151]
  ds_read_b64_tr_b16 a[56:57], v218 offset:8192
  ds_read_b128 a[92:95], v250
  v_mfma_f32_16x16x32_bf16 v[156:159], a[12:15], a[180:183], v[156:159]
  ds_read_b64_tr_b16 a[58:59], v218 offset:9216
  ds_read_b128 a[124:127], v250 offset:8192
  v_mfma_f32_16x16x32_bf16 v[164:167], a[16:19], a[180:183], v[164:167]
  ds_read_b64_tr_b16 a[60:61], v219 offset:8192
  ds_read_b128 a[156:159], v250 offset:16384
  v_mfma_f32_16x16x32_bf16 v[172:175], a[20:23], a[180:183], v[172:175]
  buffer_load_dwordx4 v224, s[40:43], s84 offen offset:3072 nt lds
  ds_read_b64_tr_b16 a[62:63], v219 offset:9216
  v_mfma_f32_16x16x32_bf16 v[180:183], a[24:27], a[180:183], v[180:183]
  v_mfma_f32_16x16x32_bf16 v[188:191], a[28:31], a[180:183], v[188:191]
  s_waitcnt lgkmcnt(15)
  v_mfma_f32_16x16x32_bf16 v[0:3], a[32:35], a[184:187], v[0:3]
  v_mfma_f32_16x16x32_bf16 v[8:11], a[36:39], a[184:187], v[8:11]
  v_mfma_f32_16x16x32_bf16 v[16:19], a[40:43], a[184:187], v[16:19]
  s_waitcnt lgkmcnt(14)
  v_mfma_f32_16x16x32_bf16 v[24:27], a[44:47], a[184:187], v[24:27]
  s_waitcnt lgkmcnt(11)
  v_mfma_f32_16x16x32_bf16 v[32:35], a[48:51], a[184:187], v[32:35]
  s_waitcnt lgkmcnt(7)
  v_mfma_f32_16x16x32_bf16 v[40:43], a[52:55], a[184:187], v[40:43]
  s_waitcnt lgkmcnt(4)
  v_mfma_f32_16x16x32_bf16 v[48:51], a[56:59], a[184:187], v[48:51]
  s_waitcnt lgkmcnt(0)
  v_mfma_f32_16x16x32_bf16 v[56:59], a[60:63], a[184:187], v[56:59]
  v_mfma_f32_16x16x32_bf16 v[4:7], a[32:35], a[188:191], v[4:7]
  v_mfma_f32_16x16x32_bf16 v[12:15], a[36:39], a[188:191], v[12:15]
  v_mfma_f32_16x16x32_bf16 v[20:23], a[40:43], a[188:191], v[20:23]
  v_mfma_f32_16x16x32_bf16 v[28:31], a[44:47], a[188:191], v[28:31]
  v_mfma_f32_16x16x32_bf16 v[36:39], a[48:51], a[188:191], v[36:39]
  v_mfma_f32_16x16x32_bf16 v[44:47], a[52:55], a[188:191], v[44:47]
  v_mfma_f32_16x16x32_bf16 v[52:55], a[56:59], a[188:191], v[52:55]
  v_mfma_f32_16x16x32_bf16 v[60:63], a[60:63], a[188:191], v[60:63]
  v_mfma_f32_16x16x32_bf16 v[64:67], a[32:35], a[192:195], v[64:67]
  v_mfma_f32_16x16x32_bf16 v[72:75], a[36:39], a[192:195], v[72:75]
  v_mfma_f32_16x16x32_bf16 v[80:83], a[40:43], a[192:195], v[80:83]
  v_mfma_f32_16x16x32_bf16 v[88:91], a[44:47], a[192:195], v[88:91]
  v_mfma_f32_16x16x32_bf16 v[96:99], a[48:51], a[192:195], v[96:99]
  v_mfma_f32_16x16x32_bf16 v[104:107], a[52:55], a[192:195], v[104:107]
  v_mfma_f32_16x16x32_bf16 v[112:115], a[56:59], a[192:195], v[112:115]
  v_mfma_f32_16x16x32_bf16 v[120:123], a[60:63], a[192:195], v[120:123]
  v_mfma_f32_16x16x32_bf16 v[68:71], a[32:35], a[196:199], v[68:71]
  v_mfma_f32_16x16x32_bf16 v[76:79], a[36:39], a[196:199], v[76:79]
  v_mfma_f32_16x16x32_bf16 v[84:87], a[40:43], a[196:199], v[84:87]
  v_mfma_f32_16x16x32_bf16 v[92:95], a[44:47], a[196:199], v[92:95]
  v_mfma_f32_16x16x32_bf16 v[100:103], a[48:51], a[196:199], v[100:103]
  v_mfma_f32_16x16x32_bf16 v[108:111], a[52:55], a[196:199], v[108:111]
  v_mfma_f32_16x16x32_bf16 v[116:119], a[56:59], a[196:199], v[116:119]
  v_mfma_f32_16x16x32_bf16 v[124:127], a[60:63], a[196:199], v[124:127]
  v_mfma_f32_16x16x32_bf16 v[128:131], a[32:35], a[200:203], v[128:131]
  v_mfma_f32_16x16x32_bf16 v[136:139], a[36:39], a[200:203], v[136:139]
  v_mfma_f32_16x16x32_bf16 v[144:147], a[40:43], a[200:203], v[144:147]
  v_mfma_f32_16x16x32_bf16 v[152:155], a[44:47], a[200:203], v[152:155]
  v_mfma_f32_16x16x32_bf16 v[160:163], a[48:51], a[200:203], v[160:163]
  v_mfma_f32_16x16x32_bf16 v[168:171], a[52:55], a[200:203], v[168:171]
  v_mfma_f32_16x16x32_bf16 v[176:179], a[56:59], a[200:203], v[176:179]
  v_mfma_f32_16x16x32_bf16 v[184:187], a[60:63], a[200:203], v[184:187]
  v_mfma_f32_16x16x32_bf16 v[132:135], a[32:35], a[204:207], v[132:135]
  v_mfma_f32_16x16x32_bf16 v[140:143], a[36:39], a[204:207], v[140:143]
  v_mfma_f32_16x16x32_bf16 v[148:151], a[40:43], a[204:207], v[148:151]
  v_mfma_f32_16x16x32_bf16 v[156:159], a[44:47], a[204:207], v[156:159]
  v_mfma_f32_16x16x32_bf16 v[164:167], a[48:51], a[204:207], v[164:167]
  v_mfma_f32_16x16x32_bf16 v[172:175], a[52:55], a[204:207], v[172:175]
  v_mfma_f32_16x16x32_bf16 v[180:183], a[56:59], a[204:207], v[180:183]
  v_mfma_f32_16x16x32_bf16 v[188:191], a[60:63], a[204:207], v[188:191]
  s_add_u32 m0, s74, 8192
  s_mov_b32 s84, 8192
  buffer_load_dwordx4 v224, s[40:43], s84 offen nt lds
  v_cvt_pk_bf16_f32 v0, v0, v1
  v_cvt_pk_bf16_f32 v1, v2, v3
  v_cvt_pk_bf16_f32 v2, v4, v5
  v_cvt_pk_bf16_f32 v3, v6, v7
  v_cvt_pk_bf16_f32 v4, v8, v9
  v_permlane16_swap_b32 v0, v2
  v_permlane16_swap_b32 v1, v3
  v_cvt_pk_bf16_f32 v5, v10, v11
  v_cvt_pk_bf16_f32 v8, v16, v17
  v_mfma_f32_32x32x16_bf16 v[192:207], a[128:131], v[0:3], 0
  v_cvt_pk_bf16_f32 v9, v18, v19
  v_cvt_pk_bf16_f32 v10, v20, v21
  v_cvt_pk_bf16_f32 v11, v22, v23
  v_cvt_pk_bf16_f32 v6, v12, v13
  v_cvt_pk_bf16_f32 v7, v14, v15
  v_cvt_pk_bf16_f32 v16, v32, v33
  v_cvt_pk_bf16_f32 v17, v34, v35
  v_cvt_pk_bf16_f32 v18, v36, v37
  v_cvt_pk_bf16_f32 v19, v38, v39
  v_cvt_pk_bf16_f32 v20, v40, v41
  v_cvt_pk_bf16_f32 v21, v42, v43
  v_cvt_pk_bf16_f32 v22, v44, v45
  v_cvt_pk_bf16_f32 v23, v46, v47
  v_mfma_f32_32x32x16_bf16 v[32:47], a[64:67], v[0:3], 0
  v_cvt_pk_bf16_f32 v12, v24, v25
  v_cvt_pk_bf16_f32 v13, v26, v27
  v_cvt_pk_bf16_f32 v14, v28, v29
  v_cvt_pk_bf16_f32 v15, v30, v31
  v_cvt_pk_bf16_f32 v24, v48, v49
  v_cvt_pk_bf16_f32 v25, v50, v51
  v_cvt_pk_bf16_f32 v26, v52, v53
  v_cvt_pk_bf16_f32 v27, v54, v55
  v_cvt_pk_bf16_f32 v28, v56, v57
  v_cvt_pk_bf16_f32 v29, v58, v59
  v_cvt_pk_bf16_f32 v30, v60, v61
  v_cvt_pk_bf16_f32 v31, v62, v63
  v_mfma_f32_32x32x16_bf16 v[48:63], a[96:99], v[0:3], 0
  v_permlane16_swap_b32 v4, v6
  v_permlane16_swap_b32 v5, v7
  v_permlane16_swap_b32 v8, v10
  v_permlane16_swap_b32 v9, v11
  v_permlane16_swap_b32 v12, v14
  v_permlane16_swap_b32 v13, v15
  v_mfma_f32_32x32x16_bf16 v[32:47], a[68:71], v[4:7], v[32:47]
  v_permlane16_swap_b32 v16, v18
  v_permlane16_swap_b32 v17, v19
  v_permlane16_swap_b32 v20, v22
  v_permlane16_swap_b32 v21, v23
  v_cvt_pk_bf16_f32 v64, v64, v65
  v_mfma_f32_32x32x16_bf16 v[48:63], a[100:103], v[4:7], v[48:63]
  buffer_load_dwordx4 v224, s[40:43], s84 offen offset:1024 nt lds
  v_cvt_pk_bf16_f32 v65, v66, v67
  v_cvt_pk_bf16_f32 v66, v68, v69
  v_mfma_f32_32x32x16_bf16 v[32:47], a[72:75], v[8:11], v[32:47]
  v_cvt_pk_bf16_f32 v67, v70, v71
  v_permlane16_swap_b32 v24, v26
  v_permlane16_swap_b32 v25, v27
  v_permlane16_swap_b32 v64, v66
  v_permlane16_swap_b32 v65, v67
  v_mfma_f32_32x32x16_bf16 v[192:207], a[132:135], v[4:7], v[192:207]
  v_cvt_pk_bf16_f32 v68, v72, v73
  v_cvt_pk_bf16_f32 v69, v74, v75
  v_cvt_pk_bf16_f32 v72, v80, v81
  v_cvt_pk_bf16_f32 v73, v82, v83
  v_permlane16_swap_b32 v28, v30
  v_mfma_f32_32x32x16_bf16 v[48:63], a[104:107], v[8:11], v[48:63]
  v_cvt_pk_bf16_f32 v74, v84, v85
  v_cvt_pk_bf16_f32 v75, v86, v87
  v_cvt_pk_bf16_f32 v70, v76, v77
  v_cvt_pk_bf16_f32 v71, v78, v79
  v_permlane16_swap_b32 v29, v31
  v_mfma_f32_32x32x16_bf16 v[32:47], a[76:79], v[12:15], v[32:47]
  v_cvt_pk_bf16_f32 v80, v96, v97
  v_cvt_pk_bf16_f32 v81, v98, v99
  v_cvt_pk_bf16_f32 v82, v100, v101
  v_cvt_pk_bf16_f32 v83, v102, v103
  v_permlane16_swap_b32 v68, v70
  v_mfma_f32_32x32x16_bf16 v[192:207], a[136:139], v[8:11], v[192:207]
  v_cvt_pk_bf16_f32 v84, v104, v105
  v_cvt_pk_bf16_f32 v85, v106, v107
  v_cvt_pk_bf16_f32 v86, v108, v109
  v_cvt_pk_bf16_f32 v87, v110, v111
  v_permlane16_swap_b32 v69, v71
  v_mfma_f32_32x32x16_bf16 v[48:63], a[108:111], v[12:15], v[48:63]
  v_cvt_pk_bf16_f32 v76, v88, v89
  v_cvt_pk_bf16_f32 v77, v90, v91
  v_cvt_pk_bf16_f32 v78, v92, v93
  v_cvt_pk_bf16_f32 v79, v94, v95
  v_permlane16_swap_b32 v72, v74
  v_mfma_f32_32x32x16_bf16 v[32:47], a[80:83], v[16:19], v[32:47]
  v_cvt_pk_bf16_f32 v88, v112, v113
  v_cvt_pk_bf16_f32 v89, v114, v115
  v_cvt_pk_bf16_f32 v90, v116, v117
  v_cvt_pk_bf16_f32 v91, v118, v119
  v_permlane16_swap_b32 v73, v75
  v_mfma_f32_32x32x16_bf16 v[192:207], a[140:143], v[12:15], v[192:207]
  buffer_load_dwordx4 v224, s[40:43], s84 offen offset:2048 nt lds
  v_cvt_pk_bf16_f32 v92, v120, v121
  v_cvt_pk_bf16_f32 v93, v122, v123
  v_mfma_f32_32x32x16_bf16 v[48:63], a[112:115], v[16:19], v[48:63]
  v_cvt_pk_bf16_f32 v94, v124, v125
  v_cvt_pk_bf16_f32 v95, v126, v127
  v_permlane16_swap_b32 v76, v78
  v_permlane16_swap_b32 v77, v79
  v_permlane16_swap_b32 v80, v82
  v_mfma_f32_32x32x16_bf16 v[32:47], a[84:87], v[20:23], v[32:47]
  v_permlane16_swap_b32 v81, v83
  s_waitcnt vmcnt(7)
  ds_read_b64_tr_b16 a[0:1], v225
  ds_read_b64_tr_b16 a[2:3], v225 offset:2048
  ds_read_b64_tr_b16 a[24:25], v226
  ds_read_b64_tr_b16 a[26:27], v226 offset:2048
  v_mfma_f32_32x32x16_bf16 v[192:207], a[144:147], v[16:19], v[192:207]
  ds_read_b64_tr_b16 a[48:49], v227
  ds_read_b64_tr_b16 a[50:51], v227 offset:2048
  ds_read_b64_tr_b16 a[216:217], v228
  ds_read_b64_tr_b16 a[218:219], v228 offset:2048
  v_permlane16_swap_b32 v84, v86
  v_mfma_f32_32x32x16_bf16 v[48:63], a[116:119], v[20:23], v[48:63]
  v_permlane16_swap_b32 v85, v87
  v_permlane16_swap_b32 v88, v90
  v_permlane16_swap_b32 v89, v91
  v_permlane16_swap_b32 v92, v94
  v_permlane16_swap_b32 v93, v95
  v_cmp_eq_u32 vcc, 0, v255
  v_mfma_f32_32x32x16_bf16 v[32:47], a[88:91], v[24:27], v[32:47]
  v_mov_b32 v254, 0x7ffffff0
  v_mov_b32 v253, s86
  v_cvt_pk_bf16_f32 v128, v128, v129
  v_cvt_pk_bf16_f32 v129, v130, v131
  v_cvt_pk_bf16_f32 v130, v132, v133
  v_mfma_f32_32x32x16_bf16 v[96:111], a[64:67], v[64:67], 0
  v_cvt_pk_bf16_f32 v131, v134, v135
  v_permlane16_swap_b32 v128, v130
  v_cvt_pk_bf16_f32 v132, v136, v137
  v_permlane16_swap_b32 v129, v131
  v_cvt_pk_bf16_f32 v133, v138, v139
  v_mfma_f32_32x32x16_bf16 v[192:207], a[148:151], v[20:23], v[192:207]
  v_cvt_pk_bf16_f32 v136, v144, v145
  v_cvt_pk_bf16_f32 v137, v146, v147
  v_cvt_pk_bf16_f32 v138, v148, v149
  v_cvt_pk_bf16_f32 v139, v150, v151
  v_mfma_f32_32x32x16_bf16 v[48:63], a[120:123], v[24:27], v[48:63]
  buffer_load_dwordx4 v224, s[40:43], s84 offen offset:3072 nt lds
  s_add_u32 m0, s74, 12288
  s_mov_b32 s84, 12288
  v_permlane16_swap_b32 v136, v138
  v_mfma_f32_32x32x16_bf16 v[112:127], a[96:99], v[64:67], 0
  v_cvt_pk_bf16_f32 v134, v140, v141
  v_cvt_pk_bf16_f32 v135, v142, v143
  v_cvt_pk_bf16_f32 v144, v160, v161
  v_cvt_pk_bf16_f32 v145, v162, v163
  v_permlane16_swap_b32 v132, v134
  v_mfma_f32_32x32x16_bf16 v[32:47], a[92:95], v[28:31], v[32:47]
  v_cvt_pk_bf16_f32 v146, v164, v165
  v_cvt_pk_bf16_f32 v147, v166, v167
  v_cvt_pk_bf16_f32 v148, v168, v169
  v_cvt_pk_bf16_f32 v149, v170, v171
  v_permlane16_swap_b32 v133, v135
  v_mfma_f32_32x32x16_bf16 v[96:111], a[68:71], v[68:71], v[96:111]
  v_cvt_pk_bf16_f32 v150, v172, v173
  v_cvt_pk_bf16_f32 v151, v174, v175
  v_cvt_pk_bf16_f32 v140, v152, v153
  v_cvt_pk_bf16_f32 v141, v154, v155
  v_permlane16_swap_b32 v137, v139
  v_mfma_f32_32x32x16_bf16 v[192:207], a[152:155], v[24:27], v[192:207]
  v_max3_f32 v242, v32, v33, v34
  v_max3_f32 v242, v242, v35, v36
  v_max3_f32 v242, v242, v37, v38
  v_max3_f32 v242, v242, v39, v40
  v_permlane16_swap_b32 v144, v146
  v_mfma_f32_32x32x16_bf16 v[208:223], a[128:131], v[64:67], 0
  v_max3_f32 v242, v242, v41, v42
  v_max3_f32 v242, v242, v43, v44
  v_max3_f32 v242, v242, v45, v46
  v_cvt_pk_bf16_f32 v142, v156, v157
  v_permlane16_swap_b32 v145, v147
  v_mfma_f32_32x32x16_bf16 v[48:63], a[124:127], v[28:31], v[48:63]
  v_cvt_pk_bf16_f32 v143, v158, v159
  v_cvt_pk_bf16_f32 v152, v176, v177
  v_cvt_pk_bf16_f32 v153, v178, v179
  v_cvt_pk_bf16_f32 v154, v180, v181
  v_permlane16_swap_b32 v140, v142
  v_mfma_f32_32x32x16_bf16 v[112:127], a[100:103], v[68:71], v[112:127]
  v_cvt_pk_bf16_f32 v155, v182, v183
  v_cvt_pk_bf16_f32 v156, v184, v185
  v_cvt_pk_bf16_f32 v157, v186, v187
  v_cvt_pk_bf16_f32 v158, v188, v189
  v_permlane16_swap_b32 v141, v143
  v_mfma_f32_32x32x16_bf16 v[96:111], a[72:75], v[72:75], v[96:111]
  buffer_load_dwordx4 v224, s[40:43], s84 offen nt lds
  v_max3_f32 v243, v56, v57, v58
  v_max3_f32 v243, v243, v59, v60
  v_mfma_f32_32x32x16_bf16 v[192:207], a[156:159], v[28:31], v[192:207]
  v_max3_f32 v243, v243, v61, v62
  v_max3_f32 v242, v242, v47, v48
  v_max3_f32 v242, v242, v49, v50
  v_max3_f32 v242, v242, v51, v52
  v_permlane16_swap_b32 v148, v150
  v_mfma_f32_32x32x16_bf16 v[208:223], a[132:135], v[68:71], v[208:223]
  v_max3_f32 v242, v242, v53, v54
  v_cvt_pk_bf16_f32 v159, v190, v191
  s_waitcnt vmcnt(5)
  ds_read_b64_tr_b16 a[4:5], v225 offset:4096
  ds_read_b64_tr_b16 a[6:7], v225 offset:6144
  v_permlane16_swap_b32 v149, v151
  v_mfma_f32_32x32x16_bf16 v[112:127], a[104:107], v[72:75], v[112:127]
  v_max3_f32 v243, v243, v63, v192
  v_max3_f32 v243, v243, v193, v194
  v_max3_f32 v243, v243, v195, v196
  v_max3_f32 v243, v243, v197, v198
  v_permlane16_swap_b32 v152, v154
  v_mfma_f32_32x32x16_bf16 v[96:111], a[76:79], v[76:79], v[96:111]
  v_max3_f32 v243, v243, v199, v200
  v_max3_f32 v243, v243, v201, v202
  v_max3_f32 v243, v243, v203, v204
  v_max3_f32 v243, v243, v205, v206
  v_permlane16_swap_b32 v153, v155
  v_mfma_f32_32x32x16_bf16 v[208:223], a[136:139], v[72:75], v[208:223]
  v_max3_f32 v242, v242, v55, v207
  v_max_f32 v242, v242, v243
  v_mov_b32 v243, v242
  ds_read_b64_tr_b16 a[28:29], v226 offset:4096
  ds_read_b64_tr_b16 a[30:31], v226 offset:6144
  v_mfma_f32_32x32x16_bf16 v[112:127], a[108:111], v[76:79], v[112:127]
  v_permlane32_swap_b32 v242, v243
  v_max_f32 v242, v242, v243
  v_mul_f32 v242, s81, v242
  v_fma_f32 v32, v32, s81, -v242
  v_fma_f32 v33, v33, s81, -v242
  v_mfma_f32_32x32x16_bf16 v[96:111], a[80:83], v[80:83], v[96:111]
  v_fma_f32 v34, v34, s81, -v242
  v_fma_f32 v35, v35, s81, -v242
  v_fma_f32 v36, v36, s81, -v242
  v_fma_f32 v37, v37, s81, -v242
  v_permlane16_swap_b32 v156, v158
  v_mfma_f32_32x32x16_bf16 v[208:223], a[140:143], v[76:79], v[208:223]
  buffer_load_dwordx4 v224, s[40:43], s84 offen offset:1024 nt lds
  v_exp_f32 v32, v32
  v_permlane16_swap_b32 v157, v159
  v_mfma_f32_32x32x16_bf16 v[112:127], a[112:115], v[80:83], v[112:127]
  v_exp_f32 v33, v33
  v_exp_f32 v34, v34
  v_exp_f32 v35, v35
  v_mfma_f32_32x32x16_bf16 v[96:111], a[84:87], v[84:87], v[96:111]
  v_fma_f32 v38, v38, s81, -v242
  v_fma_f32 v39, v39, s81, -v242
  v_exp_f32 v36, v36
  v_fma_f32 v40, v40, s81, -v242
  v_mfma_f32_32x32x16_bf16 v[208:223], a[144:147], v[80:83], v[208:223]
  v_exp_f32 v37, v37
  v_fma_f32 v41, v41, s81, -v242
  v_exp_f32 v38, v38
  v_mfma_f32_32x32x16_bf16 v[112:127], a[116:119], v[84:87], v[112:127]
  v_exp_f32 v39, v39
  v_add_f32 v244, v32, v33
  v_add_f32 v245, v34, v35
  v_fma_f32 v42, v42, s81, -v242
  v_mfma_f32_32x32x16_bf16 v[96:111], a[88:91], v[88:91], v[96:111]
  v_fma_f32 v43, v43, s81, -v242
  v_exp_f32 v40, v40
  v_exp_f32 v41, v41
  v_mfma_f32_32x32x16_bf16 v[208:223], a[148:151], v[84:87], v[208:223]
  v_add_f32 v244, v244, v36
  v_add_f32 v245, v245, v37
  v_fma_f32 v44, v44, s81, -v242
  v_fma_f32 v45, v45, s81, -v242
  v_add_f32 v244, v244, v38
  v_mfma_f32_32x32x16_bf16 v[112:127], a[120:123], v[88:91], v[112:127]
  v_exp_f32 v42, v42
  v_exp_f32 v43, v43
  v_add_f32 v245, v245, v39
  v_add_f32 v244, v244, v40
  v_mfma_f32_32x32x16_bf16 v[96:111], a[92:95], v[92:95], v[96:111]
  buffer_load_dwordx4 v224, s[40:43], s84 offen offset:2048 nt lds
  v_fma_f32 v46, v46, s81, -v242
  v_fma_f32 v47, v47, s81, -v242
  v_mfma_f32_32x32x16_bf16 v[208:223], a[152:155], v[88:91], v[208:223]
  v_exp_f32 v44, v44
  v_exp_f32 v45, v45
  v_add_f32 v245, v245, v41
  v_add_f32 v244, v244, v42
  v_mfma_f32_32x32x16_bf16 v[112:127], a[124:127], v[92:95], v[112:127]
  s_nop 2
  v_max3_f32 v246, v96, v97, v98
  v_max3_f32 v246, v246, v99, v100
  v_fma_f32 v48, v48, s81, -v242
  v_fma_f32 v49, v49, s81, -v242
  v_add_f32 v245, v245, v43
  v_mfma_f32_32x32x16_bf16 v[208:223], a[156:159], v[92:95], v[208:223]
  v_max3_f32 v246, v246, v101, v102
  v_exp_f32 v46, v46
  v_exp_f32 v47, v47
  v_mfma_f32_32x32x16_bf16 v[160:175], a[64:67], v[128:131], 0
  v_max3_f32 v247, v120, v121, v122
  v_max3_f32 v247, v247, v123, v124
  v_fma_f32 v50, v50, s81, -v242
  v_fma_f32 v51, v51, s81, -v242
  v_add_f32 v244, v244, v44
  v_mfma_f32_32x32x16_bf16 v[176:191], a[96:99], v[128:131], 0
  v_exp_f32 v48, v48
  v_exp_f32 v49, v49
  v_max3_f32 v247, v247, v125, v126
  v_mfma_f32_32x32x16_bf16 v[160:175], a[68:71], v[132:135], v[160:175]
  v_max3_f32 v246, v246, v103, v104
  v_add_f32 v245, v245, v45
  v_fma_f32 v52, v52, s81, -v242
  v_fma_f32 v53, v53, s81, -v242
  v_max3_f32 v247, v247, v127, v208
  v_mfma_f32_32x32x16_bf16 v[176:191], a[100:103], v[132:135], v[176:191]
  v_exp_f32 v50, v50
  v_exp_f32 v51, v51
  v_max3_f32 v246, v246, v105, v106
  v_mfma_f32_32x32x16_bf16 v[160:175], a[72:75], v[136:139], v[160:175]
  buffer_load_dwordx4 v224, s[40:43], s84 offen offset:3072 nt lds
  s_add_u32 m0, s85, 0
  s_mov_b32 s84, 16384
  v_add_f32 v244, v244, v46
  v_mfma_f32_32x32x16_bf16 v[176:191], a[104:107], v[136:139], v[176:191]
  v_add_f32 v245, v245, v47
  v_fma_f32 v54, v54, s81, -v242
  v_fma_f32 v55, v55, s81, -v242
  v_exp_f32 v52, v52
  v_mfma_f32_32x32x16_bf16 v[160:175], a[76:79], v[140:143], v[160:175]
  v_exp_f32 v53, v53
  v_max3_f32 v247, v247, v209, v210
  v_max3_f32 v246, v246, v107, v108
  v_add_f32 v244, v244, v48
  v_mfma_f32_32x32x16_bf16 v[176:191], a[108:111], v[140:143], v[176:191]
  v_add_f32 v245, v245, v49
  v_fma_f32 v56, v56, s81, -v242
  v_fma_f32 v57, v57, s81, -v242
  v_exp_f32 v54, v54
  v_mfma_f32_32x32x16_bf16 v[160:175], a[80:83], v[144:147], v[160:175]
  v_exp_f32 v55, v55
  v_max3_f32 v247, v247, v211, v212
  v_max3_f32 v246, v246, v109, v110
  v_add_f32 v244, v244, v50
  v_mfma_f32_32x32x16_bf16 v[176:191], a[112:115], v[144:147], v[176:191]
  v_add_f32 v245, v245, v51
  v_fma_f32 v58, v58, s81, -v242
  v_fma_f32 v59, v59, s81, -v242
  v_exp_f32 v56, v56
  v_mfma_f32_32x32x16_bf16 v[160:175], a[84:87], v[148:151], v[160:175]
  v_exp_f32 v57, v57
  v_add_f32 v244, v244, v52
  v_add_f32 v245, v245, v53
  v_max3_f32 v247, v247, v213, v214
  v_mfma_f32_32x32x16_bf16 v[176:191], a[116:119], v[148:151], v[176:191]
  v_max3_f32 v246, v246, v111, v112
  v_fma_f32 v60, v60, s81, -v242
  v_fma_f32 v61, v61, s81, -v242
  v_exp_f32 v58, v58
  v_mfma_f32_32x32x16_bf16 v[160:175], a[88:91], v[152:155], v[160:175]
  buffer_load_dwordx4 v224, s[40:43], s84 offen nt lds
  v_exp_f32 v59, v59
  v_add_f32 v244, v244, v54
  v_mfma_f32_32x32x16_bf16 v[176:191], a[120:123], v[152:155], v[176:191]
  v_add_f32 v245, v245, v55
  v_max3_f32 v247, v247, v215, v216
  v_max3_f32 v246, v246, v113, v114
  v_fma_f32 v62, v62, s81, -v242
  v_fma_f32 v63, v63, s81, -v242
  v_mfma_f32_32x32x16_bf16 v[160:175], a[92:95], v[156:159], v[160:175]
  v_exp_f32 v60, v60
  v_exp_f32 v61, v61
  v_add_f32 v244, v244, v56
  v_add_f32 v245, v245, v57
  v_mfma_f32_32x32x16_bf16 v[176:191], a[124:127], v[156:159], v[176:191]
  v_max3_f32 v247, v247, v217, v218
  v_max3_f32 v246, v246, v115, v116
  v_fma_f32 v192, v192, s81, -v242
  v_fma_f32 v193, v193, s81, -v242
  v_exp_f32 v62, v62
  v_exp_f32 v63, v63
  v_add_f32 v244, v244, v58
  v_add_f32 v245, v245, v59
  v_fma_f32 v194, v194, s81, -v242
  v_fma_f32 v195, v195, s81, -v242
  v_max3_f32 v247, v247, v219, v220
  v_max3_f32 v246, v246, v117, v118
  v_exp_f32 v192, v192
  v_exp_f32 v193, v193
  v_add_f32 v244, v244, v60
  v_add_f32 v245, v245, v61
  v_fma_f32 v196, v196, s81, -v242
  v_fma_f32 v197, v197, s81, -v242
  v_exp_f32 v194, v194
  v_exp_f32 v195, v195
  v_max3_f32 v247, v247, v221, v222
  v_max3_f32 v246, v246, v119, v223
  v_add_f32 v244, v244, v62
  v_add_f32 v245, v245, v63
  v_fma_f32 v198, v198, s81, -v242
  v_fma_f32 v199, v199, s81, -v242
  v_exp_f32 v196, v196
  v_exp_f32 v197, v197
  buffer_load_dwordx4 v224, s[40:43], s84 offen offset:1024 nt lds
  v_max_f32 v246, v246, v247
  v_add_f32 v244, v244, v192
  v_add_f32 v245, v245, v193
  v_fma_f32 v200, v200, s81, -v242
  v_fma_f32 v201, v201, s81, -v242
  v_exp_f32 v198, v198
  v_exp_f32 v199, v199
  v_mov_b32 v247, v246
  v_add_f32 v244, v244, v194
  v_add_f32 v245, v245, v195
  v_fma_f32 v202, v202, s81, -v242
  v_fma_f32 v203, v203, s81, -v242
  v_exp_f32 v200, v200
  v_exp_f32 v201, v201
  v_add_f32 v244, v244, v196
  v_add_f32 v245, v245, v197
  v_fma_f32 v204, v204, s81, -v242
  v_fma_f32 v205, v205, s81, -v242
  v_exp_f32 v202, v202
  v_exp_f32 v203, v203
  v_permlane32_swap_b32 v246, v247
  v_add_f32 v244, v244, v198
  v_add_f32 v245, v245, v199
  v_fma_f32 v206, v206, s81, -v242
  v_fma_f32 v207, v207, s81, -v242
  v_exp_f32 v204, v204
  v_exp_f32 v205, v205
  v_max_f32 v246, v246, v247
  v_add_f32 v244, v244, v200
  v_add_f32 v245, v245, v201
  v_exp_f32 v206, v206
  v_exp_f32 v207, v207
  v_mul_f32 v246, s81, v246
  v_add_f32 v244, v244, v202
  v_add_f32 v245, v245, v203
  v_fma_f32 v96, v96, s81, -v246
  v_fma_f32 v97, v97, s81, -v246
  v_fma_f32 v98, v98, s81, -v246
  v_fma_f32 v99, v99, s81, -v246
  v_add_f32 v244, v244, v204
  v_add_f32 v245, v245, v205
  v_fma_f32 v100, v100, s81, -v246
  v_fma_f32 v101, v101, s81, -v246
  v_exp_f32 v96, v96
  v_exp_f32 v97, v97
  buffer_load_dwordx4 v224, s[40:43], s84 offen offset:2048 nt lds
  v_exp_f32 v98, v98
  v_exp_f32 v99, v99
  v_add_f32 v244, v244, v206
  v_add_f32 v245, v245, v207
  v_fma_f32 v102, v102, s81, -v246
  v_fma_f32 v103, v103, s81, -v246
  v_exp_f32 v100, v100
  v_exp_f32 v101, v101
  v_add_f32 v244, v244, v245
  v_fma_f32 v104, v104, s81, -v246
  v_fma_f32 v105, v105, s81, -v246
  v_exp_f32 v102, v102
  v_exp_f32 v103, v103
  v_mov_b32 v245, v244
  v_add_f32 v248, v96, v97
  v_add_f32 v249, v98, v99
  v_fma_f32 v106, v106, s81, -v246
  v_fma_f32 v107, v107, s81, -v246
  v_exp_f32 v104, v104
  v_exp_f32 v105, v105
  v_add_f32 v248, v248, v100
  v_add_f32 v249, v249, v101
  v_fma_f32 v108, v108, s81, -v246
  v_fma_f32 v109, v109, s81, -v246
  v_exp_f32 v106, v106
  v_exp_f32 v107, v107
  v_permlane32_swap_b32 v244, v245
  v_add_f32 v248, v248, v102
  v_add_f32 v249, v249, v103
  v_fma_f32 v110, v110, s81, -v246
  v_fma_f32 v111, v111, s81, -v246
  v_exp_f32 v108, v108
  v_exp_f32 v109, v109
  v_add_f32 v244, v244, v245
  v_add_f32 v248, v248, v104
  v_add_f32 v249, v249, v105
  v_fma_f32 v112, v112, s81, -v246
  v_fma_f32 v113, v113, s81, -v246
  v_exp_f32 v110, v110
  v_exp_f32 v111, v111
  v_rcp_f32 v244, v244
  v_add_f32 v248, v248, v106
  buffer_load_dwordx4 v224, s[40:43], s84 offen offset:3072 nt lds
  s_add_u32 m0, s85, 4096
  s_mov_b32 s84, 20480
  s_lshl_b32 s75, s87, 3
  s_add_u32 s75, s75, s70
  s_sub_u32 s76, s85, s74
  s_lshl_b32 s80, s73, 1
  s_add_u32 s20, s30, 0
  s_and_b32 s20, s20, 3
  s_add_u32 s20, s20, s80
  s_and_b32 s20, s20, 15
  s_lshl_b32 s80, s73, 1
  s_add_u32 s21, s30, 1
  s_and_b32 s21, s21, 3
  s_add_u32 s21, s21, s80
  s_and_b32 s21, s21, 15
  s_lshl_b32 s80, s73, 1
  s_add_u32 s22, s30, 2
  s_and_b32 s22, s22, 3
  s_add_u32 s22, s22, s80
  s_and_b32 s22, s22, 15
  s_lshl_b32 s80, s73, 1
  s_add_u32 s23, s30, 3
  s_and_b32 s23, s23, 3
  s_add_u32 s23, s23, s80
  s_and_b32 s23, s23, 15
  s_lshl_b32 s24, s31, 7
  v_mov_b32 v252, s75
  s_lshl_b32 s25, s3, 7
  s_lshl_b32 s82, s20, 15
  v_cndmask_b32 v252, v254, v252, vcc
  s_add_u32 s82, s82, s24
  v_add_f32 v249, v249, v107
  v_fma_f32 v114, v114, s81, -v246
  v_fma_f32 v115, v115, s81, -v246
  v_exp_f32 v112, v112
  v_exp_f32 v113, v113
  v_add_f32 v248, v248, v108
  v_add_f32 v249, v249, v109
  v_fma_f32 v116, v116, s81, -v246
  v_fma_f32 v117, v117, s81, -v246
  v_exp_f32 v114, v114
  v_exp_f32 v115, v115
  v_add_f32 v248, v248, v110
  v_add_f32 v249, v249, v111
  v_mul_f32 v192, v244, v192
  v_mul_f32 v193, v244, v193
  v_mul_f32 v194, v244, v194
  v_mul_f32 v195, v244, v195
  v_mul_f32 v196, v244, v196
  v_mul_f32 v197, v244, v197
  v_mul_f32 v198, v244, v198
  v_mul_f32 v199, v244, v199
  v_mul_f32 v200, v244, v200
  v_mul_f32 v201, v244, v201
  v_mul_f32 v202, v244, v202
  buffer_load_dwordx4 v224, s[40:43], s84 offen nt lds
  v_mul_f32 v203, v244, v203
  v_mul_f32 v204, v244, v204
  v_mul_f32 v205, v244, v205
  v_mul_f32 v206, v244, v206
  v_mul_f32 v207, v244, v207
  v_fma_f32 v118, v118, s81, -v246
  v_fma_f32 v119, v119, s81, -v246
  v_exp_f32 v116, v116
  v_exp_f32 v117, v117
  v_add_f32 v248, v248, v112
  v_add_f32 v249, v249, v113
  v_cvt_pk_bf16_f32 v16, v192, v193
  v_cvt_pk_bf16_f32 v17, v194, v195
  v_cvt_pk_bf16_f32 v18, v196, v197
  v_cvt_pk_bf16_f32 v19, v198, v199
  v_cvt_pk_bf16_f32 v20, v200, v201
  v_cvt_pk_bf16_f32 v21, v202, v203
  v_cvt_pk_bf16_f32 v22, v204, v205
  v_cvt_pk_bf16_f32 v23, v206, v207
  v_mfma_f32_32x32x16_bf16 v[192:207], a[128:131], v[128:131], 0
  v_fma_f32 v120, v120, s81, -v246
  v_fma_f32 v121, v121, s81, -v246
  v_exp_f32 v118, v118
  v_add_f32 v248, v248, v114
  v_mfma_f32_32x32x16_bf16 v[192:207], a[132:135], v[132:135], v[192:207]
  v_exp_f32 v119, v119
  v_add_f32 v249, v249, v115
  v_fma_f32 v122, v122, s81, -v246
  v_fma_f32 v123, v123, s81, -v246
  v_mfma_f32_32x32x16_bf16 v[192:207], a[136:139], v[136:139], v[192:207]
  v_exp_f32 v120, v120
  v_exp_f32 v121, v121
  v_add_f32 v248, v248, v116
  v_add_f32 v249, v249, v117
  v_mfma_f32_32x32x16_bf16 v[192:207], a[140:143], v[140:143], v[192:207]
  v_fma_f32 v124, v124, s81, -v246
  v_fma_f32 v125, v125, s81, -v246
  v_exp_f32 v122, v122
  v_add_f32 v248, v248, v118
  v_mfma_f32_32x32x16_bf16 v[192:207], a[144:147], v[144:147], v[192:207]
  v_exp_f32 v123, v123
  buffer_load_dwordx4 v224, s[40:43], s84 offen offset:1024 nt lds
  v_add_f32 v249, v249, v119
  v_mfma_f32_32x32x16_bf16 v[192:207], a[148:151], v[148:151], v[192:207]
  v_fma_f32 v126, v126, s81, -v246
  v_fma_f32 v127, v127, s81, -v246
  v_exp_f32 v124, v124
  v_add_f32 v248, v248, v120
  v_mfma_f32_32x32x16_bf16 v[192:207], a[152:155], v[152:155], v[192:207]
  v_exp_f32 v125, v125
  v_add_f32 v249, v249, v121
  v_fma_f32 v208, v208, s81, -v246
  v_fma_f32 v209, v209, s81, -v246
  v_mfma_f32_32x32x16_bf16 v[192:207], a[156:159], v[156:159], v[192:207]
  v_exp_f32 v126, v126
  v_exp_f32 v127, v127
  v_add_f32 v248, v248, v122
  v_add_f32 v249, v249, v123
  v_fma_f32 v210, v210, s81, -v246
  v_fma_f32 v211, v211, s81, -v246
  v_exp_f32 v208, v208
  v_exp_f32 v209, v209
  v_add_f32 v248, v248, v124
  v_add_f32 v249, v249, v125
  v_fma_f32 v212, v212, s81, -v246
  v_fma_f32 v213, v213, s81, -v246
  v_exp_f32 v210, v210
  v_exp_f32 v211, v211
  v_add_f32 v248, v248, v126
  v_add_f32 v249, v249, v127
  v_fma_f32 v214, v214, s81, -v246
  v_fma_f32 v215, v215, s81, -v246
  v_exp_f32 v212, v212
  v_exp_f32 v213, v213
  v_add_f32 v248, v248, v208
  v_add_f32 v249, v249, v209
  v_fma_f32 v216, v216, s81, -v246
  v_fma_f32 v217, v217, s81, -v246
  v_exp_f32 v214, v214
  v_exp_f32 v215, v215
  v_add_f32 v248, v248, v210
  v_add_f32 v249, v249, v211
  v_fma_f32 v218, v218, s81, -v246
  buffer_load_dwordx4 v224, s[40:43], s84 offen offset:2048 nt lds
  v_fma_f32 v219, v219, s81, -v246
  v_exp_f32 v216, v216
  v_exp_f32 v217, v217
  v_add_f32 v248, v248, v212
  v_add_f32 v249, v249, v213
  v_fma_f32 v220, v220, s81, -v246
  v_fma_f32 v221, v221, s81, -v246
  v_exp_f32 v218, v218
  v_exp_f32 v219, v219
  v_add_f32 v248, v248, v214
  v_add_f32 v249, v249, v215
  ds_read_b64_tr_b16 a[52:53], v227 offset:4096
  ds_read_b64_tr_b16 a[54:55], v227 offset:6144
  v_fma_f32 v222, v222, s81, -v246
  v_fma_f32 v223, v223, s81, -v246
  v_exp_f32 v220, v220
  v_exp_f32 v221, v221
  v_add_f32 v248, v248, v216
  v_add_f32 v249, v249, v217
  ds_read_b64_tr_b16 a[220:221], v228 offset:4096
  ds_read_b64_tr_b16 a[222:223], v228 offset:6144
  v_exp_f32 v222, v222
  v_exp_f32 v223, v223
  s_waitcnt vmcnt(11)
  ds_read_b64_tr_b16 a[8:9], v225 offset:8192
  ds_read_b64_tr_b16 a[10:11], v225 offset:10240
  v_add_f32 v248, v248, v218
  v_add_f32 v249, v249, v219
  ds_read_b64_tr_b16 a[32:33], v226 offset:8192
  ds_read_b64_tr_b16 a[34:35], v226 offset:10240
  v_add_f32 v248, v248, v220
  v_add_f32 v249, v249, v221
  v_add_f32 v248, v248, v222
  v_add_f32 v249, v249, v223
  ds_read_b64_tr_b16 a[56:57], v227 offset:8192
  ds_read_b64_tr_b16 a[58:59], v227 offset:10240
  v_add_f32 v248, v248, v249
  ds_read_b64_tr_b16 a[224:225], v228 offset:8192
  ds_read_b64_tr_b16 a[226:227], v228 offset:10240
  s_waitcnt vmcnt(7)
  ds_read_b64_tr_b16 a[12:13], v225 offset:12288
  ds_read_b64_tr_b16 a[14:15], v225 offset:14336
  v_mov_b32 v249, v248
  ds_read_b64_tr_b16 a[36:37], v226 offset:12288
  ds_read_b64_tr_b16 a[38:39], v226 offset:14336
  v_permlane32_swap_b32 v248, v249
  ds_read_b64_tr_b16 a[60:61], v227 offset:12288
  ds_read_b64_tr_b16 a[62:63], v227 offset:14336
  buffer_load_dwordx4 v224, s[40:43], s84 offen offset:3072 nt lds
  s_add_u32 m0, s74, 0
  v_mul_f32 v32, v244, v32
  v_mul_f32 v33, v244, v33
  v_mul_f32 v34, v244, v34
  v_mul_f32 v35, v244, v35
  v_mul_f32 v36, v244, v36
  v_mul_f32 v37, v244, v37
  v_mul_f32 v38, v244, v38
  v_mul_f32 v39, v244, v39
  v_add_u32 v225, s76, v225
  v_add_f32 v248, v248, v249
  ds_read_b64_tr_b16 a[228:229], v228 offset:12288
  ds_read_b64_tr_b16 a[230:231], v228 offset:14336
  v_cvt_pk_bf16_f32 v0, v32, v33
  v_cvt_pk_bf16_f32 v1, v34, v35
  v_cvt_pk_bf16_f32 v2, v36, v37
  v_cvt_pk_bf16_f32 v3, v38, v39
  v_add_u32 v226, s76, v226
  v_mul_f32 v40, v244, v40
  v_mul_f32 v41, v244, v41
  v_mul_f32 v42, v244, v42
  v_mul_f32 v43, v244, v43
  v_mul_f32 v44, v244, v44
  v_mul_f32 v45, v244, v45
  v_mul_f32 v46, v244, v46
  v_mul_f32 v47, v244, v47
  v_rcp_f32 v248, v248
  v_cvt_pk_bf16_f32 v4, v40, v41
  v_cvt_pk_bf16_f32 v5, v42, v43
  v_cvt_pk_bf16_f32 v6, v44, v45
  v_cvt_pk_bf16_f32 v7, v46, v47
  s_waitcnt lgkmcnt(15)
  v_mfma_f32_32x32x16_bf16 v[32:47], a[0:3], v[0:3], 0
  v_add_u32 v227, s76, v227
  v_mul_f32 v48, v244, v48
  v_mul_f32 v49, v244, v49
  v_mul_f32 v50, v244, v50
  v_mul_f32 v51, v244, v51
  v_mul_f32 v52, v244, v52
  v_mfma_f32_32x32x16_bf16 v[32:47], a[4:7], v[4:7], v[32:47]
  v_mul_f32 v53, v244, v53
  v_mul_f32 v54, v244, v54
  v_mul_f32 v55, v244, v55
  v_mul_f32 v56, v244, v56
  v_mul_f32 v57, v244, v57
  v_mul_f32 v58, v244, v58
  v_mul_f32 v59, v244, v59
  v_mul_f32 v60, v244, v60
  v_mul_f32 v61, v244, v61
  v_mul_f32 v62, v244, v62
  v_mul_f32 v63, v244, v63
  v_cvt_pk_bf16_f32 v8, v48, v49
  v_cvt_pk_bf16_f32 v9, v50, v51
  v_cvt_pk_bf16_f32 v10, v52, v53
  v_cvt_pk_bf16_f32 v11, v54, v55
  buffer_store_byte v253, v252, s[60:63], 0 offen sc0 sc1
  s_waitcnt lgkmcnt(14)
  v_mfma_f32_32x32x16_bf16 v[32:47], a[8:11], v[8:11], v[32:47]
  buffer_load_dwordx4 v232, s[48:51], s82 offen lds
  v_cvt_pk_bf16_f32 v12, v56, v57
  v_cvt_pk_bf16_f32 v13, v58, v59
  v_cvt_pk_bf16_f32 v14, v60, v61
  v_cvt_pk_bf16_f32 v15, v62, v63
  v_mfma_f32_32x32x16_bf16 v[48:63], a[24:27], v[0:3], 0
  v_add_u32 v228, s76, v228
  v_mul_f32 v96, v248, v96
  v_mul_f32 v97, v248, v97
  v_mul_f32 v98, v248, v98
  v_mul_f32 v99, v248, v99
  v_mul_f32 v100, v248, v100
  v_mfma_f32_32x32x16_bf16 v[48:63], a[28:31], v[4:7], v[48:63]
  buffer_load_dwordx4 v233, s[48:51], s82 offen offset:1024 lds
  v_mul_f32 v101, v248, v101
  v_mul_f32 v102, v248, v102
  v_mul_f32 v103, v248, v103
  s_waitcnt lgkmcnt(12)
  v_mfma_f32_32x32x16_bf16 v[48:63], a[32:35], v[8:11], v[48:63]
  v_mul_f32 v104, v248, v104
  v_mul_f32 v105, v248, v105
  v_mul_f32 v106, v248, v106
  v_mul_f32 v107, v248, v107
  v_mul_f32 v108, v248, v108
  v_mul_f32 v109, v248, v109
  s_waitcnt lgkmcnt(6)
  v_mfma_f32_32x32x16_bf16 v[32:47], a[12:15], v[12:15], v[32:47]
  buffer_load_dwordx4 v234, s[48:51], s82 offen offset:2048 lds
  v_mul_f32 v110, v248, v110
  v_mul_f32 v111, v248, v111
  v_mul_f32 v112, v248, v112
  s_waitcnt lgkmcnt(4)
  v_mfma_f32_32x32x16_bf16 v[48:63], a[36:39], v[12:15], v[48:63]
  v_cvt_pk_bf16_f32 v64, v96, v97
  v_cvt_pk_bf16_f32 v65, v98, v99
  v_cvt_pk_bf16_f32 v66, v100, v101
  v_cvt_pk_bf16_f32 v67, v102, v103
  v_cvt_pk_bf16_f32 v68, v104, v105
  v_cvt_pk_bf16_f32 v69, v106, v107
  v_cvt_pk_bf16_f32 v70, v108, v109
  buffer_load_dwordx4 v235, s[48:51], s82 offen offset:3072 lds
  v_cvt_pk_bf16_f32 v71, v110, v111
  v_mfma_f32_32x32x16_bf16 v[96:111], a[48:51], v[0:3], 0
  s_waitcnt vmcnt(9)
  ds_read_b64_tr_b16 a[16:17], v225
  ds_read_b64_tr_b16 a[18:19], v225 offset:2048
  ds_read_b64_tr_b16 a[40:41], v226
  ds_read_b64_tr_b16 a[42:43], v226 offset:2048
  v_mul_f32 v113, v248, v113
  v_mfma_f32_32x32x16_bf16 v[96:111], a[52:55], v[4:7], v[96:111]
  ds_read_b64_tr_b16 a[208:209], v227
  ds_read_b64_tr_b16 a[210:211], v227 offset:2048
  ds_read_b64_tr_b16 a[232:233], v228
  ds_read_b64_tr_b16 a[234:235], v228 offset:2048
  v_mul_f32 v114, v248, v114
  v_mfma_f32_32x32x16_bf16 v[96:111], a[56:59], v[8:11], v[96:111]
  v_mul_f32 v115, v248, v115
  v_mul_f32 v116, v248, v116
  v_mul_f32 v117, v248, v117
  v_mul_f32 v118, v248, v118
  v_mul_f32 v119, v248, v119
  v_mul_f32 v120, v248, v120
  s_waitcnt lgkmcnt(10)
  v_mfma_f32_32x32x16_bf16 v[96:111], a[60:63], v[12:15], v[96:111]
  v_mul_f32 v121, v248, v121
  v_mul_f32 v122, v248, v122
  v_mul_f32 v123, v248, v123
  v_mul_f32 v124, v248, v124
  v_mul_f32 v125, v248, v125
  v_mul_f32 v126, v248, v126
  v_mul_f32 v127, v248, v127
  v_cvt_pk_bf16_f32 v72, v112, v113
  v_cvt_pk_bf16_f32 v73, v114, v115
  v_cvt_pk_bf16_f32 v74, v116, v117
  v_cvt_pk_bf16_f32 v75, v118, v119
  v_cvt_pk_bf16_f32 v76, v120, v121
  s_waitcnt lgkmcnt(6)
  v_mfma_f32_32x32x16_bf16 v[32:47], a[16:19], v[16:19], v[32:47]
  v_cvt_pk_bf16_f32 v77, v122, v123
  v_cvt_pk_bf16_f32 v78, v124, v125
  v_cvt_pk_bf16_f32 v79, v126, v127
  v_max3_f32 v242, v160, v161, v162
  s_lshl_b32 s82, s21, 15
  v_mfma_f32_32x32x16_bf16 v[112:127], a[216:219], v[0:3], 0
  s_add_u32 s82, s82, s24
  v_max3_f32 v243, v184, v185, v186
  v_max3_f32 v242, v242, v163, v164
  s_add_u32 m0, s74, 4096
  v_max3_f32 v243, v243, v187, v188
  v_mfma_f32_32x32x16_bf16 v[112:127], a[220:223], v[4:7], v[112:127]
  v_max3_f32 v242, v242, v165, v166
  buffer_load_dwordx4 v232, s[48:51], s82 offen lds
  v_max3_f32 v243, v243, v189, v190
  v_mfma_f32_32x32x16_bf16 v[112:127], a[224:227], v[8:11], v[112:127]
  v_max3_f32 v242, v242, v167, v168
  v_max3_f32 v243, v243, v191, v192
  v_max3_f32 v242, v242, v169, v170
  v_max3_f32 v243, v243, v193, v194
  v_mul_f32 v208, v248, v208
  v_mfma_f32_32x32x16_bf16 v[112:127], a[228:231], v[12:15], v[112:127]
  v_max3_f32 v242, v242, v171, v172
  v_max3_f32 v243, v243, v195, v196
  v_max3_f32 v242, v242, v173, v174
  v_max3_f32 v243, v243, v197, v198
  v_mul_f32 v209, v248, v209
  s_waitcnt lgkmcnt(4)
  v_mfma_f32_32x32x16_bf16 v[48:63], a[40:43], v[16:19], v[48:63]
  v_max3_f32 v242, v242, v175, v176
  v_max3_f32 v243, v243, v199, v200
  v_max3_f32 v242, v242, v177, v178
  v_max3_f32 v243, v243, v201, v202
  v_mul_f32 v210, v248, v210
  s_waitcnt lgkmcnt(2)
  v_mfma_f32_32x32x16_bf16 v[96:111], a[208:211], v[16:19], v[96:111]
  v_max3_f32 v242, v242, v179, v180
  v_max3_f32 v243, v243, v203, v204
  v_max3_f32 v242, v242, v181, v182
  v_max3_f32 v243, v243, v205, v206
  v_mul_f32 v211, v248, v211
  s_waitcnt lgkmcnt(0)
  v_mfma_f32_32x32x16_bf16 v[112:127], a[232:235], v[16:19], v[112:127]
  v_max3_f32 v242, v242, v183, v207
  buffer_load_dwordx4 v233, s[48:51], s82 offen offset:1024 lds
  v_max_f32 v242, v242, v243
  v_mov_b32 v243, v242
  v_mul_f32 v212, v248, v212
  v_mul_f32 v213, v248, v213
  v_mul_f32 v214, v248, v214
  v_permlane32_swap_b32 v242, v243
  v_max_f32 v242, v242, v243
  v_mul_f32 v242, s81, v242
  v_fma_f32 v160, v160, s81, -v242
  v_fma_f32 v161, v161, s81, -v242
  v_fma_f32 v162, v162, s81, -v242
  v_fma_f32 v163, v163, s81, -v242
  v_fma_f32 v164, v164, s81, -v242
  v_fma_f32 v165, v165, s81, -v242
  v_exp_f32 v160, v160
  v_exp_f32 v161, v161
  v_exp_f32 v162, v162
  v_exp_f32 v163, v163
  v_fma_f32 v166, v166, s81, -v242
  v_fma_f32 v167, v167, s81, -v242
  v_exp_f32 v164, v164
  v_exp_f32 v165, v165
  buffer_load_dwordx4 v234, s[48:51], s82 offen offset:2048 lds
  v_fma_f32 v168, v168, s81, -v242
  v_fma_f32 v169, v169, s81, -v242
  v_exp_f32 v166, v166
  v_exp_f32 v167, v167
  v_add_f32 v244, v160, v161
  v_add_f32 v245, v162, v163
  v_fma_f32 v170, v170, s81, -v242
  v_fma_f32 v171, v171, s81, -v242
  v_exp_f32 v168, v168
  v_exp_f32 v169, v169
  v_add_f32 v244, v244, v164
  v_add_f32 v245, v245, v165
  v_fma_f32 v172, v172, s81, -v242
  v_fma_f32 v173, v173, s81, -v242
  v_exp_f32 v170, v170
  v_exp_f32 v171, v171
  v_add_f32 v244, v244, v166
  v_add_f32 v245, v245, v167
  v_fma_f32 v174, v174, s81, -v242
  v_fma_f32 v175, v175, s81, -v242
  v_exp_f32 v172, v172
  v_exp_f32 v173, v173
  v_add_f32 v244, v244, v168
  v_add_f32 v245, v245, v169
  v_fma_f32 v176, v176, s81, -v242
  v_fma_f32 v177, v177, s81, -v242
  v_exp_f32 v174, v174
  v_exp_f32 v175, v175
  v_add_f32 v244, v244, v170
  v_add_f32 v245, v245, v171
  v_fma_f32 v178, v178, s81, -v242
  v_fma_f32 v179, v179, s81, -v242
  v_exp_f32 v176, v176
  v_exp_f32 v177, v177
  v_add_f32 v244, v244, v172
  v_add_f32 v245, v245, v173
  v_fma_f32 v180, v180, s81, -v242
  v_fma_f32 v181, v181, s81, -v242
  v_exp_f32 v178, v178
  v_exp_f32 v179, v179
  v_add_f32 v244, v244, v174
  v_add_f32 v245, v245, v175
  v_fma_f32 v182, v182, s81, -v242
  v_fma_f32 v183, v183, s81, -v242
  v_exp_f32 v180, v180
  v_exp_f32 v181, v181
  v_add_f32 v244, v244, v176
  v_add_f32 v245, v245, v177
  v_fma_f32 v184, v184, s81, -v242
  v_fma_f32 v185, v185, s81, -v242
  v_exp_f32 v182, v182
  v_exp_f32 v183, v183
  v_add_f32 v244, v244, v178
  v_add_f32 v245, v245, v179
  buffer_load_dwordx4 v235, s[48:51], s82 offen offset:3072 lds
  v_fma_f32 v186, v186, s81, -v242
  v_fma_f32 v187, v187, s81, -v242
  v_exp_f32 v184, v184
  v_exp_f32 v185, v185
  v_add_f32 v244, v244, v180
  v_add_f32 v245, v245, v181
  v_fma_f32 v188, v188, s81, -v242
  v_fma_f32 v189, v189, s81, -v242
  v_exp_f32 v186, v186
  v_exp_f32 v187, v187
  v_add_f32 v244, v244, v182
  v_add_f32 v245, v245, v183
  v_fma_f32 v190, v190, s81, -v242
  v_fma_f32 v191, v191, s81, -v242
  v_exp_f32 v188, v188
  v_exp_f32 v189, v189
  v_add_f32 v244, v244, v184
  v_add_f32 v245, v245, v185
  v_fma_f32 v192, v192, s81, -v242
  v_fma_f32 v193, v193, s81, -v242
  v_mul_f32 v215, v248, v215
  v_exp_f32 v190, v190
  v_exp_f32 v191, v191
  v_add_f32 v244, v244, v186
  v_add_f32 v245, v245, v187
  v_fma_f32 v194, v194, s81, -v242
  v_fma_f32 v195, v195, s81, -v242
  s_waitcnt vmcnt(9)
  ds_read_b64_tr_b16 a[20:21], v225 offset:4096
  ds_read_b64_tr_b16 a[22:23], v225 offset:6144
  ds_read_b64_tr_b16 a[44:45], v226 offset:4096
  ds_read_b64_tr_b16 a[46:47], v226 offset:6144
  ds_read_b64_tr_b16 a[212:213], v227 offset:4096
  ds_read_b64_tr_b16 a[214:215], v227 offset:6144
  ds_read_b64_tr_b16 a[236:237], v228 offset:4096
  ds_read_b64_tr_b16 a[238:239], v228 offset:6144
  v_cvt_pk_bf16_f32 v80, v208, v209
  v_cvt_pk_bf16_f32 v81, v210, v211
  v_cvt_pk_bf16_f32 v82, v212, v213
  v_cvt_pk_bf16_f32 v83, v214, v215
  v_exp_f32 v192, v192
  v_exp_f32 v193, v193
  v_add_f32 v244, v244, v188
  v_add_f32 v245, v245, v189
  v_fma_f32 v196, v196, s81, -v242
  v_fma_f32 v197, v197, s81, -v242
  v_exp_f32 v194, v194
  v_exp_f32 v195, v195
  v_add_f32 v244, v244, v190
  v_add_f32 v245, v245, v191
  v_fma_f32 v198, v198, s81, -v242
  v_fma_f32 v199, v199, s81, -v242
  v_exp_f32 v196, v196
  v_exp_f32 v197, v197
  s_lshl_b32 s82, s22, 15
  s_waitcnt lgkmcnt(6)
  v_mfma_f32_32x32x16_bf16 v[32:47], a[20:23], v[20:23], v[32:47]
  v_add_f32 v244, v244, v192
  v_add_f32 v245, v245, v193
  v_fma_f32 v200, v200, s81, -v242
  v_fma_f32 v201, v201, s81, -v242
  v_mul_f32 v216, v248, v216
  s_waitcnt lgkmcnt(4)
  v_mfma_f32_32x32x16_bf16 v[48:63], a[44:47], v[20:23], v[48:63]
  v_mul_f32 v217, v248, v217
  v_mul_f32 v218, v248, v218
  v_mul_f32 v219, v248, v219
  v_mul_f32 v220, v248, v220
  v_mul_f32 v221, v248, v221
  v_mul_f32 v222, v248, v222
  s_waitcnt lgkmcnt(2)
  v_mfma_f32_32x32x16_bf16 v[96:111], a[212:215], v[20:23], v[96:111]
  v_cvt_pk_bf16_f32 v32, v32, v33
  v_cvt_pk_bf16_f32 v33, v34, v35
  v_cvt_pk_bf16_f32 v34, v36, v37
  v_cvt_pk_bf16_f32 v35, v38, v39
  v_mul_f32 v223, v248, v223
  s_waitcnt lgkmcnt(0)
  v_mfma_f32_32x32x16_bf16 v[112:127], a[236:239], v[20:23], v[112:127]
  v_cvt_pk_bf16_f32 v48, v48, v49
  v_cvt_pk_bf16_f32 v36, v40, v41
  v_cvt_pk_bf16_f32 v37, v42, v43
  v_cvt_pk_bf16_f32 v38, v44, v45
  v_cvt_pk_bf16_f32 v39, v46, v47
  v_cvt_pk_bf16_f32 v49, v50, v51
  ds_write_b128 v231, v[32:35]
  v_cvt_pk_bf16_f32 v50, v52, v53
  v_cvt_pk_bf16_f32 v51, v54, v55
  v_cvt_pk_bf16_f32 v96, v96, v97
  ds_write_b128 v231, v[36:39] offset:3072
  v_mfma_f32_32x32x16_bf16 v[32:47], a[0:3], v[64:67], 0
  v_cvt_pk_bf16_f32 v52, v56, v57
  v_cvt_pk_bf16_f32 v53, v58, v59
  v_cvt_pk_bf16_f32 v54, v60, v61
  v_cvt_pk_bf16_f32 v55, v62, v63
  s_add_u32 s82, s82, s24
  v_mfma_f32_32x32x16_bf16 v[32:47], a[4:7], v[68:71], v[32:47]
  v_cvt_pk_bf16_f32 v97, v98, v99
  ds_write_b128 v231, v[48:51] offset:6144
  v_cvt_pk_bf16_f32 v98, v100, v101
  v_cvt_pk_bf16_f32 v99, v102, v103
  v_add_f32 v244, v244, v194
  v_mfma_f32_32x32x16_bf16 v[32:47], a[8:11], v[72:75], v[32:47]
  v_cvt_pk_bf16_f32 v112, v112, v113
  ds_write_b128 v231, v[52:55] offset:9216
  v_cvt_pk_bf16_f32 v100, v104, v105
  v_cvt_pk_bf16_f32 v101, v106, v107
  v_add_f32 v245, v245, v195
  v_mfma_f32_32x32x16_bf16 v[48:63], a[24:27], v[64:67], 0
  v_cvt_pk_bf16_f32 v102, v108, v109
  v_cvt_pk_bf16_f32 v103, v110, v111
  v_cvt_pk_bf16_f32 v113, v114, v115
  ds_write_b128 v231, v[96:99] offset:12288
  s_add_u32 m0, s74, 8192
  v_mfma_f32_32x32x16_bf16 v[48:63], a[28:31], v[68:71], v[48:63]
  v_cvt_pk_bf16_f32 v114, v116, v117
  v_cvt_pk_bf16_f32 v115, v118, v119
  ds_write_b128 v231, v[100:103] offset:15360
  v_cvt_pk_bf16_f32 v116, v120, v121
  v_add_f32 v244, v244, v196
  v_mfma_f32_32x32x16_bf16 v[96:111], a[48:51], v[64:67], 0
  v_cvt_pk_bf16_f32 v117, v122, v123
  v_cvt_pk_bf16_f32 v118, v124, v125
  v_cvt_pk_bf16_f32 v119, v126, v127
  ds_write_b128 v231, v[112:115] offset:18432
  v_add_f32 v245, v245, v197
  v_mfma_f32_32x32x16_bf16 v[96:111], a[52:55], v[68:71], v[96:111]
  ds_write_b128 v231, v[116:119] offset:21504
  v_exp_f32 v198, v198
  v_exp_f32 v199, v199
  v_mfma_f32_32x32x16_bf16 v[112:127], a[216:219], v[64:67], 0
  v_fma_f32 v202, v202, s81, -v242
  v_fma_f32 v203, v203, s81, -v242
  v_cvt_pk_bf16_f32 v84, v216, v217
  v_cvt_pk_bf16_f32 v85, v218, v219
  v_add_f32 v244, v244, v198
  v_mfma_f32_32x32x16_bf16 v[112:127], a[220:223], v[68:71], v[112:127]
  v_cvt_pk_bf16_f32 v86, v220, v221
  v_cvt_pk_bf16_f32 v87, v222, v223
  v_exp_f32 v200, v200
  v_fma_f32 v204, v204, s81, -v242
  v_mfma_f32_32x32x16_bf16 v[48:63], a[32:35], v[72:75], v[48:63]
  v_exp_f32 v201, v201
  v_fma_f32 v205, v205, s81, -v242
  v_exp_f32 v202, v202
  v_mfma_f32_32x32x16_bf16 v[96:111], a[56:59], v[72:75], v[96:111]
  v_exp_f32 v203, v203
  buffer_load_dwordx4 v232, s[48:51], s82 offen lds
  v_add_f32 v245, v245, v199
  v_mfma_f32_32x32x16_bf16 v[112:127], a[224:227], v[72:75], v[112:127]
  v_fma_f32 v206, v206, s81, -v242
  v_fma_f32 v207, v207, s81, -v242
  v_exp_f32 v204, v204
  v_add_f32 v244, v244, v200
  v_mfma_f32_32x32x16_bf16 v[32:47], a[12:15], v[76:79], v[32:47]
  v_exp_f32 v205, v205
  v_add_f32 v245, v245, v201
  v_exp_f32 v206, v206
  v_add_f32 v244, v244, v202
  v_mfma_f32_32x32x16_bf16 v[48:63], a[36:39], v[76:79], v[48:63]
  v_exp_f32 v207, v207
  v_add_f32 v245, v245, v203
  v_add_f32 v244, v244, v204
  v_add_f32 v245, v245, v205
  v_add_f32 v244, v244, v206
  v_mfma_f32_32x32x16_bf16 v[96:111], a[60:63], v[76:79], v[96:111]
  v_add_f32 v245, v245, v207
  v_add_f32 v244, v244, v245
  v_mov_b32 v245, v244
  buffer_load_dwordx4 v233, s[48:51], s82 offen offset:1024 lds
  v_mfma_f32_32x32x16_bf16 v[112:127], a[228:231], v[76:79], v[112:127]
  v_permlane32_swap_b32 v244, v245
  v_add_f32 v244, v244, v245
  v_rcp_f32 v244, v244
  s_waitcnt vmcnt(6)
  ds_read_b64_tr_b16 a[176:177], v236
  v_mfma_f32_32x32x16_bf16 v[32:47], a[16:19], v[80:83], v[32:47]
  v_mul_f32 v160, v244, v160
  v_mul_f32 v161, v244, v161
  v_mul_f32 v162, v244, v162
  v_mul_f32 v163, v244, v163
  v_mul_f32 v164, v244, v164
  v_mul_f32 v165, v244, v165
  v_mfma_f32_32x32x16_bf16 v[48:63], a[40:43], v[80:83], v[48:63]
  v_mul_f32 v166, v244, v166
  v_mul_f32 v167, v244, v167
  v_cvt_pk_bf16_f32 v128, v160, v161
  v_cvt_pk_bf16_f32 v129, v162, v163
  v_cvt_pk_bf16_f32 v130, v164, v165
  v_mfma_f32_32x32x16_bf16 v[96:111], a[208:211], v[80:83], v[96:111]
  v_cvt_pk_bf16_f32 v131, v166, v167
  v_mul_f32 v168, v244, v168
  v_mul_f32 v169, v244, v169
  v_mul_f32 v170, v244, v170
  v_mul_f32 v171, v244, v171
  v_mfma_f32_32x32x16_bf16 v[112:127], a[232:235], v[80:83], v[112:127]
  v_mul_f32 v172, v244, v172
  v_mul_f32 v173, v244, v173
  v_mul_f32 v174, v244, v174
  v_mul_f32 v175, v244, v175
  v_cvt_pk_bf16_f32 v132, v168, v169
  v_mfma_f32_32x32x16_bf16 v[32:47], a[20:23], v[84:87], v[32:47]
  v_cvt_pk_bf16_f32 v133, v170, v171
  v_cvt_pk_bf16_f32 v134, v172, v173
  v_cvt_pk_bf16_f32 v135, v174, v175
  v_mul_f32 v176, v244, v176
  v_mul_f32 v177, v244, v177
  v_mfma_f32_32x32x16_bf16 v[48:63], a[44:47], v[84:87], v[48:63]
  buffer_load_dwordx4 v234, s[48:51], s82 offen offset:2048 lds
  v_mul_f32 v178, v244, v178
  v_mul_f32 v179, v244, v179
  v_mul_f32 v180, v244, v180
  v_mfma_f32_32x32x16_bf16 v[96:111], a[212:215], v[84:87], v[96:111]
  s_nop 0
  v_cvt_pk_bf16_f32 v32, v32, v33
  v_cvt_pk_bf16_f32 v33, v34, v35
  v_cvt_pk_bf16_f32 v34, v36, v37
  v_cvt_pk_bf16_f32 v35, v38, v39
  v_mul_f32 v181, v244, v181
  v_mfma_f32_32x32x16_bf16 v[112:127], a[236:239], v[84:87], v[112:127]
  v_cvt_pk_bf16_f32 v48, v48, v49
  v_cvt_pk_bf16_f32 v36, v40, v41
  v_cvt_pk_bf16_f32 v37, v42, v43
  v_cvt_pk_bf16_f32 v38, v44, v45
  v_cvt_pk_bf16_f32 v39, v46, v47
  v_cvt_pk_bf16_f32 v49, v50, v51
  ds_write_b128 v231, v[32:35] offset:1024
  v_cvt_pk_bf16_f32 v50, v52, v53
  v_cvt_pk_bf16_f32 v51, v54, v55
  v_cvt_pk_bf16_f32 v96, v96, v97
  ds_write_b128 v231, v[36:39] offset:4096
  v_mfma_f32_32x32x16_bf16 v[32:47], a[0:3], v[128:131], 0
  v_cvt_pk_bf16_f32 v52, v56, v57
  v_cvt_pk_bf16_f32 v53, v58, v59
  v_cvt_pk_bf16_f32 v54, v60, v61
  v_cvt_pk_bf16_f32 v55, v62, v63
  v_mul_f32 v182, v244, v182
  v_mfma_f32_32x32x16_bf16 v[32:47], a[4:7], v[132:135], v[32:47]
  v_cvt_pk_bf16_f32 v97, v98, v99
  ds_write_b128 v231, v[48:51] offset:7168
  v_cvt_pk_bf16_f32 v98, v100, v101
  v_cvt_pk_bf16_f32 v99, v102, v103
  v_cvt_pk_bf16_f32 v112, v112, v113
  ds_write_b128 v231, v[52:55] offset:10240
  v_mfma_f32_32x32x16_bf16 v[48:63], a[24:27], v[128:131], 0
  v_cvt_pk_bf16_f32 v100, v104, v105
  v_cvt_pk_bf16_f32 v101, v106, v107
  v_cvt_pk_bf16_f32 v102, v108, v109
  v_cvt_pk_bf16_f32 v103, v110, v111
  v_mul_f32 v183, v244, v183
  v_mfma_f32_32x32x16_bf16 v[48:63], a[28:31], v[132:135], v[48:63]
  v_cvt_pk_bf16_f32 v113, v114, v115
  ds_write_b128 v231, v[96:99] offset:13312
  v_cvt_pk_bf16_f32 v114, v116, v117
  v_cvt_pk_bf16_f32 v115, v118, v119
  ds_write_b128 v231, v[100:103] offset:16384
  v_mfma_f32_32x32x16_bf16 v[96:111], a[48:51], v[128:131], 0
  v_cvt_pk_bf16_f32 v116, v120, v121
  v_cvt_pk_bf16_f32 v117, v122, v123
  v_cvt_pk_bf16_f32 v118, v124, v125
  v_cvt_pk_bf16_f32 v119, v126, v127
  v_mul_f32 v184, v244, v184
  v_mfma_f32_32x32x16_bf16 v[96:111], a[52:55], v[132:135], v[96:111]
  ds_write_b128 v231, v[112:115] offset:19456
  ds_write_b128 v231, v[116:119] offset:22528
  v_cvt_pk_bf16_f32 v136, v176, v177
  v_cvt_pk_bf16_f32 v137, v178, v179
  v_mul_f32 v185, v244, v185
  v_mfma_f32_32x32x16_bf16 v[112:127], a[216:219], v[128:131], 0
  v_cvt_pk_bf16_f32 v138, v180, v181
  v_cvt_pk_bf16_f32 v139, v182, v183
  v_mul_f32 v186, v244, v186
  v_mul_f32 v187, v244, v187
  v_mul_f32 v188, v244, v188
  v_mfma_f32_32x32x16_bf16 v[112:127], a[220:223], v[132:135], v[112:127]
  v_mul_f32 v189, v244, v189
  v_mul_f32 v190, v244, v190
  v_mul_f32 v191, v244, v191
  v_cvt_pk_bf16_f32 v140, v184, v185
  v_cvt_pk_bf16_f32 v141, v186, v187
  v_mfma_f32_32x32x16_bf16 v[32:47], a[8:11], v[136:139], v[32:47]
  v_cvt_pk_bf16_f32 v142, v188, v189
  v_cvt_pk_bf16_f32 v143, v190, v191
  buffer_load_dwordx4 v235, s[48:51], s82 offen offset:3072 lds
  v_mfma_f32_32x32x16_bf16 v[48:63], a[32:35], v[136:139], v[48:63]
  v_mul_f32 v192, v244, v192
  v_mul_f32 v193, v244, v193
  v_mul_f32 v194, v244, v194
  v_mul_f32 v195, v244, v195
  v_mul_f32 v196, v244, v196
  v_mul_f32 v197, v244, v197
  v_mfma_f32_32x32x16_bf16 v[96:111], a[56:59], v[136:139], v[96:111]
  v_mul_f32 v198, v244, v198
  v_mul_f32 v199, v244, v199
  v_cvt_pk_bf16_f32 v144, v192, v193
  v_cvt_pk_bf16_f32 v145, v194, v195
  v_cvt_pk_bf16_f32 v146, v196, v197
  v_mfma_f32_32x32x16_bf16 v[112:127], a[224:227], v[136:139], v[112:127]
  v_cvt_pk_bf16_f32 v147, v198, v199
  v_mul_f32 v200, v244, v200
  v_mul_f32 v201, v244, v201
  v_mul_f32 v202, v244, v202
  v_mul_f32 v203, v244, v203
  v_mfma_f32_32x32x16_bf16 v[32:47], a[12:15], v[140:143], v[32:47]
  v_mul_f32 v204, v244, v204
  v_mul_f32 v205, v244, v205
  v_mul_f32 v206, v244, v206
  v_mul_f32 v207, v244, v207
  v_cvt_pk_bf16_f32 v148, v200, v201
  v_mfma_f32_32x32x16_bf16 v[48:63], a[36:39], v[140:143], v[48:63]
  v_cvt_pk_bf16_f32 v149, v202, v203
  v_cvt_pk_bf16_f32 v150, v204, v205
  v_cvt_pk_bf16_f32 v151, v206, v207
  s_lshl_b32 s82, s23, 15
  s_add_u32 s82, s82, s24
  v_mfma_f32_32x32x16_bf16 v[96:111], a[60:63], v[140:143], v[96:111]
  s_add_u32 m0, s74, 12288
  ds_read_b64_tr_b16 a[178:179], v236 offset:1024
  buffer_load_dwordx4 v232, s[48:51], s82 offen lds
  v_mfma_f32_32x32x16_bf16 v[112:127], a[228:231], v[140:143], v[112:127]
  ds_read_b64_tr_b16 a[180:181], v237
  ds_read_b64_tr_b16 a[182:183], v237 offset:1024
  ds_read_b64_tr_b16 a[184:185], v238
  ds_read_b64_tr_b16 a[186:187], v238 offset:1024
  v_mfma_f32_32x32x16_bf16 v[32:47], a[16:19], v[144:147], v[32:47]
  ds_read_b64_tr_b16 a[188:189], v239
  ds_read_b64_tr_b16 a[190:191], v239 offset:1024
  buffer_load_dwordx4 v233, s[48:51], s82 offen offset:1024 lds
  v_mfma_f32_32x32x16_bf16 v[48:63], a[40:43], v[144:147], v[48:63]
  v_mfma_f32_32x32x16_bf16 v[96:111], a[208:211], v[144:147], v[96:111]
  v_mfma_f32_32x32x16_bf16 v[112:127], a[232:235], v[144:147], v[112:127]
  buffer_load_dwordx4 v234, s[48:51], s82 offen offset:2048 lds
  v_mfma_f32_32x32x16_bf16 v[32:47], a[20:23], v[148:151], v[32:47]
  v_mfma_f32_32x32x16_bf16 v[48:63], a[44:47], v[148:151], v[48:63]
  buffer_load_dwordx4 v235, s[48:51], s82 offen offset:3072 lds
  v_mfma_f32_32x32x16_bf16 v[96:111], a[212:215], v[148:151], v[96:111]
  s_nop 8
  v_cvt_pk_bf16_f32 v32, v32, v33
  v_cvt_pk_bf16_f32 v33, v34, v35
  v_cvt_pk_bf16_f32 v34, v36, v37
  v_cvt_pk_bf16_f32 v35, v38, v39
  v_mfma_f32_32x32x16_bf16 v[112:127], a[236:239], v[148:151], v[112:127]
  v_cvt_pk_bf16_f32 v48, v48, v49
  v_cvt_pk_bf16_f32 v36, v40, v41
  v_cvt_pk_bf16_f32 v37, v42, v43
  v_cvt_pk_bf16_f32 v38, v44, v45
  v_cvt_pk_bf16_f32 v39, v46, v47
  v_cvt_pk_bf16_f32 v49, v50, v51
  ds_write_b128 v231, v[32:35] offset:2048
  v_cvt_pk_bf16_f32 v50, v52, v53
  v_cvt_pk_bf16_f32 v51, v54, v55
  v_cvt_pk_bf16_f32 v96, v96, v97
  ds_write_b128 v231, v[36:39] offset:5120
  v_cvt_pk_bf16_f32 v52, v56, v57
  v_cvt_pk_bf16_f32 v53, v58, v59
  v_cvt_pk_bf16_f32 v54, v60, v61
  v_cvt_pk_bf16_f32 v55, v62, v63
  v_cvt_pk_bf16_f32 v97, v98, v99
  ds_write_b128 v231, v[48:51] offset:8192
  v_cvt_pk_bf16_f32 v98, v100, v101
  v_cvt_pk_bf16_f32 v99, v102, v103
  v_cvt_pk_bf16_f32 v112, v112, v113
  ds_write_b128 v231, v[52:55] offset:11264
  v_cvt_pk_bf16_f32 v100, v104, v105
  v_cvt_pk_bf16_f32 v101, v106, v107
  v_cvt_pk_bf16_f32 v102, v108, v109
  v_cvt_pk_bf16_f32 v103, v110, v111
  v_cvt_pk_bf16_f32 v113, v114, v115
  ds_write_b128 v231, v[96:99] offset:14336
  v_cvt_pk_bf16_f32 v114, v116, v117
  v_cvt_pk_bf16_f32 v115, v118, v119
  ds_write_b128 v231, v[100:103] offset:17408
  v_cvt_pk_bf16_f32 v116, v120, v121
  v_cvt_pk_bf16_f32 v117, v122, v123
  v_cvt_pk_bf16_f32 v118, v124, v125
  v_cvt_pk_bf16_f32 v119, v126, v127
  ds_write_b128 v231, v[112:115] offset:20480
  ds_write_b128 v231, v[116:119] offset:23552
  s_waitcnt lgkmcnt(0)
  s_barrier
  v_lshrrev_b32 v252, 4, v241
  v_lshrrev_b32 v253, 5, v252
  v_mul_u32_u24 v253, 3072, v253
  v_bfe_u32 v254, v252, 4, 1
  v_lshlrev_b32 v254, 9, v254
  v_and_b32 v222, 15, v252
  v_lshlrev_b32 v222, 4, v222
  v_add3_u32 v222, v222, v253, v254
  s_mul_i32 s83, s20, 6144
  v_add_u32 v240, s83, v222
  ds_read_b128 a[208:211], v240
  ds_read_b128 a[212:215], v240 offset:256
  ds_read_b128 a[216:219], v240 offset:1024
  ds_read_b128 a[220:223], v240 offset:1280
  ds_read_b128 a[224:227], v240 offset:2048
  ds_read_b128 a[228:231], v240 offset:2304
  v_lshlrev_b32 v218, 7, v252
  v_add_u32 v253, 8192, v218
  v_cmp_gt_u32 vcc, 32, v252
  v_mov_b32 v254, 0x7ffffff0
  s_nop 0
  v_cndmask_b32 v219, v254, v253, vcc
  s_waitcnt lgkmcnt(5)
  v_mfma_f32_16x16x32_bf16 v[0:3], a[176:179], a[208:211], 0
  s_mul_i32 s83, s21, 6144
  s_add_u32 s20, s20, 4
  v_mfma_f32_16x16x32_bf16 v[4:7], a[180:183], a[208:211], 0
  v_add_u32 v240, s83, v222
  s_and_b32 s20, s20, 15
  v_mfma_f32_16x16x32_bf16 v[8:11], a[184:187], a[208:211], 0
  ds_read_b128 a[232:235], v240
  v_mfma_f32_16x16x32_bf16 v[12:15], a[188:191], a[208:211], 0
  ds_read_b128 a[236:239], v240 offset:256
  s_waitcnt lgkmcnt(6)
  v_mfma_f32_16x16x32_bf16 v[16:19], a[176:179], a[212:215], 0
  ds_read_b128 a[240:243], v240 offset:1024
  v_mfma_f32_16x16x32_bf16 v[20:23], a[180:183], a[212:215], 0
  ds_read_b128 a[244:247], v240 offset:1280
  v_mfma_f32_16x16x32_bf16 v[24:27], a[184:187], a[212:215], 0
  ds_read_b128 a[248:251], v240 offset:2048
  v_mfma_f32_16x16x32_bf16 v[28:31], a[188:191], a[212:215], 0
  ds_read_b128 a[252:255], v240 offset:2304
  s_waitcnt lgkmcnt(9)
  v_mfma_f32_16x16x32_bf16 v[32:35], a[176:179], a[216:219], 0
  s_lshl_b32 s82, s20, 15
  s_add_u32 s82, s82, s24
  v_mfma_f32_16x16x32_bf16 v[36:39], a[180:183], a[216:219], 0
  s_add_u32 m0, s74, 0
  v_mfma_f32_16x16x32_bf16 v[40:43], a[184:187], a[216:219], 0
  s_waitcnt vmcnt(8)
  ds_read_b64_tr_b16 a[192:193], v236 offset:4096
  v_mfma_f32_16x16x32_bf16 v[44:47], a[188:191], a[216:219], 0
  ds_read_b64_tr_b16 a[194:195], v236 offset:5120
  s_waitcnt lgkmcnt(10)
  v_mfma_f32_16x16x32_bf16 v[48:51], a[176:179], a[220:223], 0
  buffer_load_dwordx4 v232, s[48:51], s82 offen lds
  v_mfma_f32_16x16x32_bf16 v[52:55], a[180:183], a[220:223], 0
  ds_read_b64_tr_b16 a[196:197], v237 offset:4096
  v_mfma_f32_16x16x32_bf16 v[56:59], a[184:187], a[220:223], 0
  ds_read_b64_tr_b16 a[198:199], v237 offset:5120
  v_mfma_f32_16x16x32_bf16 v[60:63], a[188:191], a[220:223], 0
  buffer_load_dwordx4 v233, s[48:51], s82 offen offset:1024 lds
  s_waitcnt lgkmcnt(11)
  v_mfma_f32_16x16x32_bf16 v[64:67], a[176:179], a[224:227], 0
  ds_read_b64_tr_b16 a[200:201], v238 offset:4096
  v_mfma_f32_16x16x32_bf16 v[68:71], a[180:183], a[224:227], 0
  ds_read_b64_tr_b16 a[202:203], v238 offset:5120
  v_mfma_f32_16x16x32_bf16 v[72:75], a[184:187], a[224:227], 0
  buffer_load_dwordx4 v234, s[48:51], s82 offen offset:2048 lds
  v_mfma_f32_16x16x32_bf16 v[76:79], a[188:191], a[224:227], 0
  ds_read_b64_tr_b16 a[204:205], v239 offset:4096
  s_waitcnt lgkmcnt(13)
  v_mfma_f32_16x16x32_bf16 v[80:83], a[176:179], a[228:231], 0
  ds_read_b64_tr_b16 a[206:207], v239 offset:5120
  v_mfma_f32_16x16x32_bf16 v[84:87], a[180:183], a[228:231], 0
  buffer_load_dwordx4 v235, s[48:51], s82 offen offset:3072 lds
  v_mfma_f32_16x16x32_bf16 v[88:91], a[184:187], a[228:231], 0
  v_mfma_f32_16x16x32_bf16 v[92:95], a[188:191], a[228:231], 0
  s_waitcnt lgkmcnt(6)
  v_mfma_f32_16x16x32_bf16 v[0:3], a[192:195], a[232:235], v[0:3]
  s_mul_i32 s83, s22, 6144
  s_add_u32 s21, s21, 4
  s_waitcnt lgkmcnt(4)
  v_mfma_f32_16x16x32_bf16 v[4:7], a[196:199], a[232:235], v[4:7]
  v_add_u32 v240, s83, v222
  s_and_b32 s21, s21, 15
  s_waitcnt lgkmcnt(2)
  v_mfma_f32_16x16x32_bf16 v[8:11], a[200:203], a[232:235], v[8:11]
  ds_read_b128 a[208:211], v240
  s_waitcnt lgkmcnt(1)
  v_mfma_f32_16x16x32_bf16 v[12:15], a[204:207], a[232:235], v[12:15]
  ds_read_b128 a[212:215], v240 offset:256
  v_mfma_f32_16x16x32_bf16 v[16:19], a[192:195], a[236:239], v[16:19]
  ds_read_b128 a[216:219], v240 offset:1024
  v_mfma_f32_16x16x32_bf16 v[20:23], a[196:199], a[236:239], v[20:23]
  ds_read_b128 a[220:223], v240 offset:1280
  v_mfma_f32_16x16x32_bf16 v[24:27], a[200:203], a[236:239], v[24:27]
  ds_read_b128 a[224:227], v240 offset:2048
  v_mfma_f32_16x16x32_bf16 v[28:31], a[204:207], a[236:239], v[28:31]
  ds_read_b128 a[228:231], v240 offset:2304
  v_mfma_f32_16x16x32_bf16 v[32:35], a[192:195], a[240:243], v[32:35]
  s_lshl_b32 s82, s21, 15
  s_add_u32 s82, s82, s24
  v_mfma_f32_16x16x32_bf16 v[36:39], a[196:199], a[240:243], v[36:39]
  s_add_u32 m0, s74, 4096
  v_mfma_f32_16x16x32_bf16 v[40:43], a[200:203], a[240:243], v[40:43]
  s_waitcnt vmcnt(8)
  ds_read_b64_tr_b16 a[176:177], v236 offset:8192
  v_mfma_f32_16x16x32_bf16 v[44:47], a[204:207], a[240:243], v[44:47]
  ds_read_b64_tr_b16 a[178:179], v236 offset:9216
  v_mfma_f32_16x16x32_bf16 v[48:51], a[192:195], a[244:247], v[48:51]
  buffer_load_dwordx4 v232, s[48:51], s82 offen lds
  v_mfma_f32_16x16x32_bf16 v[52:55], a[196:199], a[244:247], v[52:55]
  ds_read_b64_tr_b16 a[180:181], v237 offset:8192
  v_mfma_f32_16x16x32_bf16 v[56:59], a[200:203], a[244:247], v[56:59]
  ds_read_b64_tr_b16 a[182:183], v237 offset:9216
  v_mfma_f32_16x16x32_bf16 v[60:63], a[204:207], a[244:247], v[60:63]
  buffer_load_dwordx4 v233, s[48:51], s82 offen offset:1024 lds
  v_mfma_f32_16x16x32_bf16 v[64:67], a[192:195], a[248:251], v[64:67]
  ds_read_b64_tr_b16 a[184:185], v238 offset:8192
  v_mfma_f32_16x16x32_bf16 v[68:71], a[196:199], a[248:251], v[68:71]
  ds_read_b64_tr_b16 a[186:187], v238 offset:9216
  v_mfma_f32_16x16x32_bf16 v[72:75], a[200:203], a[248:251], v[72:75]
  buffer_load_dwordx4 v234, s[48:51], s82 offen offset:2048 lds
  v_mfma_f32_16x16x32_bf16 v[76:79], a[204:207], a[248:251], v[76:79]
  ds_read_b64_tr_b16 a[188:189], v239 offset:8192
  v_mfma_f32_16x16x32_bf16 v[80:83], a[192:195], a[252:255], v[80:83]
  ds_read_b64_tr_b16 a[190:191], v239 offset:9216
  v_mfma_f32_16x16x32_bf16 v[84:87], a[196:199], a[252:255], v[84:87]
  buffer_load_dwordx4 v235, s[48:51], s82 offen offset:3072 lds
  v_mfma_f32_16x16x32_bf16 v[88:91], a[200:203], a[252:255], v[88:91]
  v_mfma_f32_16x16x32_bf16 v[92:95], a[204:207], a[252:255], v[92:95]
  s_waitcnt lgkmcnt(6)
  v_mfma_f32_16x16x32_bf16 v[0:3], a[176:179], a[208:211], v[0:3]
  s_mul_i32 s83, s23, 6144
  s_add_u32 s22, s22, 4
  s_lshl_b32 s75, s87, 3
  s_waitcnt lgkmcnt(4)
  v_mfma_f32_16x16x32_bf16 v[4:7], a[180:183], a[208:211], v[4:7]
  v_add_u32 v240, s83, v222
  s_and_b32 s22, s22, 15
  s_waitcnt lgkmcnt(2)
  v_mfma_f32_16x16x32_bf16 v[8:11], a[184:187], a[208:211], v[8:11]
  ds_read_b128 a[232:235], v240
  s_waitcnt lgkmcnt(1)
  v_mfma_f32_16x16x32_bf16 v[12:15], a[188:191], a[208:211], v[12:15]
  ds_read_b128 a[236:239], v240 offset:256
  v_mfma_f32_16x16x32_bf16 v[16:19], a[176:179], a[212:215], v[16:19]
  ds_read_b128 a[240:243], v240 offset:1024
  v_mfma_f32_16x16x32_bf16 v[20:23], a[180:183], a[212:215], v[20:23]
  ds_read_b128 a[244:247], v240 offset:1280
  v_mfma_f32_16x16x32_bf16 v[24:27], a[184:187], a[212:215], v[24:27]
  ds_read_b128 a[248:251], v240 offset:2048
  v_mfma_f32_16x16x32_bf16 v[28:31], a[188:191], a[212:215], v[28:31]
  ds_read_b128 a[252:255], v240 offset:2304
  v_mfma_f32_16x16x32_bf16 v[32:35], a[176:179], a[216:219], v[32:35]
  s_lshl_b32 s82, s22, 15
  s_add_u32 s82, s82, s24
  v_mov_b32 v252, s75
  v_mfma_f32_16x16x32_bf16 v[36:39], a[180:183], a[216:219], v[36:39]
  s_add_u32 m0, s74, 8192
  v_mfma_f32_16x16x32_bf16 v[40:43], a[184:187], a[216:219], v[40:43]
  s_waitcnt vmcnt(8)
  ds_read_b64_tr_b16 a[192:193], v236 offset:12288
  v_mfma_f32_16x16x32_bf16 v[44:47], a[188:191], a[216:219], v[44:47]
  ds_read_b64_tr_b16 a[194:195], v236 offset:13312
  v_mfma_f32_16x16x32_bf16 v[48:51], a[176:179], a[220:223], v[48:51]
  buffer_load_dwordx4 v232, s[48:51], s82 offen lds
  v_mfma_f32_16x16x32_bf16 v[52:55], a[180:183], a[220:223], v[52:55]
  ds_read_b64_tr_b16 a[196:197], v237 offset:12288
  v_mfma_f32_16x16x32_bf16 v[56:59], a[184:187], a[220:223], v[56:59]
  ds_read_b64_tr_b16 a[198:199], v237 offset:13312
  v_mfma_f32_16x16x32_bf16 v[60:63], a[188:191], a[220:223], v[60:63]
  buffer_load_dwordx4 v233, s[48:51], s82 offen offset:1024 lds
  v_mfma_f32_16x16x32_bf16 v[64:67], a[176:179], a[224:227], v[64:67]
  ds_read_b64_tr_b16 a[200:201], v238 offset:12288
  v_mfma_f32_16x16x32_bf16 v[68:71], a[180:183], a[224:227], v[68:71]
  ds_read_b64_tr_b16 a[202:203], v238 offset:13312
  v_mfma_f32_16x16x32_bf16 v[72:75], a[184:187], a[224:227], v[72:75]
  buffer_load_dwordx4 v234, s[48:51], s82 offen offset:2048 lds
  v_mfma_f32_16x16x32_bf16 v[76:79], a[188:191], a[224:227], v[76:79]
  ds_read_b64_tr_b16 a[204:205], v239 offset:12288
  v_mfma_f32_16x16x32_bf16 v[80:83], a[176:179], a[228:231], v[80:83]
  ds_read_b64_tr_b16 a[206:207], v239 offset:13312
  v_mfma_f32_16x16x32_bf16 v[84:87], a[180:183], a[228:231], v[84:87]
  buffer_load_dwordx4 v235, s[48:51], s82 offen offset:3072 lds
  v_mfma_f32_16x16x32_bf16 v[88:91], a[184:187], a[228:231], v[88:91]
  buffer_load_dwordx2 v[220:221], v252, s[60:63], 0 offen sc1
  v_mfma_f32_16x16x32_bf16 v[92:95], a[188:191], a[228:231], v[92:95]
  s_waitcnt lgkmcnt(6)
  v_mfma_f32_16x16x32_bf16 v[0:3], a[192:195], a[232:235], v[0:3]
  s_mul_i32 s83, s20, 6144
  s_add_u32 s23, s23, 4
  s_waitcnt lgkmcnt(4)
  v_mfma_f32_16x16x32_bf16 v[4:7], a[196:199], a[232:235], v[4:7]
  v_add_u32 v240, s83, v222
  s_and_b32 s23, s23, 15
  s_waitcnt lgkmcnt(2)
  v_mfma_f32_16x16x32_bf16 v[8:11], a[200:203], a[232:235], v[8:11]
  ds_read_b128 a[208:211], v240
  s_waitcnt lgkmcnt(1)
  v_mfma_f32_16x16x32_bf16 v[12:15], a[204:207], a[232:235], v[12:15]
  ds_read_b128 a[212:215], v240 offset:256
  v_mfma_f32_16x16x32_bf16 v[16:19], a[192:195], a[236:239], v[16:19]
  ds_read_b128 a[216:219], v240 offset:1024
  v_mfma_f32_16x16x32_bf16 v[20:23], a[196:199], a[236:239], v[20:23]
  ds_read_b128 a[220:223], v240 offset:1280
  v_mfma_f32_16x16x32_bf16 v[24:27], a[200:203], a[236:239], v[24:27]
  ds_read_b128 a[224:227], v240 offset:2048
  v_mfma_f32_16x16x32_bf16 v[28:31], a[204:207], a[236:239], v[28:31]
  ds_read_b128 a[228:231], v240 offset:2304
  v_mfma_f32_16x16x32_bf16 v[32:35], a[192:195], a[240:243], v[32:35]
  s_lshl_b32 s82, s23, 15
  s_add_u32 s82, s82, s24
  v_mfma_f32_16x16x32_bf16 v[36:39], a[196:199], a[240:243], v[36:39]
  s_add_u32 m0, s74, 12288
  v_mfma_f32_16x16x32_bf16 v[40:43], a[200:203], a[240:243], v[40:43]
  s_waitcnt vmcnt(9)
  ds_read_b64_tr_b16 a[176:177], v236
  v_mfma_f32_16x16x32_bf16 v[44:47], a[204:207], a[240:243], v[44:47]
  ds_read_b64_tr_b16 a[178:179], v236 offset:1024
  v_mfma_f32_16x16x32_bf16 v[48:51], a[192:195], a[244:247], v[48:51]
  buffer_load_dwordx4 v232, s[48:51], s82 offen lds
  v_mfma_f32_16x16x32_bf16 v[52:55], a[196:199], a[244:247], v[52:55]
  ds_read_b64_tr_b16 a[180:181], v237
  v_mfma_f32_16x16x32_bf16 v[56:59], a[200:203], a[244:247], v[56:59]
  ds_read_b64_tr_b16 a[182:183], v237 offset:1024
  v_mfma_f32_16x16x32_bf16 v[60:63], a[204:207], a[244:247], v[60:63]
  buffer_load_dwordx4 v233, s[48:51], s82 offen offset:1024 lds
  v_mfma_f32_16x16x32_bf16 v[64:67], a[192:195], a[248:251], v[64:67]
  ds_read_b64_tr_b16 a[184:185], v238
  v_mfma_f32_16x16x32_bf16 v[68:71], a[196:199], a[248:251], v[68:71]
  ds_read_b64_tr_b16 a[186:187], v238 offset:1024
  v_mfma_f32_16x16x32_bf16 v[72:75], a[200:203], a[248:251], v[72:75]
  buffer_load_dwordx4 v234, s[48:51], s82 offen offset:2048 lds
  v_mfma_f32_16x16x32_bf16 v[76:79], a[204:207], a[248:251], v[76:79]
  ds_read_b64_tr_b16 a[188:189], v239
  v_mfma_f32_16x16x32_bf16 v[80:83], a[192:195], a[252:255], v[80:83]
  ds_read_b64_tr_b16 a[190:191], v239 offset:1024
  v_mfma_f32_16x16x32_bf16 v[84:87], a[196:199], a[252:255], v[84:87]
  buffer_load_dwordx4 v235, s[48:51], s82 offen offset:3072 lds
  v_mfma_f32_16x16x32_bf16 v[88:91], a[200:203], a[252:255], v[88:91]
  v_mfma_f32_16x16x32_bf16 v[92:95], a[204:207], a[252:255], v[92:95]
  s_waitcnt lgkmcnt(6)
  v_mfma_f32_16x16x32_bf16 v[0:3], a[176:179], a[208:211], v[0:3]
  s_mul_i32 s83, s21, 6144
  s_add_u32 s20, s20, 4
  s_lshl_b32 s75, s70, 2
  s_waitcnt lgkmcnt(4)
  v_mfma_f32_16x16x32_bf16 v[4:7], a[180:183], a[208:211], v[4:7]
  v_add_u32 v240, s83, v222
  s_and_b32 s20, s20, 15
  s_waitcnt lgkmcnt(2)
  v_mfma_f32_16x16x32_bf16 v[8:11], a[184:187], a[208:211], v[8:11]
  ds_read_b128 a[232:235], v240
  s_waitcnt lgkmcnt(1)
  v_mfma_f32_16x16x32_bf16 v[12:15], a[188:191], a[208:211], v[12:15]
  ds_read_b128 a[236:239], v240 offset:256
  v_mfma_f32_16x16x32_bf16 v[16:19], a[176:179], a[212:215], v[16:19]
  ds_read_b128 a[240:243], v240 offset:1024
  v_mfma_f32_16x16x32_bf16 v[20:23], a[180:183], a[212:215], v[20:23]
  ds_read_b128 a[244:247], v240 offset:1280
  v_mfma_f32_16x16x32_bf16 v[24:27], a[184:187], a[212:215], v[24:27]
  ds_read_b128 a[248:251], v240 offset:2048
  s_add_u32 s75, s75, s68
  v_mfma_f32_16x16x32_bf16 v[28:31], a[188:191], a[212:215], v[28:31]
  ds_read_b128 a[252:255], v240 offset:2304
  v_mfma_f32_16x16x32_bf16 v[32:35], a[176:179], a[216:219], v[32:35]
  s_lshl_b32 s82, s20, 15
  s_add_u32 s82, s82, s24
  v_mfma_f32_16x16x32_bf16 v[36:39], a[180:183], a[216:219], v[36:39]
  s_add_u32 m0, s74, 0
  v_mfma_f32_16x16x32_bf16 v[40:43], a[184:187], a[216:219], v[40:43]
  s_waitcnt vmcnt(9)
  ds_read_b64_tr_b16 a[192:193], v236 offset:4096
  v_mfma_f32_16x16x32_bf16 v[44:47], a[188:191], a[216:219], v[44:47]
  ds_read_b64_tr_b16 a[194:195], v236 offset:5120
  v_mfma_f32_16x16x32_bf16 v[48:51], a[176:179], a[220:223], v[48:51]
  buffer_load_dwordx4 v232, s[48:51], s82 offen lds
  s_mul_i32 s75, s75, 12288
  v_mfma_f32_16x16x32_bf16 v[52:55], a[180:183], a[220:223], v[52:55]
  ds_read_b64_tr_b16 a[196:197], v237 offset:4096
  v_mfma_f32_16x16x32_bf16 v[56:59], a[184:187], a[220:223], v[56:59]
  ds_read_b64_tr_b16 a[198:199], v237 offset:5120
  v_mfma_f32_16x16x32_bf16 v[60:63], a[188:191], a[220:223], v[60:63]
  buffer_load_dwordx4 v233, s[48:51], s82 offen offset:1024 lds
  v_mfma_f32_16x16x32_bf16 v[64:67], a[176:179], a[224:227], v[64:67]
  ds_read_b64_tr_b16 a[200:201], v238 offset:4096
  v_mfma_f32_16x16x32_bf16 v[68:71], a[180:183], a[224:227], v[68:71]
  ds_read_b64_tr_b16 a[202:203], v238 offset:5120
  v_mfma_f32_16x16x32_bf16 v[72:75], a[184:187], a[224:227], v[72:75]
  buffer_load_dwordx4 v234, s[48:51], s82 offen offset:2048 lds
  v_mfma_f32_16x16x32_bf16 v[76:79], a[188:191], a[224:227], v[76:79]
  ds_read_b64_tr_b16 a[204:205], v239 offset:4096
  v_mfma_f32_16x16x32_bf16 v[80:83], a[176:179], a[228:231], v[80:83]
  ds_read_b64_tr_b16 a[206:207], v239 offset:5120
  v_mfma_f32_16x16x32_bf16 v[84:87], a[180:183], a[228:231], v[84:87]
  buffer_load_dwordx4 v235, s[48:51], s82 offen offset:3072 lds
  v_mfma_f32_16x16x32_bf16 v[88:91], a[184:187], a[228:231], v[88:91]
  buffer_load_dword a96, v218, s[52:55], s75 offen
  v_mfma_f32_16x16x32_bf16 v[92:95], a[188:191], a[228:231], v[92:95]
  s_waitcnt lgkmcnt(6)
  v_mfma_f32_16x16x32_bf16 v[0:3], a[192:195], a[232:235], v[0:3]
  s_mul_i32 s83, s22, 6144
  s_add_u32 s21, s21, 4
  s_waitcnt lgkmcnt(4)
  v_mfma_f32_16x16x32_bf16 v[4:7], a[196:199], a[232:235], v[4:7]
  v_add_u32 v240, s83, v222
  s_and_b32 s21, s21, 15
  s_waitcnt lgkmcnt(2)
  v_mfma_f32_16x16x32_bf16 v[8:11], a[200:203], a[232:235], v[8:11]
  ds_read_b128 a[208:211], v240
  s_waitcnt lgkmcnt(1)
  v_mfma_f32_16x16x32_bf16 v[12:15], a[204:207], a[232:235], v[12:15]
  ds_read_b128 a[212:215], v240 offset:256
  v_mfma_f32_16x16x32_bf16 v[16:19], a[192:195], a[236:239], v[16:19]
  ds_read_b128 a[216:219], v240 offset:1024
  v_mfma_f32_16x16x32_bf16 v[20:23], a[196:199], a[236:239], v[20:23]
  ds_read_b128 a[220:223], v240 offset:1280
  v_mfma_f32_16x16x32_bf16 v[24:27], a[200:203], a[236:239], v[24:27]
  ds_read_b128 a[224:227], v240 offset:2048
  v_mfma_f32_16x16x32_bf16 v[28:31], a[204:207], a[236:239], v[28:31]
  ds_read_b128 a[228:231], v240 offset:2304
  v_mfma_f32_16x16x32_bf16 v[32:35], a[192:195], a[240:243], v[32:35]
  s_lshl_b32 s82, s21, 15
  s_add_u32 s82, s82, s24
  v_mfma_f32_16x16x32_bf16 v[36:39], a[196:199], a[240:243], v[36:39]
  s_add_u32 m0, s74, 4096
  v_mfma_f32_16x16x32_bf16 v[40:43], a[200:203], a[240:243], v[40:43]
  s_waitcnt vmcnt(10)
  ds_read_b64_tr_b16 a[176:177], v236 offset:8192
  v_mfma_f32_16x16x32_bf16 v[44:47], a[204:207], a[240:243], v[44:47]
  ds_read_b64_tr_b16 a[178:179], v236 offset:9216
  v_mfma_f32_16x16x32_bf16 v[48:51], a[192:195], a[244:247], v[48:51]
  buffer_load_dwordx4 v232, s[48:51], s82 offen lds
  v_mfma_f32_16x16x32_bf16 v[52:55], a[196:199], a[244:247], v[52:55]
  ds_read_b64_tr_b16 a[180:181], v237 offset:8192
  v_mfma_f32_16x16x32_bf16 v[56:59], a[200:203], a[244:247], v[56:59]
  ds_read_b64_tr_b16 a[182:183], v237 offset:9216
  v_mfma_f32_16x16x32_bf16 v[60:63], a[204:207], a[244:247], v[60:63]
  buffer_load_dwordx4 v233, s[48:51], s82 offen offset:1024 lds
  v_mfma_f32_16x16x32_bf16 v[64:67], a[192:195], a[248:251], v[64:67]
  ds_read_b64_tr_b16 a[184:185], v238 offset:8192
  v_mfma_f32_16x16x32_bf16 v[68:71], a[196:199], a[248:251], v[68:71]
  ds_read_b64_tr_b16 a[186:187], v238 offset:9216
  v_mfma_f32_16x16x32_bf16 v[72:75], a[200:203], a[248:251], v[72:75]
  buffer_load_dwordx4 v234, s[48:51], s82 offen offset:2048 lds
  v_mfma_f32_16x16x32_bf16 v[76:79], a[204:207], a[248:251], v[76:79]
  ds_read_b64_tr_b16 a[188:189], v239 offset:8192
  v_mfma_f32_16x16x32_bf16 v[80:83], a[192:195], a[252:255], v[80:83]
  ds_read_b64_tr_b16 a[190:191], v239 offset:9216
  v_mfma_f32_16x16x32_bf16 v[84:87], a[196:199], a[252:255], v[84:87]
  buffer_load_dwordx4 v235, s[48:51], s82 offen offset:3072 lds
  v_mfma_f32_16x16x32_bf16 v[88:91], a[200:203], a[252:255], v[88:91]
  v_mfma_f32_16x16x32_bf16 v[92:95], a[204:207], a[252:255], v[92:95]
  s_waitcnt lgkmcnt(6)
  v_mfma_f32_16x16x32_bf16 v[0:3], a[176:179], a[208:211], v[0:3]
  s_mul_i32 s83, s23, 6144
  s_add_u32 s22, s22, 4
  s_waitcnt lgkmcnt(4)
  v_mfma_f32_16x16x32_bf16 v[4:7], a[180:183], a[208:211], v[4:7]
  v_add_u32 v240, s83, v222
  s_and_b32 s22, s22, 15
  s_waitcnt lgkmcnt(2)
  v_mfma_f32_16x16x32_bf16 v[8:11], a[184:187], a[208:211], v[8:11]
  ds_read_b128 a[232:235], v240
  s_waitcnt lgkmcnt(1)
  v_mfma_f32_16x16x32_bf16 v[12:15], a[188:191], a[208:211], v[12:15]
  ds_read_b128 a[236:239], v240 offset:256
  v_mfma_f32_16x16x32_bf16 v[16:19], a[176:179], a[212:215], v[16:19]
  ds_read_b128 a[240:243], v240 offset:1024
  v_mfma_f32_16x16x32_bf16 v[20:23], a[180:183], a[212:215], v[20:23]
  ds_read_b128 a[244:247], v240 offset:1280
  v_mfma_f32_16x16x32_bf16 v[24:27], a[184:187], a[212:215], v[24:27]
  ds_read_b128 a[248:251], v240 offset:2048
  v_mfma_f32_16x16x32_bf16 v[28:31], a[188:191], a[212:215], v[28:31]
  ds_read_b128 a[252:255], v240 offset:2304
  v_mfma_f32_16x16x32_bf16 v[32:35], a[176:179], a[216:219], v[32:35]
  s_lshl_b32 s82, s22, 15
  s_add_u32 s82, s82, s24
  v_mfma_f32_16x16x32_bf16 v[36:39], a[180:183], a[216:219], v[36:39]
  s_add_u32 m0, s74, 8192
  v_mfma_f32_16x16x32_bf16 v[40:43], a[184:187], a[216:219], v[40:43]
  s_waitcnt vmcnt(9)
  ds_read_b64_tr_b16 a[192:193], v236 offset:12288
  v_mfma_f32_16x16x32_bf16 v[44:47], a[188:191], a[216:219], v[44:47]
  ds_read_b64_tr_b16 a[194:195], v236 offset:13312
  v_mfma_f32_16x16x32_bf16 v[48:51], a[176:179], a[220:223], v[48:51]
  buffer_load_dwordx4 v232, s[48:51], s82 offen lds
  v_mfma_f32_16x16x32_bf16 v[52:55], a[180:183], a[220:223], v[52:55]
  ds_read_b64_tr_b16 a[196:197], v237 offset:12288
  v_mfma_f32_16x16x32_bf16 v[56:59], a[184:187], a[220:223], v[56:59]
  ds_read_b64_tr_b16 a[198:199], v237 offset:13312
  v_mfma_f32_16x16x32_bf16 v[60:63], a[188:191], a[220:223], v[60:63]
  buffer_load_dwordx4 v233, s[48:51], s82 offen offset:1024 lds
  v_mfma_f32_16x16x32_bf16 v[64:67], a[176:179], a[224:227], v[64:67]
  ds_read_b64_tr_b16 a[200:201], v238 offset:12288
  v_mfma_f32_16x16x32_bf16 v[68:71], a[180:183], a[224:227], v[68:71]
  ds_read_b64_tr_b16 a[202:203], v238 offset:13312
  v_mfma_f32_16x16x32_bf16 v[72:75], a[184:187], a[224:227], v[72:75]
  buffer_load_dwordx4 v234, s[48:51], s82 offen offset:2048 lds
  v_mfma_f32_16x16x32_bf16 v[76:79], a[188:191], a[224:227], v[76:79]
  ds_read_b64_tr_b16 a[204:205], v239 offset:12288
  v_mfma_f32_16x16x32_bf16 v[80:83], a[176:179], a[228:231], v[80:83]
  ds_read_b64_tr_b16 a[206:207], v239 offset:13312
  v_mfma_f32_16x16x32_bf16 v[84:87], a[180:183], a[228:231], v[84:87]
  buffer_load_dwordx4 v235, s[48:51], s82 offen offset:3072 lds
  v_mfma_f32_16x16x32_bf16 v[88:91], a[184:187], a[228:231], v[88:91]
  v_mfma_f32_16x16x32_bf16 v[92:95], a[188:191], a[228:231], v[92:95]
  s_waitcnt lgkmcnt(6)
  v_mfma_f32_16x16x32_bf16 v[0:3], a[192:195], a[232:235], v[0:3]
  s_mul_i32 s83, s20, 6144
  s_add_u32 s23, s23, 4
  s_waitcnt lgkmcnt(4)
  v_mfma_f32_16x16x32_bf16 v[4:7], a[196:199], a[232:235], v[4:7]
  v_add_u32 v240, s83, v222
  s_and_b32 s23, s23, 15
  s_waitcnt lgkmcnt(2)
  v_mfma_f32_16x16x32_bf16 v[8:11], a[200:203], a[232:235], v[8:11]
  ds_read_b128 a[208:211], v240
  s_waitcnt lgkmcnt(1)
  v_mfma_f32_16x16x32_bf16 v[12:15], a[204:207], a[232:235], v[12:15]
  ds_read_b128 a[212:215], v240 offset:256
  v_mfma_f32_16x16x32_bf16 v[16:19], a[192:195], a[236:239], v[16:19]
  ds_read_b128 a[216:219], v240 offset:1024
  v_mfma_f32_16x16x32_bf16 v[20:23], a[196:199], a[236:239], v[20:23]
  ds_read_b128 a[220:223], v240 offset:1280
  v_mfma_f32_16x16x32_bf16 v[24:27], a[200:203], a[236:239], v[24:27]
  ds_read_b128 a[224:227], v240 offset:2048
  v_mfma_f32_16x16x32_bf16 v[28:31], a[204:207], a[236:239], v[28:31]
  ds_read_b128 a[228:231], v240 offset:2304
  v_mfma_f32_16x16x32_bf16 v[32:35], a[192:195], a[240:243], v[32:35]
  s_lshl_b32 s82, s23, 15
  s_add_u32 s82, s82, s24
  v_mfma_f32_16x16x32_bf16 v[36:39], a[196:199], a[240:243], v[36:39]
  s_add_u32 m0, s74, 12288
  v_mfma_f32_16x16x32_bf16 v[40:43], a[200:203], a[240:243], v[40:43]
  s_waitcnt vmcnt(9)
  ds_read_b64_tr_b16 a[176:177], v236
  v_mfma_f32_16x16x32_bf16 v[44:47], a[204:207], a[240:243], v[44:47]
  ds_read_b64_tr_b16 a[178:179], v236 offset:1024
  v_mfma_f32_16x16x32_bf16 v[48:51], a[192:195], a[244:247], v[48:51]
  buffer_load_dwordx4 v232, s[48:51], s82 offen lds
  v_mfma_f32_16x16x32_bf16 v[52:55], a[196:199], a[244:247], v[52:55]
  ds_read_b64_tr_b16 a[180:181], v237
  v_mfma_f32_16x16x32_bf16 v[56:59], a[200:203], a[244:247], v[56:59]
  ds_read_b64_tr_b16 a[182:183], v237 offset:1024
  v_mfma_f32_16x16x32_bf16 v[60:63], a[204:207], a[244:247], v[60:63]
  buffer_load_dwordx4 v233, s[48:51], s82 offen offset:1024 lds
  v_mfma_f32_16x16x32_bf16 v[64:67], a[192:195], a[248:251], v[64:67]
  ds_read_b64_tr_b16 a[184:185], v238
  v_mfma_f32_16x16x32_bf16 v[68:71], a[196:199], a[248:251], v[68:71]
  ds_read_b64_tr_b16 a[186:187], v238 offset:1024
  v_mfma_f32_16x16x32_bf16 v[72:75], a[200:203], a[248:251], v[72:75]
  buffer_load_dwordx4 v234, s[48:51], s82 offen offset:2048 lds
  v_mfma_f32_16x16x32_bf16 v[76:79], a[204:207], a[248:251], v[76:79]
  ds_read_b64_tr_b16 a[188:189], v239
  v_mfma_f32_16x16x32_bf16 v[80:83], a[192:195], a[252:255], v[80:83]
  ds_read_b64_tr_b16 a[190:191], v239 offset:1024
  v_mfma_f32_16x16x32_bf16 v[84:87], a[196:199], a[252:255], v[84:87]
  buffer_load_dwordx4 v235, s[48:51], s82 offen offset:3072 lds
  v_mfma_f32_16x16x32_bf16 v[88:91], a[200:203], a[252:255], v[88:91]
  v_mfma_f32_16x16x32_bf16 v[92:95], a[204:207], a[252:255], v[92:95]
  s_waitcnt lgkmcnt(6)
  v_mfma_f32_16x16x32_bf16 v[0:3], a[176:179], a[208:211], v[0:3]
  s_mul_i32 s83, s21, 6144
  s_add_u32 s20, s20, 4
  s_waitcnt lgkmcnt(4)
  v_mfma_f32_16x16x32_bf16 v[4:7], a[180:183], a[208:211], v[4:7]
  v_add_u32 v240, s83, v222
  s_and_b32 s20, s20, 15
  s_waitcnt lgkmcnt(2)
  v_mfma_f32_16x16x32_bf16 v[8:11], a[184:187], a[208:211], v[8:11]
  ds_read_b128 a[232:235], v240
  s_waitcnt lgkmcnt(1)
  v_mfma_f32_16x16x32_bf16 v[12:15], a[188:191], a[208:211], v[12:15]
  ds_read_b128 a[236:239], v240 offset:256
  v_mfma_f32_16x16x32_bf16 v[16:19], a[176:179], a[212:215], v[16:19]
  ds_read_b128 a[240:243], v240 offset:1024
  v_mfma_f32_16x16x32_bf16 v[20:23], a[180:183], a[212:215], v[20:23]
  ds_read_b128 a[244:247], v240 offset:1280
  v_mfma_f32_16x16x32_bf16 v[24:27], a[184:187], a[212:215], v[24:27]
  ds_read_b128 a[248:251], v240 offset:2048
  v_mfma_f32_16x16x32_bf16 v[28:31], a[188:191], a[212:215], v[28:31]
  ds_read_b128 a[252:255], v240 offset:2304
  v_mfma_f32_16x16x32_bf16 v[32:35], a[176:179], a[216:219], v[32:35]
  s_lshl_b32 s82, s20, 15
  s_add_u32 s82, s82, s24
  v_mfma_f32_16x16x32_bf16 v[36:39], a[180:183], a[216:219], v[36:39]
  s_add_u32 m0, s74, 0
  v_mfma_f32_16x16x32_bf16 v[40:43], a[184:187], a[216:219], v[40:43]
  s_waitcnt vmcnt(8)
  ds_read_b64_tr_b16 a[192:193], v236 offset:4096
  v_mfma_f32_16x16x32_bf16 v[44:47], a[188:191], a[216:219], v[44:47]
  ds_read_b64_tr_b16 a[194:195], v236 offset:5120
  v_mfma_f32_16x16x32_bf16 v[48:51], a[176:179], a[220:223], v[48:51]
  buffer_load_dwordx4 v232, s[48:51], s82 offen lds
  v_mfma_f32_16x16x32_bf16 v[52:55], a[180:183], a[220:223], v[52:55]
  ds_read_b64_tr_b16 a[196:197], v237 offset:4096
  v_mfma_f32_16x16x32_bf16 v[56:59], a[184:187], a[220:223], v[56:59]
  ds_read_b64_tr_b16 a[198:199], v237 offset:5120
  v_mfma_f32_16x16x32_bf16 v[60:63], a[188:191], a[220:223], v[60:63]
  buffer_load_dwordx4 v233, s[48:51], s82 offen offset:1024 lds
  v_mfma_f32_16x16x32_bf16 v[64:67], a[176:179], a[224:227], v[64:67]
  ds_read_b64_tr_b16 a[200:201], v238 offset:4096
  v_mfma_f32_16x16x32_bf16 v[68:71], a[180:183], a[224:227], v[68:71]
  ds_read_b64_tr_b16 a[202:203], v238 offset:5120
  v_mfma_f32_16x16x32_bf16 v[72:75], a[184:187], a[224:227], v[72:75]
  buffer_load_dwordx4 v234, s[48:51], s82 offen offset:2048 lds
  v_mfma_f32_16x16x32_bf16 v[76:79], a[188:191], a[224:227], v[76:79]
  ds_read_b64_tr_b16 a[204:205], v239 offset:4096
  v_mfma_f32_16x16x32_bf16 v[80:83], a[176:179], a[228:231], v[80:83]
  ds_read_b64_tr_b16 a[206:207], v239 offset:5120
  v_mfma_f32_16x16x32_bf16 v[84:87], a[180:183], a[228:231], v[84:87]
  buffer_load_dwordx4 v235, s[48:51], s82 offen offset:3072 lds
  v_mfma_f32_16x16x32_bf16 v[88:91], a[184:187], a[228:231], v[88:91]
  v_mfma_f32_16x16x32_bf16 v[92:95], a[188:191], a[228:231], v[92:95]
  s_waitcnt lgkmcnt(6)
  v_mfma_f32_16x16x32_bf16 v[0:3], a[192:195], a[232:235], v[0:3]
  s_mul_i32 s83, s22, 6144
  s_add_u32 s21, s21, 4
  s_waitcnt lgkmcnt(4)
  v_mfma_f32_16x16x32_bf16 v[4:7], a[196:199], a[232:235], v[4:7]
  v_add_u32 v240, s83, v222
  s_and_b32 s21, s21, 15
  s_waitcnt lgkmcnt(2)
  v_mfma_f32_16x16x32_bf16 v[8:11], a[200:203], a[232:235], v[8:11]
  ds_read_b128 a[208:211], v240
  s_waitcnt lgkmcnt(1)
  v_mfma_f32_16x16x32_bf16 v[12:15], a[204:207], a[232:235], v[12:15]
  ds_read_b128 a[212:215], v240 offset:256
  v_mfma_f32_16x16x32_bf16 v[16:19], a[192:195], a[236:239], v[16:19]
  ds_read_b128 a[216:219], v240 offset:1024
  v_mfma_f32_16x16x32_bf16 v[20:23], a[196:199], a[236:239], v[20:23]
  ds_read_b128 a[220:223], v240 offset:1280
  v_mfma_f32_16x16x32_bf16 v[24:27], a[200:203], a[236:239], v[24:27]
  ds_read_b128 a[224:227], v240 offset:2048
  v_mfma_f32_16x16x32_bf16 v[28:31], a[204:207], a[236:239], v[28:31]
  ds_read_b128 a[228:231], v240 offset:2304
  v_mfma_f32_16x16x32_bf16 v[32:35], a[192:195], a[240:243], v[32:35]
  s_lshl_b32 s82, s21, 15
  s_add_u32 s82, s82, s24
  v_mfma_f32_16x16x32_bf16 v[36:39], a[196:199], a[240:243], v[36:39]
  s_add_u32 m0, s74, 4096
  v_mfma_f32_16x16x32_bf16 v[40:43], a[200:203], a[240:243], v[40:43]
  s_waitcnt vmcnt(8)
  ds_read_b64_tr_b16 a[176:177], v236 offset:8192
  v_mfma_f32_16x16x32_bf16 v[44:47], a[204:207], a[240:243], v[44:47]
  ds_read_b64_tr_b16 a[178:179], v236 offset:9216
  v_mfma_f32_16x16x32_bf16 v[48:51], a[192:195], a[244:247], v[48:51]
  buffer_load_dwordx4 v232, s[48:51], s82 offen lds
  v_mfma_f32_16x16x32_bf16 v[52:55], a[196:199], a[244:247], v[52:55]
  ds_read_b64_tr_b16 a[180:181], v237 offset:8192
  v_mfma_f32_16x16x32_bf16 v[56:59], a[200:203], a[244:247], v[56:59]
  ds_read_b64_tr_b16 a[182:183], v237 offset:9216
  v_mfma_f32_16x16x32_bf16 v[60:63], a[204:207], a[244:247], v[60:63]
  buffer_load_dwordx4 v233, s[48:51], s82 offen offset:1024 lds
  v_mfma_f32_16x16x32_bf16 v[64:67], a[192:195], a[248:251], v[64:67]
  ds_read_b64_tr_b16 a[184:185], v238 offset:8192
  v_mfma_f32_16x16x32_bf16 v[68:71], a[196:199], a[248:251], v[68:71]
  ds_read_b64_tr_b16 a[186:187], v238 offset:9216
  v_mfma_f32_16x16x32_bf16 v[72:75], a[200:203], a[248:251], v[72:75]
  buffer_load_dwordx4 v234, s[48:51], s82 offen offset:2048 lds
  v_mfma_f32_16x16x32_bf16 v[76:79], a[204:207], a[248:251], v[76:79]
  ds_read_b64_tr_b16 a[188:189], v239 offset:8192
  v_mfma_f32_16x16x32_bf16 v[80:83], a[192:195], a[252:255], v[80:83]
  ds_read_b64_tr_b16 a[190:191], v239 offset:9216
  v_mfma_f32_16x16x32_bf16 v[84:87], a[196:199], a[252:255], v[84:87]
  buffer_load_dwordx4 v235, s[48:51], s82 offen offset:3072 lds
  v_mfma_f32_16x16x32_bf16 v[88:91], a[200:203], a[252:255], v[88:91]
  v_mfma_f32_16x16x32_bf16 v[92:95], a[204:207], a[252:255], v[92:95]
  s_waitcnt lgkmcnt(6)
  v_mfma_f32_16x16x32_bf16 v[0:3], a[176:179], a[208:211], v[0:3]
  s_mul_i32 s83, s23, 6144
  s_add_u32 s22, s22, 4
  s_waitcnt lgkmcnt(4)
  v_mfma_f32_16x16x32_bf16 v[4:7], a[180:183], a[208:211], v[4:7]
  v_add_u32 v240, s83, v222
  s_and_b32 s22, s22, 15
  s_waitcnt lgkmcnt(2)
  v_mfma_f32_16x16x32_bf16 v[8:11], a[184:187], a[208:211], v[8:11]
  ds_read_b128 a[232:235], v240
  s_waitcnt lgkmcnt(1)
  v_mfma_f32_16x16x32_bf16 v[12:15], a[188:191], a[208:211], v[12:15]
  ds_read_b128 a[236:239], v240 offset:256
  v_mfma_f32_16x16x32_bf16 v[16:19], a[176:179], a[212:215], v[16:19]
  ds_read_b128 a[240:243], v240 offset:1024
  v_mfma_f32_16x16x32_bf16 v[20:23], a[180:183], a[212:215], v[20:23]
  ds_read_b128 a[244:247], v240 offset:1280
  v_mfma_f32_16x16x32_bf16 v[24:27], a[184:187], a[212:215], v[24:27]
  ds_read_b128 a[248:251], v240 offset:2048
  v_mfma_f32_16x16x32_bf16 v[28:31], a[188:191], a[212:215], v[28:31]
  ds_read_b128 a[252:255], v240 offset:2304
  v_mfma_f32_16x16x32_bf16 v[32:35], a[176:179], a[216:219], v[32:35]
  s_lshl_b32 s82, s22, 15
  s_add_u32 s82, s82, s24
  v_mfma_f32_16x16x32_bf16 v[36:39], a[180:183], a[216:219], v[36:39]
  s_add_u32 m0, s74, 8192
  v_mfma_f32_16x16x32_bf16 v[40:43], a[184:187], a[216:219], v[40:43]
  s_waitcnt vmcnt(8)
  ds_read_b64_tr_b16 a[192:193], v236 offset:12288
  v_mfma_f32_16x16x32_bf16 v[44:47], a[188:191], a[216:219], v[44:47]
  ds_read_b64_tr_b16 a[194:195], v236 offset:13312
  v_mfma_f32_16x16x32_bf16 v[48:51], a[176:179], a[220:223], v[48:51]
  buffer_load_dwordx4 v232, s[48:51], s82 offen lds
  v_mfma_f32_16x16x32_bf16 v[52:55], a[180:183], a[220:223], v[52:55]
  ds_read_b64_tr_b16 a[196:197], v237 offset:12288
  v_mfma_f32_16x16x32_bf16 v[56:59], a[184:187], a[220:223], v[56:59]
  ds_read_b64_tr_b16 a[198:199], v237 offset:13312
  v_mfma_f32_16x16x32_bf16 v[60:63], a[188:191], a[220:223], v[60:63]
  buffer_load_dwordx4 v233, s[48:51], s82 offen offset:1024 lds
  v_mfma_f32_16x16x32_bf16 v[64:67], a[176:179], a[224:227], v[64:67]
  ds_read_b64_tr_b16 a[200:201], v238 offset:12288
  v_mfma_f32_16x16x32_bf16 v[68:71], a[180:183], a[224:227], v[68:71]
  ds_read_b64_tr_b16 a[202:203], v238 offset:13312
  v_mfma_f32_16x16x32_bf16 v[72:75], a[184:187], a[224:227], v[72:75]
  buffer_load_dwordx4 v234, s[48:51], s82 offen offset:2048 lds
  v_mfma_f32_16x16x32_bf16 v[76:79], a[188:191], a[224:227], v[76:79]
  ds_read_b64_tr_b16 a[204:205], v239 offset:12288
  v_mfma_f32_16x16x32_bf16 v[80:83], a[176:179], a[228:231], v[80:83]
  ds_read_b64_tr_b16 a[206:207], v239 offset:13312
  v_mfma_f32_16x16x32_bf16 v[84:87], a[180:183], a[228:231], v[84:87]
  buffer_load_dwordx4 v235, s[48:51], s82 offen offset:3072 lds
  v_mfma_f32_16x16x32_bf16 v[88:91], a[184:187], a[228:231], v[88:91]
  v_mfma_f32_16x16x32_bf16 v[92:95], a[188:191], a[228:231], v[92:95]
  s_waitcnt lgkmcnt(6)
  v_mfma_f32_16x16x32_bf16 v[0:3], a[192:195], a[232:235], v[0:3]
  s_mul_i32 s83, s20, 6144
  s_add_u32 s23, s23, 4
  s_lshl_b32 s75, s70, 2
  s_waitcnt lgkmcnt(4)
  v_mfma_f32_16x16x32_bf16 v[4:7], a[196:199], a[232:235], v[4:7]
  v_add_u32 v240, s83, v222
  s_and_b32 s23, s23, 15
  s_waitcnt lgkmcnt(2)
  v_mfma_f32_16x16x32_bf16 v[8:11], a[200:203], a[232:235], v[8:11]
  ds_read_b128 a[208:211], v240
  s_waitcnt lgkmcnt(1)
  v_mfma_f32_16x16x32_bf16 v[12:15], a[204:207], a[232:235], v[12:15]
  ds_read_b128 a[212:215], v240 offset:256
  v_mfma_f32_16x16x32_bf16 v[16:19], a[192:195], a[236:239], v[16:19]
  ds_read_b128 a[216:219], v240 offset:1024
  v_mfma_f32_16x16x32_bf16 v[20:23], a[196:199], a[236:239], v[20:23]
  ds_read_b128 a[220:223], v240 offset:1280
  v_mfma_f32_16x16x32_bf16 v[24:27], a[200:203], a[236:239], v[24:27]
  ds_read_b128 a[224:227], v240 offset:2048
  s_add_u32 s75, s75, s68
  v_mfma_f32_16x16x32_bf16 v[28:31], a[204:207], a[236:239], v[28:31]
  ds_read_b128 a[228:231], v240 offset:2304
  v_mfma_f32_16x16x32_bf16 v[32:35], a[192:195], a[240:243], v[32:35]
  s_lshl_b32 s82, s23, 15
  s_add_u32 s82, s82, s24
  v_mfma_f32_16x16x32_bf16 v[36:39], a[196:199], a[240:243], v[36:39]
  s_add_u32 m0, s74, 12288
  v_mfma_f32_16x16x32_bf16 v[40:43], a[200:203], a[240:243], v[40:43]
  s_waitcnt vmcnt(8)
  ds_read_b64_tr_b16 a[176:177], v236
  v_mfma_f32_16x16x32_bf16 v[44:47], a[204:207], a[240:243], v[44:47]
  ds_read_b64_tr_b16 a[178:179], v236 offset:1024
  v_mfma_f32_16x16x32_bf16 v[48:51], a[192:195], a[244:247], v[48:51]
  buffer_load_dwordx4 v232, s[48:51], s82 offen lds
  s_mul_i32 s75, s75, 12288
  v_mfma_f32_16x16x32_bf16 v[52:55], a[196:199], a[244:247], v[52:55]
  ds_read_b64_tr_b16 a[180:181], v237
  v_mfma_f32_16x16x32_bf16 v[56:59], a[200:203], a[244:247], v[56:59]
  ds_read_b64_tr_b16 a[182:183], v237 offset:1024
  v_mfma_f32_16x16x32_bf16 v[60:63], a[204:207], a[244:247], v[60:63]
  buffer_load_dwordx4 v233, s[48:51], s82 offen offset:1024 lds
  v_mfma_f32_16x16x32_bf16 v[64:67], a[192:195], a[248:251], v[64:67]
  ds_read_b64_tr_b16 a[184:185], v238
  v_mfma_f32_16x16x32_bf16 v[68:71], a[196:199], a[248:251], v[68:71]
  ds_read_b64_tr_b16 a[186:187], v238 offset:1024
  v_mfma_f32_16x16x32_bf16 v[72:75], a[200:203], a[248:251], v[72:75]
  buffer_load_dwordx4 v234, s[48:51], s82 offen offset:2048 lds
  v_mfma_f32_16x16x32_bf16 v[76:79], a[204:207], a[248:251], v[76:79]
  ds_read_b64_tr_b16 a[188:189], v239
  v_mfma_f32_16x16x32_bf16 v[80:83], a[192:195], a[252:255], v[80:83]
  ds_read_b64_tr_b16 a[190:191], v239 offset:1024
  v_mfma_f32_16x16x32_bf16 v[84:87], a[196:199], a[252:255], v[84:87]
  buffer_load_dwordx4 v235, s[48:51], s82 offen offset:3072 lds
  v_mfma_f32_16x16x32_bf16 v[88:91], a[200:203], a[252:255], v[88:91]
  buffer_load_dword a97, v219, s[52:55], s75 offen
  v_mfma_f32_16x16x32_bf16 v[92:95], a[204:207], a[252:255], v[92:95]
  s_waitcnt lgkmcnt(6)
  v_mfma_f32_16x16x32_bf16 v[0:3], a[176:179], a[208:211], v[0:3]
  s_mul_i32 s83, s21, 6144
  s_add_u32 s20, s20, 4
  s_waitcnt lgkmcnt(4)
  v_mfma_f32_16x16x32_bf16 v[4:7], a[180:183], a[208:211], v[4:7]
  v_add_u32 v240, s83, v222
  s_and_b32 s20, s20, 15
  s_waitcnt lgkmcnt(2)
  v_mfma_f32_16x16x32_bf16 v[8:11], a[184:187], a[208:211], v[8:11]
  ds_read_b128 a[232:235], v240
  s_waitcnt lgkmcnt(1)
  v_mfma_f32_16x16x32_bf16 v[12:15], a[188:191], a[208:211], v[12:15]
  ds_read_b128 a[236:239], v240 offset:256
  v_mfma_f32_16x16x32_bf16 v[16:19], a[176:179], a[212:215], v[16:19]
  ds_read_b128 a[240:243], v240 offset:1024
  v_mfma_f32_16x16x32_bf16 v[20:23], a[180:183], a[212:215], v[20:23]
  ds_read_b128 a[244:247], v240 offset:1280
  v_mfma_f32_16x16x32_bf16 v[24:27], a[184:187], a[212:215], v[24:27]
  ds_read_b128 a[248:251], v240 offset:2048
  v_mfma_f32_16x16x32_bf16 v[28:31], a[188:191], a[212:215], v[28:31]
  ds_read_b128 a[252:255], v240 offset:2304
  v_mfma_f32_16x16x32_bf16 v[32:35], a[176:179], a[216:219], v[32:35]
  s_lshl_b32 s82, s20, 15
  s_add_u32 s82, s82, s25
  v_mfma_f32_16x16x32_bf16 v[36:39], a[180:183], a[216:219], v[36:39]
  s_add_u32 m0, s74, 0
  v_mfma_f32_16x16x32_bf16 v[40:43], a[184:187], a[216:219], v[40:43]
  s_waitcnt vmcnt(9)
  ds_read_b64_tr_b16 a[192:193], v236 offset:4096
  v_mfma_f32_16x16x32_bf16 v[44:47], a[188:191], a[216:219], v[44:47]
  ds_read_b64_tr_b16 a[194:195], v236 offset:5120
  v_mfma_f32_16x16x32_bf16 v[48:51], a[176:179], a[220:223], v[48:51]
  buffer_load_dwordx4 v232, s[48:51], s82 offen lds
  v_mfma_f32_16x16x32_bf16 v[52:55], a[180:183], a[220:223], v[52:55]
  ds_read_b64_tr_b16 a[196:197], v237 offset:4096
  v_mfma_f32_16x16x32_bf16 v[56:59], a[184:187], a[220:223], v[56:59]
  ds_read_b64_tr_b16 a[198:199], v237 offset:5120
  v_mfma_f32_16x16x32_bf16 v[60:63], a[188:191], a[220:223], v[60:63]
  buffer_load_dwordx4 v233, s[48:51], s82 offen offset:1024 lds
  v_mfma_f32_16x16x32_bf16 v[64:67], a[176:179], a[224:227], v[64:67]
  ds_read_b64_tr_b16 a[200:201], v238 offset:4096
  v_mfma_f32_16x16x32_bf16 v[68:71], a[180:183], a[224:227], v[68:71]
  ds_read_b64_tr_b16 a[202:203], v238 offset:5120
  v_mfma_f32_16x16x32_bf16 v[72:75], a[184:187], a[224:227], v[72:75]
  buffer_load_dwordx4 v234, s[48:51], s82 offen offset:2048 lds
  v_mfma_f32_16x16x32_bf16 v[76:79], a[188:191], a[224:227], v[76:79]
  ds_read_b64_tr_b16 a[204:205], v239 offset:4096
  v_mfma_f32_16x16x32_bf16 v[80:83], a[176:179], a[228:231], v[80:83]
  ds_read_b64_tr_b16 a[206:207], v239 offset:5120
  v_mfma_f32_16x16x32_bf16 v[84:87], a[180:183], a[228:231], v[84:87]
  buffer_load_dwordx4 v235, s[48:51], s82 offen offset:3072 lds
  v_mfma_f32_16x16x32_bf16 v[88:91], a[184:187], a[228:231], v[88:91]
  v_mfma_f32_16x16x32_bf16 v[92:95], a[188:191], a[228:231], v[92:95]
  s_waitcnt lgkmcnt(6)
  v_mfma_f32_16x16x32_bf16 v[0:3], a[192:195], a[232:235], v[0:3]
  s_mul_i32 s83, s22, 6144
  s_add_u32 s21, s21, 4
  s_waitcnt lgkmcnt(4)
  v_mfma_f32_16x16x32_bf16 v[4:7], a[196:199], a[232:235], v[4:7]
  v_add_u32 v240, s83, v222
  s_and_b32 s21, s21, 15
  s_waitcnt lgkmcnt(2)
  v_mfma_f32_16x16x32_bf16 v[8:11], a[200:203], a[232:235], v[8:11]
  ds_read_b128 a[208:211], v240
  s_waitcnt lgkmcnt(1)
  v_mfma_f32_16x16x32_bf16 v[12:15], a[204:207], a[232:235], v[12:15]
  ds_read_b128 a[212:215], v240 offset:256
  v_mfma_f32_16x16x32_bf16 v[16:19], a[192:195], a[236:239], v[16:19]
  ds_read_b128 a[216:219], v240 offset:1024
  v_mfma_f32_16x16x32_bf16 v[20:23], a[196:199], a[236:239], v[20:23]
  ds_read_b128 a[220:223], v240 offset:1280
  v_mfma_f32_16x16x32_bf16 v[24:27], a[200:203], a[236:239], v[24:27]
  ds_read_b128 a[224:227], v240 offset:2048
  v_mfma_f32_16x16x32_bf16 v[28:31], a[204:207], a[236:239], v[28:31]
  ds_read_b128 a[228:231], v240 offset:2304
  v_mfma_f32_16x16x32_bf16 v[32:35], a[192:195], a[240:243], v[32:35]
  s_lshl_b32 s82, s21, 15
  s_add_u32 s82, s82, s25
  v_mfma_f32_16x16x32_bf16 v[36:39], a[196:199], a[240:243], v[36:39]
  s_add_u32 m0, s74, 4096
  v_mfma_f32_16x16x32_bf16 v[40:43], a[200:203], a[240:243], v[40:43]
  s_waitcnt vmcnt(9)
  ds_read_b64_tr_b16 a[176:177], v236 offset:8192
  v_mfma_f32_16x16x32_bf16 v[44:47], a[204:207], a[240:243], v[44:47]
  ds_read_b64_tr_b16 a[178:179], v236 offset:9216
  v_mfma_f32_16x16x32_bf16 v[48:51], a[192:195], a[244:247], v[48:51]
  buffer_load_dwordx4 v232, s[48:51], s82 offen lds
  v_mfma_f32_16x16x32_bf16 v[52:55], a[196:199], a[244:247], v[52:55]
  ds_read_b64_tr_b16 a[180:181], v237 offset:8192
  v_mfma_f32_16x16x32_bf16 v[56:59], a[200:203], a[244:247], v[56:59]
  ds_read_b64_tr_b16 a[182:183], v237 offset:9216
  v_mfma_f32_16x16x32_bf16 v[60:63], a[204:207], a[244:247], v[60:63]
  buffer_load_dwordx4 v233, s[48:51], s82 offen offset:1024 lds
  v_mfma_f32_16x16x32_bf16 v[64:67], a[192:195], a[248:251], v[64:67]
  ds_read_b64_tr_b16 a[184:185], v238 offset:8192
  v_mfma_f32_16x16x32_bf16 v[68:71], a[196:199], a[248:251], v[68:71]
  ds_read_b64_tr_b16 a[186:187], v238 offset:9216
  v_mfma_f32_16x16x32_bf16 v[72:75], a[200:203], a[248:251], v[72:75]
  buffer_load_dwordx4 v234, s[48:51], s82 offen offset:2048 lds
  v_mfma_f32_16x16x32_bf16 v[76:79], a[204:207], a[248:251], v[76:79]
  ds_read_b64_tr_b16 a[188:189], v239 offset:8192
  v_mfma_f32_16x16x32_bf16 v[80:83], a[192:195], a[252:255], v[80:83]
  ds_read_b64_tr_b16 a[190:191], v239 offset:9216
  v_mfma_f32_16x16x32_bf16 v[84:87], a[196:199], a[252:255], v[84:87]
  buffer_load_dwordx4 v235, s[48:51], s82 offen offset:3072 lds
  v_mfma_f32_16x16x32_bf16 v[88:91], a[200:203], a[252:255], v[88:91]
  v_mfma_f32_16x16x32_bf16 v[92:95], a[204:207], a[252:255], v[92:95]
  s_waitcnt lgkmcnt(6)
  v_mfma_f32_16x16x32_bf16 v[0:3], a[176:179], a[208:211], v[0:3]
  s_mul_i32 s83, s23, 6144
  s_add_u32 s22, s22, 4
  s_waitcnt lgkmcnt(4)
  v_mfma_f32_16x16x32_bf16 v[4:7], a[180:183], a[208:211], v[4:7]
  v_add_u32 v240, s83, v222
  s_and_b32 s22, s22, 15
  s_waitcnt lgkmcnt(2)
  v_mfma_f32_16x16x32_bf16 v[8:11], a[184:187], a[208:211], v[8:11]
  ds_read_b128 a[232:235], v240
  s_waitcnt lgkmcnt(1)
  v_mfma_f32_16x16x32_bf16 v[12:15], a[188:191], a[208:211], v[12:15]
  ds_read_b128 a[236:239], v240 offset:256
  v_mfma_f32_16x16x32_bf16 v[16:19], a[176:179], a[212:215], v[16:19]
  ds_read_b128 a[240:243], v240 offset:1024
  v_mfma_f32_16x16x32_bf16 v[20:23], a[180:183], a[212:215], v[20:23]
  ds_read_b128 a[244:247], v240 offset:1280
  v_mfma_f32_16x16x32_bf16 v[24:27], a[184:187], a[212:215], v[24:27]
  ds_read_b128 a[248:251], v240 offset:2048
  v_mfma_f32_16x16x32_bf16 v[28:31], a[188:191], a[212:215], v[28:31]
  ds_read_b128 a[252:255], v240 offset:2304
  v_mfma_f32_16x16x32_bf16 v[32:35], a[176:179], a[216:219], v[32:35]
  s_lshl_b32 s82, s22, 15
  s_add_u32 s82, s82, s25
  v_mfma_f32_16x16x32_bf16 v[36:39], a[180:183], a[216:219], v[36:39]
  s_add_u32 m0, s74, 8192
  v_mfma_f32_16x16x32_bf16 v[40:43], a[184:187], a[216:219], v[40:43]
  s_waitcnt vmcnt(9)
  ds_read_b64_tr_b16 a[192:193], v236 offset:12288
  v_mfma_f32_16x16x32_bf16 v[44:47], a[188:191], a[216:219], v[44:47]
  ds_read_b64_tr_b16 a[194:195], v236 offset:13312
  v_mfma_f32_16x16x32_bf16 v[48:51], a[176:179], a[220:223], v[48:51]
  buffer_load_dwordx4 v232, s[48:51], s82 offen lds
  v_mfma_f32_16x16x32_bf16 v[52:55], a[180:183], a[220:223], v[52:55]
  ds_read_b64_tr_b16 a[196:197], v237 offset:12288
  v_mfma_f32_16x16x32_bf16 v[56:59], a[184:187], a[220:223], v[56:59]
  ds_read_b64_tr_b16 a[198:199], v237 offset:13312
  v_mfma_f32_16x16x32_bf16 v[60:63], a[188:191], a[220:223], v[60:63]
  buffer_load_dwordx4 v233, s[48:51], s82 offen offset:1024 lds
  v_mfma_f32_16x16x32_bf16 v[64:67], a[176:179], a[224:227], v[64:67]
  ds_read_b64_tr_b16 a[200:201], v238 offset:12288
  v_mfma_f32_16x16x32_bf16 v[68:71], a[180:183], a[224:227], v[68:71]
  ds_read_b64_tr_b16 a[202:203], v238 offset:13312
  v_mfma_f32_16x16x32_bf16 v[72:75], a[184:187], a[224:227], v[72:75]
  buffer_load_dwordx4 v234, s[48:51], s82 offen offset:2048 lds
  v_mfma_f32_16x16x32_bf16 v[76:79], a[188:191], a[224:227], v[76:79]
  ds_read_b64_tr_b16 a[204:205], v239 offset:12288
  v_mfma_f32_16x16x32_bf16 v[80:83], a[176:179], a[228:231], v[80:83]
  ds_read_b64_tr_b16 a[206:207], v239 offset:13312
  v_mfma_f32_16x16x32_bf16 v[84:87], a[180:183], a[228:231], v[84:87]
  buffer_load_dwordx4 v235, s[48:51], s82 offen offset:3072 lds
  v_mfma_f32_16x16x32_bf16 v[88:91], a[184:187], a[228:231], v[88:91]
  v_mfma_f32_16x16x32_bf16 v[92:95], a[188:191], a[228:231], v[92:95]
  s_waitcnt lgkmcnt(6)
  v_mfma_f32_16x16x32_bf16 v[0:3], a[192:195], a[232:235], v[0:3]
  s_mul_i32 s83, s20, 6144
  s_add_u32 s23, s23, 4
  s_waitcnt lgkmcnt(4)
  v_mfma_f32_16x16x32_bf16 v[4:7], a[196:199], a[232:235], v[4:7]
  v_add_u32 v240, s83, v222
  s_and_b32 s23, s23, 15
  s_waitcnt lgkmcnt(2)
  v_mfma_f32_16x16x32_bf16 v[8:11], a[200:203], a[232:235], v[8:11]
  ds_read_b128 a[208:211], v240
  s_waitcnt lgkmcnt(1)
  v_mfma_f32_16x16x32_bf16 v[12:15], a[204:207], a[232:235], v[12:15]
  ds_read_b128 a[212:215], v240 offset:256
  v_mfma_f32_16x16x32_bf16 v[16:19], a[192:195], a[236:239], v[16:19]
  ds_read_b128 a[216:219], v240 offset:1024
  v_mfma_f32_16x16x32_bf16 v[20:23], a[196:199], a[236:239], v[20:23]
  ds_read_b128 a[220:223], v240 offset:1280
  v_mfma_f32_16x16x32_bf16 v[24:27], a[200:203], a[236:239], v[24:27]
  ds_read_b128 a[224:227], v240 offset:2048
  v_mfma_f32_16x16x32_bf16 v[28:31], a[204:207], a[236:239], v[28:31]
  ds_read_b128 a[228:231], v240 offset:2304
  v_mfma_f32_16x16x32_bf16 v[32:35], a[192:195], a[240:243], v[32:35]
  s_lshl_b32 s82, s23, 15
  s_add_u32 s82, s82, s25
  v_mfma_f32_16x16x32_bf16 v[36:39], a[196:199], a[240:243], v[36:39]
  s_add_u32 m0, s74, 12288
  v_mfma_f32_16x16x32_bf16 v[40:43], a[200:203], a[240:243], v[40:43]
  s_waitcnt vmcnt(8)
  ds_read_b64_tr_b16 a[176:177], v236
  v_mfma_f32_16x16x32_bf16 v[44:47], a[204:207], a[240:243], v[44:47]
  ds_read_b64_tr_b16 a[178:179], v236 offset:1024
  v_mfma_f32_16x16x32_bf16 v[48:51], a[192:195], a[244:247], v[48:51]
  buffer_load_dwordx4 v232, s[48:51], s82 offen lds
  v_mfma_f32_16x16x32_bf16 v[52:55], a[196:199], a[244:247], v[52:55]
  ds_read_b64_tr_b16 a[180:181], v237
  v_mfma_f32_16x16x32_bf16 v[56:59], a[200:203], a[244:247], v[56:59]
  ds_read_b64_tr_b16 a[182:183], v237 offset:1024
  v_mfma_f32_16x16x32_bf16 v[60:63], a[204:207], a[244:247], v[60:63]
  buffer_load_dwordx4 v233, s[48:51], s82 offen offset:1024 lds
  v_mfma_f32_16x16x32_bf16 v[64:67], a[192:195], a[248:251], v[64:67]
  ds_read_b64_tr_b16 a[184:185], v238
  v_mfma_f32_16x16x32_bf16 v[68:71], a[196:199], a[248:251], v[68:71]
  ds_read_b64_tr_b16 a[186:187], v238 offset:1024
  v_mfma_f32_16x16x32_bf16 v[72:75], a[200:203], a[248:251], v[72:75]
  buffer_load_dwordx4 v234, s[48:51], s82 offen offset:2048 lds
  v_mfma_f32_16x16x32_bf16 v[76:79], a[204:207], a[248:251], v[76:79]
  ds_read_b64_tr_b16 a[188:189], v239
  v_mfma_f32_16x16x32_bf16 v[80:83], a[192:195], a[252:255], v[80:83]
  ds_read_b64_tr_b16 a[190:191], v239 offset:1024
  v_mfma_f32_16x16x32_bf16 v[84:87], a[196:199], a[252:255], v[84:87]
  buffer_load_dwordx4 v235, s[48:51], s82 offen offset:3072 lds
  v_mfma_f32_16x16x32_bf16 v[88:91], a[200:203], a[252:255], v[88:91]
  v_mfma_f32_16x16x32_bf16 v[92:95], a[204:207], a[252:255], v[92:95]
  s_mov_b32 s89, 0
L_idchk:
  v_and_b32 v253, v220, v221
  s_nop 0
  v_readfirstlane_b32 s75, v253
  v_readfirstlane_b32 s76, v220
  v_readfirstlane_b32 s77, v221
  s_nop 3
  s_and_b32 s75, s75, 0x80808080
  s_cmp_eq_u32 s75, 0x80808080
  s_cbranch_scc1 L_idok
  s_add_u32 s89, s89, 1
  s_cmp_gt_u32 s89, 200000
  s_cbranch_scc1 L_idok
  buffer_load_dwordx2 v[220:221], v252, s[60:63], 0 offen sc0 sc1
  s_waitcnt vmcnt(0)
  s_branch L_idchk
L_idok:
  s_and_b32 s75, s76, 255
  s_mul_i32 s75, s75, 0x01010101
  s_cmp_eq_u32 s75, s76
  s_cselect_b32 s88, 1, 0
  s_cmp_eq_u32 s76, s77
  s_cselect_b32 s88, s88, 0
  s_cmp_eq_u32 s88, 0
  s_cbranch_scc1 L_slow
L_tail_f:
  s_waitcnt lgkmcnt(6)
  v_mfma_f32_16x16x32_bf16 v[96:99], a[176:179], a[208:211], 0
  s_mul_i32 s83, s21, 6144
  s_add_u32 s20, s20, 4
  s_lshl_b32 s76, s31, 2
  s_waitcnt lgkmcnt(4)
  v_mfma_f32_16x16x32_bf16 v[100:103], a[180:183], a[208:211], 0
  v_add_u32 v240, s83, v222
  s_and_b32 s20, s20, 15
  s_add_u32 s76, s76, 3
  s_waitcnt lgkmcnt(2)
  v_mfma_f32_16x16x32_bf16 v[104:107], a[184:187], a[208:211], 0
  ds_read_b128 a[232:235], v240
  s_waitcnt lgkmcnt(1)
  v_mfma_f32_16x16x32_bf16 v[108:111], a[188:191], a[208:211], 0
  ds_read_b128 a[236:239], v240 offset:256
  s_sub_u32 s76, s76, s68
  v_mfma_f32_16x16x32_bf16 v[112:115], a[176:179], a[212:215], 0
  ds_read_b128 a[240:243], v240 offset:1024
  v_mfma_f32_16x16x32_bf16 v[116:119], a[180:183], a[212:215], 0
  ds_read_b128 a[244:247], v240 offset:1280
  s_mul_i32 s76, s76, 12288
  v_mfma_f32_16x16x32_bf16 v[120:123], a[184:187], a[212:215], 0
  ds_read_b128 a[248:251], v240 offset:2048
  v_mfma_f32_16x16x32_bf16 v[124:127], a[188:191], a[212:215], 0
  ds_read_b128 a[252:255], v240 offset:2304
  v_cvt_pk_bf16_f32 v0, v0, v1
  v_mfma_f32_16x16x32_bf16 v[128:131], a[176:179], a[216:219], 0
  s_lshl_b32 s82, s20, 15
  s_add_u32 s82, s82, s25
  v_mfma_f32_16x16x32_bf16 v[132:135], a[180:183], a[216:219], 0
  s_add_u32 m0, s74, 0
  v_cvt_pk_bf16_f32 v1, v2, v3
  v_mfma_f32_16x16x32_bf16 v[136:139], a[184:187], a[216:219], 0
  s_waitcnt vmcnt(8)
  ds_read_b64_tr_b16 a[192:193], v236 offset:4096
  v_mfma_f32_16x16x32_bf16 v[140:143], a[188:191], a[216:219], 0
  ds_read_b64_tr_b16 a[194:195], v236 offset:5120
  v_cvt_pk_bf16_f32 v2, v4, v5
  v_mfma_f32_16x16x32_bf16 v[144:147], a[176:179], a[220:223], 0
  buffer_load_dwordx4 v232, s[48:51], s82 offen lds
  v_mfma_f32_16x16x32_bf16 v[148:151], a[180:183], a[220:223], 0
  ds_read_b64_tr_b16 a[196:197], v237 offset:4096
  v_cvt_pk_bf16_f32 v3, v6, v7
  v_mfma_f32_16x16x32_bf16 v[152:155], a[184:187], a[220:223], 0
  ds_read_b64_tr_b16 a[198:199], v237 offset:5120
  v_mfma_f32_16x16x32_bf16 v[156:159], a[188:191], a[220:223], 0
  buffer_load_dwordx4 v233, s[48:51], s82 offen offset:1024 lds
  v_mfma_f32_16x16x32_bf16 v[160:163], a[176:179], a[224:227], 0
  ds_read_b64_tr_b16 a[200:201], v238 offset:4096
  v_mfma_f32_16x16x32_bf16 v[164:167], a[180:183], a[224:227], 0
  ds_read_b64_tr_b16 a[202:203], v238 offset:5120
  v_mfma_f32_16x16x32_bf16 v[168:171], a[184:187], a[224:227], 0
  buffer_load_dwordx4 v234, s[48:51], s82 offen offset:2048 lds
  v_mfma_f32_16x16x32_bf16 v[172:175], a[188:191], a[224:227], 0
  ds_read_b64_tr_b16 a[204:205], v239 offset:4096
  v_mfma_f32_16x16x32_bf16 v[176:179], a[176:179], a[228:231], 0
  ds_read_b64_tr_b16 a[206:207], v239 offset:5120
  v_mfma_f32_16x16x32_bf16 v[180:183], a[180:183], a[228:231], 0
  buffer_load_dwordx4 v235, s[48:51], s82 offen offset:3072 lds
  v_mfma_f32_16x16x32_bf16 v[184:187], a[184:187], a[228:231], 0
  buffer_store_dwordx4 v[0:3], v241, s[52:55], s76 offen
  v_mfma_f32_16x16x32_bf16 v[188:191], a[188:191], a[228:231], 0
  v_cvt_pk_bf16_f32 v8, v8, v9
  v_cvt_pk_bf16_f32 v9, v10, v11
  v_cvt_pk_bf16_f32 v10, v12, v13
  v_cvt_pk_bf16_f32 v11, v14, v15
  s_waitcnt lgkmcnt(6)
  v_mfma_f32_16x16x32_bf16 v[96:99], a[192:195], a[232:235], v[96:99]
  s_mul_i32 s83, s22, 6144
  s_add_u32 s21, s21, 4
  s_waitcnt lgkmcnt(4)
  v_mfma_f32_16x16x32_bf16 v[100:103], a[196:199], a[232:235], v[100:103]
  v_add_u32 v240, s83, v222
  s_and_b32 s21, s21, 15
  s_waitcnt lgkmcnt(2)
  v_mfma_f32_16x16x32_bf16 v[104:107], a[200:203], a[232:235], v[104:107]
  ds_read_b128 a[208:211], v240
  s_waitcnt lgkmcnt(1)
  v_mfma_f32_16x16x32_bf16 v[108:111], a[204:207], a[232:235], v[108:111]
  ds_read_b128 a[212:215], v240 offset:256
  v_mfma_f32_16x16x32_bf16 v[112:115], a[192:195], a[236:239], v[112:115]
  ds_read_b128 a[216:219], v240 offset:1024
  v_mfma_f32_16x16x32_bf16 v[116:119], a[196:199], a[236:239], v[116:119]
  ds_read_b128 a[220:223], v240 offset:1280
  v_mfma_f32_16x16x32_bf16 v[120:123], a[200:203], a[236:239], v[120:123]
  ds_read_b128 a[224:227], v240 offset:2048
  v_mfma_f32_16x16x32_bf16 v[124:127], a[204:207], a[236:239], v[124:127]
  ds_read_b128 a[228:231], v240 offset:2304
  v_mfma_f32_16x16x32_bf16 v[128:131], a[192:195], a[240:243], v[128:131]
  s_lshl_b32 s82, s21, 15
  s_add_u32 s82, s82, s25
  v_mfma_f32_16x16x32_bf16 v[132:135], a[196:199], a[240:243], v[132:135]
  s_add_u32 m0, s74, 4096
  buffer_store_dwordx4 v[8:11], v241, s[52:55], s76 offen offset:1024
  v_mfma_f32_16x16x32_bf16 v[136:139], a[200:203], a[240:243], v[136:139]
  s_waitcnt vmcnt(10)
  ds_read_b64_tr_b16 a[176:177], v236 offset:8192
  v_cvt_pk_bf16_f32 v16, v16, v17
  v_cvt_pk_bf16_f32 v17, v18, v19
  v_mfma_f32_16x16x32_bf16 v[140:143], a[204:207], a[240:243], v[140:143]
  ds_read_b64_tr_b16 a[178:179], v236 offset:9216
  v_cvt_pk_bf16_f32 v18, v20, v21
  v_cvt_pk_bf16_f32 v19, v22, v23
  v_mfma_f32_16x16x32_bf16 v[144:147], a[192:195], a[244:247], v[144:147]
  buffer_load_dwordx4 v232, s[48:51], s82 offen lds
  v_mfma_f32_16x16x32_bf16 v[148:151], a[196:199], a[244:247], v[148:151]
  ds_read_b64_tr_b16 a[180:181], v237 offset:8192
  v_mfma_f32_16x16x32_bf16 v[152:155], a[200:203], a[244:247], v[152:155]
  ds_read_b64_tr_b16 a[182:183], v237 offset:9216
  v_mfma_f32_16x16x32_bf16 v[156:159], a[204:207], a[244:247], v[156:159]
  buffer_load_dwordx4 v233, s[48:51], s82 offen offset:1024 lds
  v_mfma_f32_16x16x32_bf16 v[160:163], a[192:195], a[248:251], v[160:163]
  ds_read_b64_tr_b16 a[184:185], v238 offset:8192
  v_mfma_f32_16x16x32_bf16 v[164:167], a[196:199], a[248:251], v[164:167]
  ds_read_b64_tr_b16 a[186:187], v238 offset:9216
  v_mfma_f32_16x16x32_bf16 v[168:171], a[200:203], a[248:251], v[168:171]
  buffer_load_dwordx4 v234, s[48:51], s82 offen offset:2048 lds
  v_mfma_f32_16x16x32_bf16 v[172:175], a[204:207], a[248:251], v[172:175]
  ds_read_b64_tr_b16 a[188:189], v239 offset:8192
  v_mfma_f32_16x16x32_bf16 v[176:179], a[192:195], a[252:255], v[176:179]
  ds_read_b64_tr_b16 a[190:191], v239 offset:9216
  v_mfma_f32_16x16x32_bf16 v[180:183], a[196:199], a[252:255], v[180:183]
  buffer_load_dwordx4 v235, s[48:51], s82 offen offset:3072 lds
  v_mfma_f32_16x16x32_bf16 v[184:187], a[200:203], a[252:255], v[184:187]
  buffer_store_dwordx4 v[16:19], v241, s[52:55], s76 offen offset:2048
  v_mfma_f32_16x16x32_bf16 v[188:191], a[204:207], a[252:255], v[188:191]
  v_cvt_pk_bf16_f32 v24, v24, v25
  v_cvt_pk_bf16_f32 v25, v26, v27
  v_cvt_pk_bf16_f32 v26, v28, v29
  v_cvt_pk_bf16_f32 v27, v30, v31
  buffer_store_dwordx4 v[24:27], v241, s[52:55], s76 offen offset:3072
  v_cvt_pk_bf16_f32 v32, v32, v33
  v_cvt_pk_bf16_f32 v33, v34, v35
  s_waitcnt lgkmcnt(6)
  v_mfma_f32_16x16x32_bf16 v[96:99], a[176:179], a[208:211], v[96:99]
  s_mul_i32 s83, s23, 6144
  s_add_u32 s22, s22, 4
  v_cvt_pk_bf16_f32 v34, v36, v37
  s_waitcnt lgkmcnt(4)
  v_mfma_f32_16x16x32_bf16 v[100:103], a[180:183], a[208:211], v[100:103]
  v_add_u32 v240, s83, v222
  s_and_b32 s22, s22, 15
  v_cvt_pk_bf16_f32 v35, v38, v39
  s_waitcnt lgkmcnt(2)
  v_mfma_f32_16x16x32_bf16 v[104:107], a[184:187], a[208:211], v[104:107]
  ds_read_b128 a[232:235], v240
  s_waitcnt lgkmcnt(1)
  v_mfma_f32_16x16x32_bf16 v[108:111], a[188:191], a[208:211], v[108:111]
  ds_read_b128 a[236:239], v240 offset:256
  s_add_u32 s76, s76, 4096
  v_mfma_f32_16x16x32_bf16 v[112:115], a[176:179], a[212:215], v[112:115]
  ds_read_b128 a[240:243], v240 offset:1024
  v_mfma_f32_16x16x32_bf16 v[116:119], a[180:183], a[212:215], v[116:119]
  ds_read_b128 a[244:247], v240 offset:1280
  v_mfma_f32_16x16x32_bf16 v[120:123], a[184:187], a[212:215], v[120:123]
  ds_read_b128 a[248:251], v240 offset:2048
  v_mfma_f32_16x16x32_bf16 v[124:127], a[188:191], a[212:215], v[124:127]
  ds_read_b128 a[252:255], v240 offset:2304
  v_mfma_f32_16x16x32_bf16 v[128:131], a[176:179], a[216:219], v[128:131]
  s_lshl_b32 s82, s22, 15
  s_add_u32 s82, s82, s25
  v_mfma_f32_16x16x32_bf16 v[132:135], a[180:183], a[216:219], v[132:135]
  s_add_u32 m0, s74, 8192
  buffer_store_dwordx4 v[32:35], v241, s[52:55], s76 offen
  v_mfma_f32_16x16x32_bf16 v[136:139], a[184:187], a[216:219], v[136:139]
  s_waitcnt vmcnt(13)
  ds_read_b64_tr_b16 a[192:193], v236 offset:12288
  v_cvt_pk_bf16_f32 v40, v40, v41
  v_cvt_pk_bf16_f32 v41, v42, v43
  v_mfma_f32_16x16x32_bf16 v[140:143], a[188:191], a[216:219], v[140:143]
  ds_read_b64_tr_b16 a[194:195], v236 offset:13312
  v_cvt_pk_bf16_f32 v42, v44, v45
  v_mfma_f32_16x16x32_bf16 v[144:147], a[176:179], a[220:223], v[144:147]
  buffer_load_dwordx4 v232, s[48:51], s82 offen lds
  v_mfma_f32_16x16x32_bf16 v[148:151], a[180:183], a[220:223], v[148:151]
  ds_read_b64_tr_b16 a[196:197], v237 offset:12288
  v_cvt_pk_bf16_f32 v43, v46, v47
  v_mfma_f32_16x16x32_bf16 v[152:155], a[184:187], a[220:223], v[152:155]
  ds_read_b64_tr_b16 a[198:199], v237 offset:13312
  v_mfma_f32_16x16x32_bf16 v[156:159], a[188:191], a[220:223], v[156:159]
  buffer_load_dwordx4 v233, s[48:51], s82 offen offset:1024 lds
  v_mfma_f32_16x16x32_bf16 v[160:163], a[176:179], a[224:227], v[160:163]
  ds_read_b64_tr_b16 a[200:201], v238 offset:12288
  v_mfma_f32_16x16x32_bf16 v[164:167], a[180:183], a[224:227], v[164:167]
  ds_read_b64_tr_b16 a[202:203], v238 offset:13312
  v_mfma_f32_16x16x32_bf16 v[168:171], a[184:187], a[224:227], v[168:171]
  buffer_load_dwordx4 v234, s[48:51], s82 offen offset:2048 lds
  v_mfma_f32_16x16x32_bf16 v[172:175], a[188:191], a[224:227], v[172:175]
  ds_read_b64_tr_b16 a[204:205], v239 offset:12288
  v_mfma_f32_16x16x32_bf16 v[176:179], a[176:179], a[228:231], v[176:179]
  ds_read_b64_tr_b16 a[206:207], v239 offset:13312
  v_mfma_f32_16x16x32_bf16 v[180:183], a[180:183], a[228:231], v[180:183]
  buffer_load_dwordx4 v235, s[48:51], s82 offen offset:3072 lds
  v_mfma_f32_16x16x32_bf16 v[184:187], a[184:187], a[228:231], v[184:187]
  buffer_store_dwordx4 v[40:43], v241, s[52:55], s76 offen offset:1024
  v_mfma_f32_16x16x32_bf16 v[188:191], a[188:191], a[228:231], v[188:191]
  v_cvt_pk_bf16_f32 v48, v48, v49
  v_cvt_pk_bf16_f32 v49, v50, v51
  v_cvt_pk_bf16_f32 v50, v52, v53
  v_cvt_pk_bf16_f32 v51, v54, v55
  s_waitcnt lgkmcnt(6)
  v_mfma_f32_16x16x32_bf16 v[96:99], a[192:195], a[232:235], v[96:99]
  s_mul_i32 s83, s20, 6144
  s_add_u32 s23, s23, 4
  s_waitcnt lgkmcnt(4)
  v_mfma_f32_16x16x32_bf16 v[100:103], a[196:199], a[232:235], v[100:103]
  v_add_u32 v240, s83, v222
  s_and_b32 s23, s23, 15
  s_waitcnt lgkmcnt(2)
  v_mfma_f32_16x16x32_bf16 v[104:107], a[200:203], a[232:235], v[104:107]
  ds_read_b128 a[208:211], v240
  s_waitcnt lgkmcnt(1)
  v_mfma_f32_16x16x32_bf16 v[108:111], a[204:207], a[232:235], v[108:111]
  ds_read_b128 a[212:215], v240 offset:256
  v_mfma_f32_16x16x32_bf16 v[112:115], a[192:195], a[236:239], v[112:115]
  ds_read_b128 a[216:219], v240 offset:1024
  v_mfma_f32_16x16x32_bf16 v[116:119], a[196:199], a[236:239], v[116:119]
  ds_read_b128 a[220:223], v240 offset:1280
  v_mfma_f32_16x16x32_bf16 v[120:123], a[200:203], a[236:239], v[120:123]
  ds_read_b128 a[224:227], v240 offset:2048
  v_mfma_f32_16x16x32_bf16 v[124:127], a[204:207], a[236:239], v[124:127]
  ds_read_b128 a[228:231], v240 offset:2304
  v_mfma_f32_16x16x32_bf16 v[128:131], a[192:195], a[240:243], v[128:131]
  s_lshl_b32 s82, s23, 15
  s_add_u32 s82, s82, s25
  v_mfma_f32_16x16x32_bf16 v[132:135], a[196:199], a[240:243], v[132:135]
  s_add_u32 m0, s74, 12288
  buffer_store_dwordx4 v[48:51], v241, s[52:55], s76 offen offset:2048
  v_mfma_f32_16x16x32_bf16 v[136:139], a[200:203], a[240:243], v[136:139]
  s_waitcnt vmcnt(15)
  ds_read_b64_tr_b16 a[176:177], v236
  v_cvt_pk_bf16_f32 v56, v56, v57
  v_cvt_pk_bf16_f32 v57, v58, v59
  v_mfma_f32_16x16x32_bf16 v[140:143], a[204:207], a[240:243], v[140:143]
  ds_read_b64_tr_b16 a[178:179], v236 offset:1024
  v_cvt_pk_bf16_f32 v58, v60, v61
  v_cvt_pk_bf16_f32 v59, v62, v63
  v_mfma_f32_16x16x32_bf16 v[144:147], a[192:195], a[244:247], v[144:147]
  buffer_load_dwordx4 v232, s[48:51], s82 offen lds
  v_mfma_f32_16x16x32_bf16 v[148:151], a[196:199], a[244:247], v[148:151]
  ds_read_b64_tr_b16 a[180:181], v237
  v_mfma_f32_16x16x32_bf16 v[152:155], a[200:203], a[244:247], v[152:155]
  ds_read_b64_tr_b16 a[182:183], v237 offset:1024
  v_mfma_f32_16x16x32_bf16 v[156:159], a[204:207], a[244:247], v[156:159]
  buffer_load_dwordx4 v233, s[48:51], s82 offen offset:1024 lds
  v_mfma_f32_16x16x32_bf16 v[160:163], a[192:195], a[248:251], v[160:163]
  ds_read_b64_tr_b16 a[184:185], v238
  v_mfma_f32_16x16x32_bf16 v[164:167], a[196:199], a[248:251], v[164:167]
  ds_read_b64_tr_b16 a[186:187], v238 offset:1024
  v_mfma_f32_16x16x32_bf16 v[168:171], a[200:203], a[248:251], v[168:171]
  buffer_load_dwordx4 v234, s[48:51], s82 offen offset:2048 lds
  v_mfma_f32_16x16x32_bf16 v[172:175], a[204:207], a[248:251], v[172:175]
  ds_read_b64_tr_b16 a[188:189], v239
  v_mfma_f32_16x16x32_bf16 v[176:179], a[192:195], a[252:255], v[176:179]
  ds_read_b64_tr_b16 a[190:191], v239 offset:1024
  v_mfma_f32_16x16x32_bf16 v[180:183], a[196:199], a[252:255], v[180:183]
  buffer_load_dwordx4 v235, s[48:51], s82 offen offset:3072 lds
  v_mfma_f32_16x16x32_bf16 v[184:187], a[200:203], a[252:255], v[184:187]
  buffer_store_dwordx4 v[56:59], v241, s[52:55], s76 offen offset:3072
  v_mfma_f32_16x16x32_bf16 v[188:191], a[204:207], a[252:255], v[188:191]
  v_cvt_pk_bf16_f32 v64, v64, v65
  v_cvt_pk_bf16_f32 v65, v66, v67
  v_cvt_pk_bf16_f32 v66, v68, v69
  v_cvt_pk_bf16_f32 v67, v70, v71
  s_add_u32 s76, s76, 4096
  buffer_store_dwordx4 v[64:67], v241, s[52:55], s76 offen
  v_cvt_pk_bf16_f32 v72, v72, v73
  s_waitcnt lgkmcnt(6)
  v_mfma_f32_16x16x32_bf16 v[96:99], a[176:179], a[208:211], v[96:99]
  s_mul_i32 s83, s21, 6144
  s_add_u32 s20, s20, 4
  v_cvt_pk_bf16_f32 v73, v74, v75
  s_waitcnt lgkmcnt(4)
  v_mfma_f32_16x16x32_bf16 v[100:103], a[180:183], a[208:211], v[100:103]
  v_add_u32 v240, s83, v222
  s_and_b32 s20, s20, 15
  v_cvt_pk_bf16_f32 v74, v76, v77
  s_waitcnt lgkmcnt(2)
  v_mfma_f32_16x16x32_bf16 v[104:107], a[184:187], a[208:211], v[104:107]
  ds_read_b128 a[232:235], v240
  s_waitcnt lgkmcnt(1)
  v_mfma_f32_16x16x32_bf16 v[108:111], a[188:191], a[208:211], v[108:111]
  ds_read_b128 a[236:239], v240 offset:256
  v_cvt_pk_bf16_f32 v75, v78, v79
  v_mfma_f32_16x16x32_bf16 v[112:115], a[176:179], a[212:215], v[112:115]
  ds_read_b128 a[240:243], v240 offset:1024
  v_mfma_f32_16x16x32_bf16 v[116:119], a[180:183], a[212:215], v[116:119]
  ds_read_b128 a[244:247], v240 offset:1280
  v_mfma_f32_16x16x32_bf16 v[120:123], a[184:187], a[212:215], v[120:123]
  ds_read_b128 a[248:251], v240 offset:2048
  v_mfma_f32_16x16x32_bf16 v[124:127], a[188:191], a[212:215], v[124:127]
  ds_read_b128 a[252:255], v240 offset:2304
  v_mfma_f32_16x16x32_bf16 v[128:131], a[176:179], a[216:219], v[128:131]
  s_lshl_b32 s82, s20, 15
  s_add_u32 s82, s82, s25
  v_mfma_f32_16x16x32_bf16 v[132:135], a[180:183], a[216:219], v[132:135]
  s_add_u32 m0, s74, 0
  buffer_store_dwordx4 v[72:75], v241, s[52:55], s76 offen offset:1024
  v_mfma_f32_16x16x32_bf16 v[136:139], a[184:187], a[216:219], v[136:139]
  s_waitcnt vmcnt(16)
  ds_read_b64_tr_b16 a[192:193], v236 offset:4096
  v_cvt_pk_bf16_f32 v80, v80, v81
  v_cvt_pk_bf16_f32 v81, v82, v83
  v_mfma_f32_16x16x32_bf16 v[140:143], a[188:191], a[216:219], v[140:143]
  ds_read_b64_tr_b16 a[194:195], v236 offset:5120
  v_cvt_pk_bf16_f32 v82, v84, v85
  v_mfma_f32_16x16x32_bf16 v[144:147], a[176:179], a[220:223], v[144:147]
  buffer_load_dwordx4 v232, s[48:51], s82 offen lds
  v_mfma_f32_16x16x32_bf16 v[148:151], a[180:183], a[220:223], v[148:151]
  ds_read_b64_tr_b16 a[196:197], v237 offset:4096
  v_cvt_pk_bf16_f32 v83, v86, v87
  v_mfma_f32_16x16x32_bf16 v[152:155], a[184:187], a[220:223], v[152:155]
  ds_read_b64_tr_b16 a[198:199], v237 offset:5120
  v_mfma_f32_16x16x32_bf16 v[156:159], a[188:191], a[220:223], v[156:159]
  buffer_load_dwordx4 v233, s[48:51], s82 offen offset:1024 lds
  v_mfma_f32_16x16x32_bf16 v[160:163], a[176:179], a[224:227], v[160:163]
  ds_read_b64_tr_b16 a[200:201], v238 offset:4096
  v_mfma_f32_16x16x32_bf16 v[164:167], a[180:183], a[224:227], v[164:167]
  ds_read_b64_tr_b16 a[202:203], v238 offset:5120
  v_mfma_f32_16x16x32_bf16 v[168:171], a[184:187], a[224:227], v[168:171]
  buffer_load_dwordx4 v234, s[48:51], s82 offen offset:2048 lds
  v_mfma_f32_16x16x32_bf16 v[172:175], a[188:191], a[224:227], v[172:175]
  ds_read_b64_tr_b16 a[204:205], v239 offset:4096
  v_mfma_f32_16x16x32_bf16 v[176:179], a[176:179], a[228:231], v[176:179]
  ds_read_b64_tr_b16 a[206:207], v239 offset:5120
  v_mfma_f32_16x16x32_bf16 v[180:183], a[180:183], a[228:231], v[180:183]
  buffer_load_dwordx4 v235, s[48:51], s82 offen offset:3072 lds
  v_mfma_f32_16x16x32_bf16 v[184:187], a[184:187], a[228:231], v[184:187]
  buffer_store_dwordx4 v[80:83], v241, s[52:55], s76 offen offset:2048
  v_mfma_f32_16x16x32_bf16 v[188:191], a[188:191], a[228:231], v[188:191]
  v_cvt_pk_bf16_f32 v88, v88, v89
  v_cvt_pk_bf16_f32 v89, v90, v91
  v_cvt_pk_bf16_f32 v90, v92, v93
  v_cvt_pk_bf16_f32 v91, v94, v95
  buffer_store_dwordx4 v[88:91], v241, s[52:55], s76 offen offset:3072
  s_waitcnt lgkmcnt(6)
  v_mfma_f32_16x16x32_bf16 v[96:99], a[192:195], a[232:235], v[96:99]
  s_mul_i32 s83, s22, 6144
  s_add_u32 s21, s21, 4
  v_lshrrev_b32 v200, 4, v241
  s_waitcnt lgkmcnt(4)
  v_mfma_f32_16x16x32_bf16 v[100:103], a[196:199], a[232:235], v[100:103]
  v_add_u32 v240, s83, v222
  s_and_b32 s21, s21, 15
  v_and_b32 v201, 3, v200
  s_waitcnt lgkmcnt(2)
  v_mfma_f32_16x16x32_bf16 v[104:107], a[200:203], a[232:235], v[104:107]
  ds_read_b128 a[208:211], v240
  v_bfe_u32 v202, v200, 3, 1
  s_waitcnt lgkmcnt(1)
  v_mfma_f32_16x16x32_bf16 v[108:111], a[204:207], a[232:235], v[108:111]
  ds_read_b128 a[212:215], v240 offset:256
  v_lshlrev_b32 v202, 2, v202
  v_mfma_f32_16x16x32_bf16 v[112:115], a[192:195], a[236:239], v[112:115]
  ds_read_b128 a[216:219], v240 offset:1024
  v_add_u32 v201, v201, v202
  v_mfma_f32_16x16x32_bf16 v[116:119], a[196:199], a[236:239], v[116:119]
  ds_read_b128 a[220:223], v240 offset:1280
  v_mfma_f32_16x16x32_bf16 v[120:123], a[200:203], a[236:239], v[120:123]
  ds_read_b128 a[224:227], v240 offset:2048
  v_bfe_u32 v202, v200, 2, 1
  v_mfma_f32_16x16x32_bf16 v[124:127], a[204:207], a[236:239], v[124:127]
  ds_read_b128 a[228:231], v240 offset:2304
  v_lshlrev_b32 v202, 1, v202
  v_mfma_f32_16x16x32_bf16 v[128:131], a[192:195], a[240:243], v[128:131]
  s_lshl_b32 s82, s21, 15
  s_add_u32 s82, s82, s25
  v_lshrrev_b32 v203, 4, v200
  v_mfma_f32_16x16x32_bf16 v[132:135], a[196:199], a[240:243], v[132:135]
  s_add_u32 m0, s74, 4096
  v_sub_u32 v202, v203, v202
  v_mfma_f32_16x16x32_bf16 v[136:139], a[200:203], a[240:243], v[136:139]
  s_waitcnt vmcnt(15)
  ds_read_b64_tr_b16 a[176:177], v236 offset:8192
  v_lshlrev_b32 v202, 3, v202
  v_mfma_f32_16x16x32_bf16 v[140:143], a[204:207], a[240:243], v[140:143]
  ds_read_b64_tr_b16 a[178:179], v236 offset:9216
  v_mfma_f32_16x16x32_bf16 v[144:147], a[192:195], a[244:247], v[144:147]
  buffer_load_dwordx4 v232, s[48:51], s82 offen lds
  v_add_u32 v201, v201, v202
  v_mfma_f32_16x16x32_bf16 v[148:151], a[196:199], a[244:247], v[148:151]
  ds_read_b64_tr_b16 a[180:181], v237 offset:8192
  v_mov_b32 v203, 0
  v_mfma_f32_16x16x32_bf16 v[152:155], a[200:203], a[244:247], v[152:155]
  ds_read_b64_tr_b16 a[182:183], v237 offset:9216
  v_mov_b32 v204, 0x3f80
  v_mfma_f32_16x16x32_bf16 v[156:159], a[204:207], a[244:247], v[156:159]
  buffer_load_dwordx4 v233, s[48:51], s82 offen offset:1024 lds
  v_mfma_f32_16x16x32_bf16 v[160:163], a[192:195], a[248:251], v[160:163]
  ds_read_b64_tr_b16 a[184:185], v238 offset:8192
  v_mov_b32 v205, 0x3f800000
  v_cmp_eq_u32 vcc, 0, v201
  v_mfma_f32_16x16x32_bf16 v[164:167], a[196:199], a[248:251], v[164:167]
  ds_read_b64_tr_b16 a[186:187], v238 offset:9216
  v_mfma_f32_16x16x32_bf16 v[168:171], a[200:203], a[248:251], v[168:171]
  buffer_load_dwordx4 v234, s[48:51], s82 offen offset:2048 lds
  v_cndmask_b32 v192, v203, v204, vcc
  v_mfma_f32_16x16x32_bf16 v[172:175], a[204:207], a[248:251], v[172:175]
  ds_read_b64_tr_b16 a[188:189], v239 offset:8192
  v_cmp_eq_u32 vcc, 1, v201
  v_mfma_f32_16x16x32_bf16 v[176:179], a[192:195], a[252:255], v[176:179]
  ds_read_b64_tr_b16 a[190:191], v239 offset:9216
  v_cndmask_b32 v192, v192, v205, vcc
  v_mfma_f32_16x16x32_bf16 v[180:183], a[196:199], a[252:255], v[180:183]
  buffer_load_dwordx4 v235, s[48:51], s82 offen offset:3072 lds
  v_cmp_eq_u32 vcc, 2, v201
  v_mfma_f32_16x16x32_bf16 v[184:187], a[200:203], a[252:255], v[184:187]
  s_nop 0
  v_cndmask_b32 v193, v203, v204, vcc
  v_mfma_f32_16x16x32_bf16 v[188:191], a[204:207], a[252:255], v[188:191]
  s_waitcnt lgkmcnt(6)
  v_mfma_f32_16x16x32_bf16 v[96:99], a[176:179], a[208:211], v[96:99]
  s_mul_i32 s83, s23, 6144
  s_add_u32 s22, s22, 4
  s_lshl_b32 s75, s31, 7
  s_waitcnt lgkmcnt(4)
  v_mfma_f32_16x16x32_bf16 v[100:103], a[180:183], a[208:211], v[100:103]
  v_add_u32 v240, s83, v222
  s_and_b32 s22, s22, 15
  s_waitcnt lgkmcnt(2)
  v_mfma_f32_16x16x32_bf16 v[104:107], a[184:187], a[208:211], v[104:107]
  ds_read_b128 a[232:235], v240
  s_lshl_b32 s78, s68, 2
  s_waitcnt lgkmcnt(1)
  v_mfma_f32_16x16x32_bf16 v[108:111], a[188:191], a[208:211], v[108:111]
  ds_read_b128 a[236:239], v240 offset:256
  v_mfma_f32_16x16x32_bf16 v[112:115], a[176:179], a[212:215], v[112:115]
  ds_read_b128 a[240:243], v240 offset:1024
  s_sub_u32 s75, s75, s78
  v_mfma_f32_16x16x32_bf16 v[116:119], a[180:183], a[212:215], v[116:119]
  ds_read_b128 a[244:247], v240 offset:1280
  v_mfma_f32_16x16x32_bf16 v[120:123], a[184:187], a[212:215], v[120:123]
  ds_read_b128 a[248:251], v240 offset:2048
  v_mfma_f32_16x16x32_bf16 v[124:127], a[188:191], a[212:215], v[124:127]
  ds_read_b128 a[252:255], v240 offset:2304
  s_add_u32 s75, s75, 12
  v_mfma_f32_16x16x32_bf16 v[128:131], a[176:179], a[216:219], v[128:131]
  s_lshl_b32 s82, s22, 15
  s_add_u32 s82, s82, s25
  v_mfma_f32_16x16x32_bf16 v[132:135], a[180:183], a[216:219], v[132:135]
  s_add_u32 m0, s74, 8192
  v_cmp_eq_u32 vcc, 0, v241
  v_mfma_f32_16x16x32_bf16 v[136:139], a[184:187], a[216:219], v[136:139]
  s_waitcnt vmcnt(13)
  ds_read_b64_tr_b16 a[192:193], v236 offset:12288
  v_mfma_f32_16x16x32_bf16 v[140:143], a[188:191], a[216:219], v[140:143]
  ds_read_b64_tr_b16 a[194:195], v236 offset:13312
  v_mfma_f32_16x16x32_bf16 v[144:147], a[176:179], a[220:223], v[144:147]
  buffer_load_dwordx4 v232, s[48:51], s82 offen lds
  v_mov_b32 v253, s75
  v_mfma_f32_16x16x32_bf16 v[148:151], a[180:183], a[220:223], v[148:151]
  ds_read_b64_tr_b16 a[196:197], v237 offset:12288
  v_mfma_f32_16x16x32_bf16 v[152:155], a[184:187], a[220:223], v[152:155]
  ds_read_b64_tr_b16 a[198:199], v237 offset:13312
  v_mov_b32 v254, 0x7ffffff0
  v_mfma_f32_16x16x32_bf16 v[156:159], a[188:191], a[220:223], v[156:159]
  buffer_load_dwordx4 v233, s[48:51], s82 offen offset:1024 lds
  v_mfma_f32_16x16x32_bf16 v[160:163], a[176:179], a[224:227], v[160:163]
  ds_read_b64_tr_b16 a[200:201], v238 offset:12288
  v_cndmask_b32 v253, v254, v253, vcc
  v_mfma_f32_16x16x32_bf16 v[164:167], a[180:183], a[224:227], v[164:167]
  ds_read_b64_tr_b16 a[202:203], v238 offset:13312
  v_mfma_f32_16x16x32_bf16 v[168:171], a[184:187], a[224:227], v[168:171]
  buffer_load_dwordx4 v234, s[48:51], s82 offen offset:2048 lds
  v_mfma_f32_16x16x32_bf16 v[172:175], a[188:191], a[224:227], v[172:175]
  ds_read_b64_tr_b16 a[204:205], v239 offset:12288
  v_mov_b32 v254, 1
  v_mfma_f32_16x16x32_bf16 v[176:179], a[176:179], a[228:231], v[176:179]
  ds_read_b64_tr_b16 a[206:207], v239 offset:13312
  v_mfma_f32_16x16x32_bf16 v[180:183], a[180:183], a[228:231], v[180:183]
  buffer_load_dwordx4 v235, s[48:51], s82 offen offset:3072 lds
  v_mfma_f32_16x16x32_bf16 v[184:187], a[184:187], a[228:231], v[184:187]
  s_waitcnt vmcnt(8)
  buffer_store_dword v254, v253, s[56:59], 0 offen
  v_mfma_f32_16x16x32_bf16 v[188:191], a[188:191], a[228:231], v[188:191]
  s_waitcnt lgkmcnt(6)
  v_mfma_f32_16x16x32_bf16 v[96:99], a[192:195], a[232:235], v[96:99]
  s_mul_i32 s83, s20, 6144
  s_add_u32 s23, s23, 4
  v_cmp_eq_u32 vcc, 3, v201
  s_nop 1
  v_cndmask_b32 v193, v193, v205, vcc
  s_waitcnt lgkmcnt(4)
  v_mfma_f32_16x16x32_bf16 v[100:103], a[196:199], a[232:235], v[100:103]
  v_add_u32 v240, s83, v222
  s_and_b32 s23, s23, 15
  v_cmp_eq_u32 vcc, 4, v201
  s_waitcnt lgkmcnt(2)
  v_mfma_f32_16x16x32_bf16 v[104:107], a[200:203], a[232:235], v[104:107]
  ds_read_b128 a[208:211], v240
  v_cndmask_b32 v194, v203, v204, vcc
  v_cmp_eq_u32 vcc, 5, v201
  s_waitcnt lgkmcnt(1)
  v_mfma_f32_16x16x32_bf16 v[108:111], a[204:207], a[232:235], v[108:111]
  ds_read_b128 a[212:215], v240 offset:256
  v_cndmask_b32 v194, v194, v205, vcc
  v_mfma_f32_16x16x32_bf16 v[112:115], a[192:195], a[236:239], v[112:115]
  ds_read_b128 a[216:219], v240 offset:1024
  v_cmp_eq_u32 vcc, 6, v201
  s_nop 1
  v_cndmask_b32 v195, v203, v204, vcc
  v_mfma_f32_16x16x32_bf16 v[116:119], a[196:199], a[236:239], v[116:119]
  ds_read_b128 a[220:223], v240 offset:1280
  v_cmp_eq_u32 vcc, 7, v201
  v_mfma_f32_16x16x32_bf16 v[120:123], a[200:203], a[236:239], v[120:123]
  ds_read_b128 a[224:227], v240 offset:2048
  v_cndmask_b32 v195, v195, v205, vcc
  v_cmp_eq_u32 vcc, 8, v201
  v_mfma_f32_16x16x32_bf16 v[124:127], a[204:207], a[236:239], v[124:127]
  ds_read_b128 a[228:231], v240 offset:2304
  v_cndmask_b32 v196, v203, v204, vcc
  v_mfma_f32_16x16x32_bf16 v[128:131], a[192:195], a[240:243], v[128:131]
  s_lshl_b32 s82, s23, 15
  s_add_u32 s82, s82, s25
  v_cmp_eq_u32 vcc, 9, v201
  s_nop 1
  v_cndmask_b32 v196, v196, v205, vcc
  v_mfma_f32_16x16x32_bf16 v[132:135], a[196:199], a[240:243], v[132:135]
  s_add_u32 m0, s74, 12288
  v_cmp_eq_u32 vcc, 10, v201
  v_mfma_f32_16x16x32_bf16 v[136:139], a[200:203], a[240:243], v[136:139]
  ds_read_b64_tr_b16 a[176:177], v236
  v_cndmask_b32 v197, v203, v204, vcc
  v_cmp_eq_u32 vcc, 11, v201
  v_mfma_f32_16x16x32_bf16 v[140:143], a[204:207], a[240:243], v[140:143]
  ds_read_b64_tr_b16 a[178:179], v236 offset:1024
  v_cndmask_b32 v197, v197, v205, vcc
  v_mfma_f32_16x16x32_bf16 v[144:147], a[192:195], a[244:247], v[144:147]
  buffer_load_dwordx4 v232, s[48:51], s82 offen lds
  v_cmp_eq_u32 vcc, 12, v201
  v_mfma_f32_16x16x32_bf16 v[148:151], a[196:199], a[244:247], v[148:151]
  ds_read_b64_tr_b16 a[180:181], v237
  v_cndmask_b32 v198, v203, v204, vcc
  v_cmp_eq_u32 vcc, 13, v201
  v_mfma_f32_16x16x32_bf16 v[152:155], a[200:203], a[244:247], v[152:155]
  ds_read_b64_tr_b16 a[182:183], v237 offset:1024
  v_cndmask_b32 v198, v198, v205, vcc
  v_cmp_eq_u32 vcc, 14, v201
  v_mfma_f32_16x16x32_bf16 v[156:159], a[204:207], a[244:247], v[156:159]
  buffer_load_dwordx4 v233, s[48:51], s82 offen offset:1024 lds
  v_cndmask_b32 v199, v203, v204, vcc
  v_mfma_f32_16x16x32_bf16 v[160:163], a[192:195], a[248:251], v[160:163]
  ds_read_b64_tr_b16 a[184:185], v238
  v_cmp_eq_u32 vcc, 15, v201
  s_nop 1
  v_cndmask_b32 v199, v199, v205, vcc
  v_mfma_f32_16x16x32_bf16 v[164:167], a[196:199], a[248:251], v[164:167]
  ds_read_b64_tr_b16 a[186:187], v238 offset:1024
  v_and_b32 v201, 15, v200
  v_mfma_f32_16x16x32_bf16 v[168:171], a[200:203], a[248:251], v[168:171]
  buffer_load_dwordx4 v234, s[48:51], s82 offen offset:2048 lds
  v_lshlrev_b32 v201, 11, v201
  v_mfma_f32_16x16x32_bf16 v[172:175], a[204:207], a[248:251], v[172:175]
  ds_read_b64_tr_b16 a[188:189], v239
  v_lshrrev_b32 v202, 4, v200
  v_lshlrev_b32 v202, 4, v202
  v_mfma_f32_16x16x32_bf16 v[176:179], a[192:195], a[252:255], v[176:179]
  ds_read_b64_tr_b16 a[190:191], v239 offset:1024
  v_add_u32 v206, v201, v202
  v_bfe_u32 v252, v241, 4, 2
  v_mfma_f32_16x16x32_bf16 v[180:183], a[196:199], a[252:255], v[180:183]
  buffer_load_dwordx4 v235, s[48:51], s82 offen offset:3072 lds
  v_lshlrev_b32 v252, 2, v252
  v_mfma_f32_16x16x32_bf16 v[184:187], a[200:203], a[252:255], v[184:187]
  s_lshl_b32 s75, s70, 7
  s_add_u32 s75, s75, 0
  v_mfma_f32_16x16x32_bf16 v[188:191], a[204:207], a[252:255], v[188:191]
  v_add_u32 v252, s75, v252
  s_waitcnt lgkmcnt(6)
  v_mfma_f32_16x16x32_bf16 v[96:99], a[176:179], a[208:211], v[96:99]
  s_mul_i32 s83, s21, 6144
  s_add_u32 s20, s20, 4
  s_waitcnt lgkmcnt(4)
  v_mfma_f32_16x16x32_bf16 v[100:103], a[180:183], a[208:211], v[100:103]
  v_add_u32 v240, s83, v222
  s_and_b32 s20, s20, 15
  s_waitcnt lgkmcnt(2)
  v_mfma_f32_16x16x32_bf16 v[104:107], a[184:187], a[208:211], v[104:107]
  ds_read_b128 a[232:235], v240
  s_waitcnt lgkmcnt(1)
  v_mfma_f32_16x16x32_bf16 v[108:111], a[188:191], a[208:211], v[108:111]
  ds_read_b128 a[236:239], v240 offset:256
  v_mfma_f32_16x16x32_bf16 v[112:115], a[176:179], a[212:215], v[112:115]
  ds_read_b128 a[240:243], v240 offset:1024
  v_mfma_f32_16x16x32_bf16 v[116:119], a[180:183], a[212:215], v[116:119]
  ds_read_b128 a[244:247], v240 offset:1280
  v_mfma_f32_16x16x32_bf16 v[120:123], a[184:187], a[212:215], v[120:123]
  ds_read_b128 a[248:251], v240 offset:2048
  v_mfma_f32_16x16x32_bf16 v[124:127], a[188:191], a[212:215], v[124:127]
  ds_read_b128 a[252:255], v240 offset:2304
  v_mfma_f32_16x16x32_bf16 v[128:131], a[176:179], a[216:219], v[128:131]
  s_lshl_b32 s82, s20, 15
  s_add_u32 s82, s82, s25
  v_mfma_f32_16x16x32_bf16 v[132:135], a[180:183], a[216:219], v[132:135]
  s_add_u32 m0, s74, 0
  buffer_load_dword v255, v252, s[56:59], 0 offen sc1
  v_mfma_f32_16x16x32_bf16 v[136:139], a[184:187], a[216:219], v[136:139]
  s_waitcnt vmcnt(10)
  ds_read_b64_tr_b16 a[192:193], v236 offset:4096
  v_mfma_f32_16x16x32_bf16 v[140:143], a[188:191], a[216:219], v[140:143]
  ds_read_b64_tr_b16 a[194:195], v236 offset:5120
  v_mfma_f32_16x16x32_bf16 v[144:147], a[176:179], a[220:223], v[144:147]
  buffer_load_dwordx4 v232, s[48:51], s82 offen lds
  v_mfma_f32_16x16x32_bf16 v[148:151], a[180:183], a[220:223], v[148:151]
  ds_read_b64_tr_b16 a[196:197], v237 offset:4096
  v_mfma_f32_16x16x32_bf16 v[152:155], a[184:187], a[220:223], v[152:155]
  ds_read_b64_tr_b16 a[198:199], v237 offset:5120
  v_mfma_f32_16x16x32_bf16 v[156:159], a[188:191], a[220:223], v[156:159]
  buffer_load_dwordx4 v233, s[48:51], s82 offen offset:1024 lds
  v_mfma_f32_16x16x32_bf16 v[160:163], a[176:179], a[224:227], v[160:163]
  ds_read_b64_tr_b16 a[200:201], v238 offset:4096
  v_mfma_f32_16x16x32_bf16 v[164:167], a[180:183], a[224:227], v[164:167]
  ds_read_b64_tr_b16 a[202:203], v238 offset:5120
  v_mfma_f32_16x16x32_bf16 v[168:171], a[184:187], a[224:227], v[168:171]
  buffer_load_dwordx4 v234, s[48:51], s82 offen offset:2048 lds
  v_mfma_f32_16x16x32_bf16 v[172:175], a[188:191], a[224:227], v[172:175]
  ds_read_b64_tr_b16 a[204:205], v239 offset:4096
  v_mfma_f32_16x16x32_bf16 v[176:179], a[176:179], a[228:231], v[176:179]
  ds_read_b64_tr_b16 a[206:207], v239 offset:5120
  v_mfma_f32_16x16x32_bf16 v[180:183], a[180:183], a[228:231], v[180:183]
  buffer_load_dwordx4 v235, s[48:51], s82 offen offset:3072 lds
  v_mfma_f32_16x16x32_bf16 v[184:187], a[184:187], a[228:231], v[184:187]
  v_mfma_f32_16x16x32_bf16 v[188:191], a[188:191], a[228:231], v[188:191]
  s_waitcnt lgkmcnt(6)
  v_mfma_f32_16x16x32_bf16 v[96:99], a[192:195], a[232:235], v[96:99]
  s_mul_i32 s83, s22, 6144
  s_add_u32 s21, s21, 4
  s_waitcnt lgkmcnt(4)
  v_mfma_f32_16x16x32_bf16 v[100:103], a[196:199], a[232:235], v[100:103]
  v_add_u32 v240, s83, v222
  s_and_b32 s21, s21, 15
  s_waitcnt lgkmcnt(2)
  v_mfma_f32_16x16x32_bf16 v[104:107], a[200:203], a[232:235], v[104:107]
  ds_read_b128 a[208:211], v240
  s_waitcnt lgkmcnt(1)
  v_mfma_f32_16x16x32_bf16 v[108:111], a[204:207], a[232:235], v[108:111]
  ds_read_b128 a[212:215], v240 offset:256
  v_mfma_f32_16x16x32_bf16 v[112:115], a[192:195], a[236:239], v[112:115]
  ds_read_b128 a[216:219], v240 offset:1024
  v_mfma_f32_16x16x32_bf16 v[116:119], a[196:199], a[236:239], v[116:119]
  ds_read_b128 a[220:223], v240 offset:1280
  v_mfma_f32_16x16x32_bf16 v[120:123], a[200:203], a[236:239], v[120:123]
  ds_read_b128 a[224:227], v240 offset:2048
  v_mfma_f32_16x16x32_bf16 v[124:127], a[204:207], a[236:239], v[124:127]
  ds_read_b128 a[228:231], v240 offset:2304
  v_mfma_f32_16x16x32_bf16 v[128:131], a[192:195], a[240:243], v[128:131]
  s_lshl_b32 s82, s21, 15
  s_add_u32 s82, s82, s25
  v_mfma_f32_16x16x32_bf16 v[132:135], a[196:199], a[240:243], v[132:135]
  s_add_u32 m0, s74, 4096
  v_mfma_f32_16x16x32_bf16 v[136:139], a[200:203], a[240:243], v[136:139]
  s_waitcnt vmcnt(10)
  ds_read_b64_tr_b16 a[176:177], v236 offset:8192
  v_mfma_f32_16x16x32_bf16 v[140:143], a[204:207], a[240:243], v[140:143]
  ds_read_b64_tr_b16 a[178:179], v236 offset:9216
  v_mfma_f32_16x16x32_bf16 v[144:147], a[192:195], a[244:247], v[144:147]
  buffer_load_dwordx4 v232, s[48:51], s82 offen lds
  v_mfma_f32_16x16x32_bf16 v[148:151], a[196:199], a[244:247], v[148:151]
  ds_read_b64_tr_b16 a[180:181], v237 offset:8192
  v_mfma_f32_16x16x32_bf16 v[152:155], a[200:203], a[244:247], v[152:155]
  ds_read_b64_tr_b16 a[182:183], v237 offset:9216
  v_mfma_f32_16x16x32_bf16 v[156:159], a[204:207], a[244:247], v[156:159]
  buffer_load_dwordx4 v233, s[48:51], s82 offen offset:1024 lds
  v_mfma_f32_16x16x32_bf16 v[160:163], a[192:195], a[248:251], v[160:163]
  ds_read_b64_tr_b16 a[184:185], v238 offset:8192
  v_mfma_f32_16x16x32_bf16 v[164:167], a[196:199], a[248:251], v[164:167]
  ds_read_b64_tr_b16 a[186:187], v238 offset:9216
  v_mfma_f32_16x16x32_bf16 v[168:171], a[200:203], a[248:251], v[168:171]
  buffer_load_dwordx4 v234, s[48:51], s82 offen offset:2048 lds
  v_mfma_f32_16x16x32_bf16 v[172:175], a[204:207], a[248:251], v[172:175]
  ds_read_b64_tr_b16 a[188:189], v239 offset:8192
  v_mfma_f32_16x16x32_bf16 v[176:179], a[192:195], a[252:255], v[176:179]
  ds_read_b64_tr_b16 a[190:191], v239 offset:9216
  v_mfma_f32_16x16x32_bf16 v[180:183], a[196:199], a[252:255], v[180:183]
  buffer_load_dwordx4 v235, s[48:51], s82 offen offset:3072 lds
  v_mfma_f32_16x16x32_bf16 v[184:187], a[200:203], a[252:255], v[184:187]
  v_mfma_f32_16x16x32_bf16 v[188:191], a[204:207], a[252:255], v[188:191]
  s_mov_b32 s89, 0
L_poll_af:
  s_waitcnt vmcnt(8)
  v_cmp_eq_u32 vcc, 1, v255
  s_add_u32 s89, s89, 1
  s_nop 1
  s_cmp_eq_u64 vcc, -1
  s_cbranch_scc1 L_got_af
  s_cmp_gt_u32 s89, 200000
  s_cbranch_scc1 L_got_af
  buffer_load_dword v255, v252, s[56:59], 0 offen sc1
  s_waitcnt vmcnt(0)
  s_branch L_poll_af
L_got_af:
  s_waitcnt lgkmcnt(6)
  v_mfma_f32_16x16x32_bf16 v[96:99], a[176:179], a[208:211], v[96:99]
  s_mul_i32 s83, s23, 6144
  s_add_u32 s22, s22, 4
  s_mul_i32 s78, s68, 3072
  s_waitcnt lgkmcnt(4)
  v_mfma_f32_16x16x32_bf16 v[100:103], a[180:183], a[208:211], v[100:103]
  v_add_u32 v240, s83, v222
  s_and_b32 s22, s22, 15
  s_waitcnt lgkmcnt(2)
  v_mfma_f32_16x16x32_bf16 v[104:107], a[184:187], a[208:211], v[104:107]
  ds_read_b128 a[232:235], v240
  s_waitcnt lgkmcnt(1)
  v_mfma_f32_16x16x32_bf16 v[108:111], a[188:191], a[208:211], v[108:111]
  ds_read_b128 a[236:239], v240 offset:256
  s_mul_i32 s75, s70, 49152
  v_mfma_f32_16x16x32_bf16 v[112:115], a[176:179], a[212:215], v[112:115]
  ds_read_b128 a[240:243], v240 offset:1024
  v_mfma_f32_16x16x32_bf16 v[116:119], a[180:183], a[212:215], v[116:119]
  ds_read_b128 a[244:247], v240 offset:1280
  v_mfma_f32_16x16x32_bf16 v[120:123], a[184:187], a[212:215], v[120:123]
  ds_read_b128 a[248:251], v240 offset:2048
  s_add_u32 s84, s75, s78
  v_mfma_f32_16x16x32_bf16 v[124:127], a[188:191], a[212:215], v[124:127]
  ds_read_b128 a[252:255], v240 offset:2304
  v_mfma_f32_16x16x32_bf16 v[128:131], a[176:179], a[216:219], v[128:131]
  s_lshl_b32 s82, s22, 15
  s_add_u32 s82, s82, s25
  v_mfma_f32_16x16x32_bf16 v[132:135], a[180:183], a[216:219], v[132:135]
  s_add_u32 m0, s74, 8192
  buffer_load_dwordx4 a[0:3], v241, s[52:55], s84 offen sc1
  v_mfma_f32_16x16x32_bf16 v[136:139], a[184:187], a[216:219], v[136:139]
  ds_read_b64_tr_b16 a[192:193], v236 offset:12288
  v_mfma_f32_16x16x32_bf16 v[140:143], a[188:191], a[216:219], v[140:143]
  ds_read_b64_tr_b16 a[194:195], v236 offset:13312
  v_mfma_f32_16x16x32_bf16 v[144:147], a[176:179], a[220:223], v[144:147]
  buffer_load_dwordx4 v232, s[48:51], s82 offen lds
  v_mfma_f32_16x16x32_bf16 v[148:151], a[180:183], a[220:223], v[148:151]
  ds_read_b64_tr_b16 a[196:197], v237 offset:12288
  v_mfma_f32_16x16x32_bf16 v[152:155], a[184:187], a[220:223], v[152:155]
  ds_read_b64_tr_b16 a[198:199], v237 offset:13312
  v_mfma_f32_16x16x32_bf16 v[156:159], a[188:191], a[220:223], v[156:159]
  buffer_load_dwordx4 v233, s[48:51], s82 offen offset:1024 lds
  v_mfma_f32_16x16x32_bf16 v[160:163], a[176:179], a[224:227], v[160:163]
  ds_read_b64_tr_b16 a[200:201], v238 offset:12288
  v_mfma_f32_16x16x32_bf16 v[164:167], a[180:183], a[224:227], v[164:167]
  ds_read_b64_tr_b16 a[202:203], v238 offset:13312
  v_mfma_f32_16x16x32_bf16 v[168:171], a[184:187], a[224:227], v[168:171]
  buffer_load_dwordx4 v234, s[48:51], s82 offen offset:2048 lds
  v_mfma_f32_16x16x32_bf16 v[172:175], a[188:191], a[224:227], v[172:175]
  ds_read_b64_tr_b16 a[204:205], v239 offset:12288
  v_mfma_f32_16x16x32_bf16 v[176:179], a[176:179], a[228:231], v[176:179]
  ds_read_b64_tr_b16 a[206:207], v239 offset:13312
  v_mfma_f32_16x16x32_bf16 v[180:183], a[180:183], a[228:231], v[180:183]
  buffer_load_dwordx4 v235, s[48:51], s82 offen offset:3072 lds
  v_mfma_f32_16x16x32_bf16 v[184:187], a[184:187], a[228:231], v[184:187]
  buffer_load_dwordx4 a[4:7], v241, s[52:55], s84 offen offset:1024 sc1
  v_mfma_f32_16x16x32_bf16 v[188:191], a[188:191], a[228:231], v[188:191]
  buffer_load_dwordx4 a[8:11], v241, s[52:55], s84 offen offset:2048 sc1
  s_add_u32 s84, s84, 12288
  buffer_load_dwordx4 a[12:15], v241, s[52:55], s84 offen sc1
  s_waitcnt lgkmcnt(6)
  v_mfma_f32_16x16x32_bf16 v[96:99], a[192:195], a[232:235], v[96:99]
  s_mul_i32 s83, s20, 6144
  s_add_u32 s23, s23, 4
  s_waitcnt lgkmcnt(4)
  v_mfma_f32_16x16x32_bf16 v[100:103], a[196:199], a[232:235], v[100:103]
  v_add_u32 v240, s83, v222
  s_and_b32 s23, s23, 15
  s_waitcnt lgkmcnt(2)
  v_mfma_f32_16x16x32_bf16 v[104:107], a[200:203], a[232:235], v[104:107]
  ds_read_b128 a[208:211], v240
  s_waitcnt lgkmcnt(1)
  v_mfma_f32_16x16x32_bf16 v[108:111], a[204:207], a[232:235], v[108:111]
  ds_read_b128 a[212:215], v240 offset:256
  v_mfma_f32_16x16x32_bf16 v[112:115], a[192:195], a[236:239], v[112:115]
  ds_read_b128 a[216:219], v240 offset:1024
  v_mfma_f32_16x16x32_bf16 v[116:119], a[196:199], a[236:239], v[116:119]
  ds_read_b128 a[220:223], v240 offset:1280
  v_mfma_f32_16x16x32_bf16 v[120:123], a[200:203], a[236:239], v[120:123]
  ds_read_b128 a[224:227], v240 offset:2048
  v_mfma_f32_16x16x32_bf16 v[124:127], a[204:207], a[236:239], v[124:127]
  ds_read_b128 a[228:231], v240 offset:2304
  v_mfma_f32_16x16x32_bf16 v[128:131], a[192:195], a[240:243], v[128:131]
  s_lshl_b32 s82, s23, 15
  s_add_u32 s82, s82, s25
  v_mfma_f32_16x16x32_bf16 v[132:135], a[196:199], a[240:243], v[132:135]
  s_add_u32 m0, s74, 12288
  buffer_load_dwordx4 a[16:19], v241, s[52:55], s84 offen offset:1024 sc1
  v_mfma_f32_16x16x32_bf16 v[136:139], a[200:203], a[240:243], v[136:139]
  s_waitcnt vmcnt(13)
  ds_read_b64_tr_b16 a[176:177], v236
  v_mfma_f32_16x16x32_bf16 v[140:143], a[204:207], a[240:243], v[140:143]
  ds_read_b64_tr_b16 a[178:179], v236 offset:1024
  v_mfma_f32_16x16x32_bf16 v[144:147], a[192:195], a[244:247], v[144:147]
  buffer_load_dwordx4 v232, s[48:51], s82 offen lds
  v_mfma_f32_16x16x32_bf16 v[148:151], a[196:199], a[244:247], v[148:151]
  ds_read_b64_tr_b16 a[180:181], v237
  v_mfma_f32_16x16x32_bf16 v[152:155], a[200:203], a[244:247], v[152:155]
  ds_read_b64_tr_b16 a[182:183], v237 offset:1024
  v_mfma_f32_16x16x32_bf16 v[156:159], a[204:207], a[244:247], v[156:159]
  buffer_load_dwordx4 v233, s[48:51], s82 offen offset:1024 lds
  v_mfma_f32_16x16x32_bf16 v[160:163], a[192:195], a[248:251], v[160:163]
  ds_read_b64_tr_b16 a[184:185], v238
  v_mfma_f32_16x16x32_bf16 v[164:167], a[196:199], a[248:251], v[164:167]
  ds_read_b64_tr_b16 a[186:187], v238 offset:1024
  v_mfma_f32_16x16x32_bf16 v[168:171], a[200:203], a[248:251], v[168:171]
  buffer_load_dwordx4 v234, s[48:51], s82 offen offset:2048 lds
  v_mfma_f32_16x16x32_bf16 v[172:175], a[204:207], a[248:251], v[172:175]
  ds_read_b64_tr_b16 a[188:189], v239
  v_mfma_f32_16x16x32_bf16 v[176:179], a[192:195], a[252:255], v[176:179]
  ds_read_b64_tr_b16 a[190:191], v239 offset:1024
  v_mfma_f32_16x16x32_bf16 v[180:183], a[196:199], a[252:255], v[180:183]
  buffer_load_dwordx4 v235, s[48:51], s82 offen offset:3072 lds
  v_mfma_f32_16x16x32_bf16 v[184:187], a[200:203], a[252:255], v[184:187]
  buffer_load_dwordx4 a[20:23], v241, s[52:55], s84 offen offset:2048 sc1
  s_add_u32 s84, s84, 12288
  v_mfma_f32_16x16x32_bf16 v[188:191], a[204:207], a[252:255], v[188:191]
  buffer_load_dwordx4 a[24:27], v241, s[52:55], s84 offen sc1
  buffer_load_dwordx4 a[28:31], v241, s[52:55], s84 offen offset:1024 sc1
  s_waitcnt lgkmcnt(6)
  v_mfma_f32_16x16x32_bf16 v[96:99], a[176:179], a[208:211], v[96:99]
  s_mul_i32 s83, s21, 6144
  buffer_load_dwordx4 a[32:35], v241, s[52:55], s84 offen offset:2048 sc1
  s_waitcnt lgkmcnt(4)
  v_mfma_f32_16x16x32_bf16 v[100:103], a[180:183], a[208:211], v[100:103]
  v_add_u32 v240, s83, v222
  s_waitcnt lgkmcnt(2)
  v_mfma_f32_16x16x32_bf16 v[104:107], a[184:187], a[208:211], v[104:107]
  ds_read_b128 a[232:235], v240
  s_waitcnt lgkmcnt(1)
  v_mfma_f32_16x16x32_bf16 v[108:111], a[188:191], a[208:211], v[108:111]
  ds_read_b128 a[236:239], v240 offset:256
  v_mfma_f32_16x16x32_bf16 v[112:115], a[176:179], a[212:215], v[112:115]
  ds_read_b128 a[240:243], v240 offset:1024
  s_add_u32 s84, s84, 12288
  v_mfma_f32_16x16x32_bf16 v[116:119], a[180:183], a[212:215], v[116:119]
  ds_read_b128 a[244:247], v240 offset:1280
  v_mfma_f32_16x16x32_bf16 v[120:123], a[184:187], a[212:215], v[120:123]
  ds_read_b128 a[248:251], v240 offset:2048
  v_mfma_f32_16x16x32_bf16 v[124:127], a[188:191], a[212:215], v[124:127]
  ds_read_b128 a[252:255], v240 offset:2304
  v_mfma_f32_16x16x32_bf16 v[128:131], a[176:179], a[216:219], v[128:131]
  v_mfma_f32_16x16x32_bf16 v[132:135], a[180:183], a[216:219], v[132:135]
  buffer_load_dwordx4 a[36:39], v241, s[52:55], s84 offen sc1
  v_mfma_f32_16x16x32_bf16 v[136:139], a[184:187], a[216:219], v[136:139]
  s_waitcnt vmcnt(18)
  ds_read_b64_tr_b16 a[192:193], v236 offset:4096
  v_mfma_f32_16x16x32_bf16 v[140:143], a[188:191], a[216:219], v[140:143]
  ds_read_b64_tr_b16 a[194:195], v236 offset:5120
  v_mfma_f32_16x16x32_bf16 v[144:147], a[176:179], a[220:223], v[144:147]
  v_mfma_f32_16x16x32_bf16 v[148:151], a[180:183], a[220:223], v[148:151]
  ds_read_b64_tr_b16 a[196:197], v237 offset:4096
  v_mfma_f32_16x16x32_bf16 v[152:155], a[184:187], a[220:223], v[152:155]
  ds_read_b64_tr_b16 a[198:199], v237 offset:5120
  v_mfma_f32_16x16x32_bf16 v[156:159], a[188:191], a[220:223], v[156:159]
  buffer_load_dwordx4 a[40:43], v241, s[52:55], s84 offen offset:1024 sc1
  v_mfma_f32_16x16x32_bf16 v[160:163], a[176:179], a[224:227], v[160:163]
  ds_read_b64_tr_b16 a[200:201], v238 offset:4096
  v_mfma_f32_16x16x32_bf16 v[164:167], a[180:183], a[224:227], v[164:167]
  ds_read_b64_tr_b16 a[202:203], v238 offset:5120
  v_mfma_f32_16x16x32_bf16 v[168:171], a[184:187], a[224:227], v[168:171]
  v_mfma_f32_16x16x32_bf16 v[172:175], a[188:191], a[224:227], v[172:175]
  ds_read_b64_tr_b16 a[204:205], v239 offset:4096
  v_mfma_f32_16x16x32_bf16 v[176:179], a[176:179], a[228:231], v[176:179]
  ds_read_b64_tr_b16 a[206:207], v239 offset:5120
  v_mfma_f32_16x16x32_bf16 v[180:183], a[180:183], a[228:231], v[180:183]
  buffer_load_dwordx4 a[44:47], v241, s[52:55], s84 offen offset:2048 sc1
  v_mfma_f32_16x16x32_bf16 v[184:187], a[184:187], a[228:231], v[184:187]
  v_mfma_f32_16x16x32_bf16 v[188:191], a[188:191], a[228:231], v[188:191]
  s_waitcnt lgkmcnt(6)
  v_mfma_f32_16x16x32_bf16 v[96:99], a[192:195], a[232:235], v[96:99]
  s_mul_i32 s83, s22, 6144
  s_waitcnt lgkmcnt(4)
  v_mfma_f32_16x16x32_bf16 v[100:103], a[196:199], a[232:235], v[100:103]
  v_add_u32 v240, s83, v222
  s_waitcnt lgkmcnt(2)
  v_mfma_f32_16x16x32_bf16 v[104:107], a[200:203], a[232:235], v[104:107]
  ds_read_b128 a[208:211], v240
  s_waitcnt lgkmcnt(1)
  v_mfma_f32_16x16x32_bf16 v[108:111], a[204:207], a[232:235], v[108:111]
  ds_read_b128 a[212:215], v240 offset:256
  v_mfma_f32_16x16x32_bf16 v[112:115], a[192:195], a[236:239], v[112:115]
  ds_read_b128 a[216:219], v240 offset:1024
  v_mfma_f32_16x16x32_bf16 v[116:119], a[196:199], a[236:239], v[116:119]
  ds_read_b128 a[220:223], v240 offset:1280
  v_mfma_f32_16x16x32_bf16 v[120:123], a[200:203], a[236:239], v[120:123]
  ds_read_b128 a[224:227], v240 offset:2048
  v_mfma_f32_16x16x32_bf16 v[124:127], a[204:207], a[236:239], v[124:127]
  ds_read_b128 a[228:231], v240 offset:2304
  v_mfma_f32_16x16x32_bf16 v[128:131], a[192:195], a[240:243], v[128:131]
  v_mfma_f32_16x16x32_bf16 v[132:135], a[196:199], a[240:243], v[132:135]
  v_mfma_f32_16x16x32_bf16 v[136:139], a[200:203], a[240:243], v[136:139]
  s_waitcnt vmcnt(15)
  ds_read_b64_tr_b16 a[176:177], v236 offset:8192
  v_mfma_f32_16x16x32_bf16 v[140:143], a[204:207], a[240:243], v[140:143]
  ds_read_b64_tr_b16 a[178:179], v236 offset:9216
  v_mfma_f32_16x16x32_bf16 v[144:147], a[192:195], a[244:247], v[144:147]
  v_mfma_f32_16x16x32_bf16 v[148:151], a[196:199], a[244:247], v[148:151]
  ds_read_b64_tr_b16 a[180:181], v237 offset:8192
  v_mfma_f32_16x16x32_bf16 v[152:155], a[200:203], a[244:247], v[152:155]
  ds_read_b64_tr_b16 a[182:183], v237 offset:9216
  v_mfma_f32_16x16x32_bf16 v[156:159], a[204:207], a[244:247], v[156:159]
  v_mfma_f32_16x16x32_bf16 v[160:163], a[192:195], a[248:251], v[160:163]
  ds_read_b64_tr_b16 a[184:185], v238 offset:8192
  v_mfma_f32_16x16x32_bf16 v[164:167], a[196:199], a[248:251], v[164:167]
  ds_read_b64_tr_b16 a[186:187], v238 offset:9216
  v_mfma_f32_16x16x32_bf16 v[168:171], a[200:203], a[248:251], v[168:171]
  v_mfma_f32_16x16x32_bf16 v[172:175], a[204:207], a[248:251], v[172:175]
  ds_read_b64_tr_b16 a[188:189], v239 offset:8192
  v_mfma_f32_16x16x32_bf16 v[176:179], a[192:195], a[252:255], v[176:179]
  ds_read_b64_tr_b16 a[190:191], v239 offset:9216
  v_mfma_f32_16x16x32_bf16 v[180:183], a[196:199], a[252:255], v[180:183]
  v_mfma_f32_16x16x32_bf16 v[184:187], a[200:203], a[252:255], v[184:187]
  v_mfma_f32_16x16x32_bf16 v[188:191], a[204:207], a[252:255], v[188:191]
  s_waitcnt lgkmcnt(6)
  v_mfma_f32_16x16x32_bf16 v[96:99], a[176:179], a[208:211], v[96:99]
  s_mul_i32 s83, s23, 6144
  s_lshl_b32 s75, s70, 7
  s_waitcnt lgkmcnt(4)
  v_mfma_f32_16x16x32_bf16 v[100:103], a[180:183], a[208:211], v[100:103]
  v_add_u32 v240, s83, v222
  s_lshl_b32 s78, s68, 2
  s_waitcnt lgkmcnt(2)
  v_mfma_f32_16x16x32_bf16 v[104:107], a[184:187], a[208:211], v[104:107]
  ds_read_b128 a[232:235], v240
  s_waitcnt lgkmcnt(1)
  v_mfma_f32_16x16x32_bf16 v[108:111], a[188:191], a[208:211], v[108:111]
  ds_read_b128 a[236:239], v240 offset:256
  s_add_u32 s75, s75, s78
  v_mfma_f32_16x16x32_bf16 v[112:115], a[176:179], a[212:215], v[112:115]
  ds_read_b128 a[240:243], v240 offset:1024
  s_add_u32 s75, s75, 32
  v_mfma_f32_16x16x32_bf16 v[116:119], a[180:183], a[212:215], v[116:119]
  ds_read_b128 a[244:247], v240 offset:1280
  v_mfma_f32_16x16x32_bf16 v[120:123], a[184:187], a[212:215], v[120:123]
  ds_read_b128 a[248:251], v240 offset:2048
  v_cmp_eq_u32 vcc, 0, v241
  v_mfma_f32_16x16x32_bf16 v[124:127], a[188:191], a[212:215], v[124:127]
  ds_read_b128 a[252:255], v240 offset:2304
  v_mfma_f32_16x16x32_bf16 v[128:131], a[176:179], a[216:219], v[128:131]
  v_mov_b32 v253, s75
  v_mfma_f32_16x16x32_bf16 v[132:135], a[180:183], a[216:219], v[132:135]
  v_mov_b32 v254, 0x7ffffff0
  v_mfma_f32_16x16x32_bf16 v[136:139], a[184:187], a[216:219], v[136:139]
  s_waitcnt vmcnt(7)
  ds_read_b64_tr_b16 a[192:193], v236 offset:12288
  v_mfma_f32_16x16x32_bf16 v[140:143], a[188:191], a[216:219], v[140:143]
  ds_read_b64_tr_b16 a[194:195], v236 offset:13312
  v_cndmask_b32 v253, v254, v253, vcc
  v_mfma_f32_16x16x32_bf16 v[144:147], a[176:179], a[220:223], v[144:147]
  v_mov_b32 v254, 1
  v_mfma_f32_16x16x32_bf16 v[148:151], a[180:183], a[220:223], v[148:151]
  ds_read_b64_tr_b16 a[196:197], v237 offset:12288
  v_mfma_f32_16x16x32_bf16 v[152:155], a[184:187], a[220:223], v[152:155]
  ds_read_b64_tr_b16 a[198:199], v237 offset:13312
  v_mfma_f32_16x16x32_bf16 v[156:159], a[188:191], a[220:223], v[156:159]
  s_waitcnt vmcnt(0)
  buffer_store_dword v254, v253, s[56:59], 0 offen
  v_mfma_f32_16x16x32_bf16 v[160:163], a[176:179], a[224:227], v[160:163]
  ds_read_b64_tr_b16 a[200:201], v238 offset:12288
  v_bfe_u32 v252, v241, 4, 2
  v_mfma_f32_16x16x32_bf16 v[164:167], a[180:183], a[224:227], v[164:167]
  ds_read_b64_tr_b16 a[202:203], v238 offset:13312
  v_lshlrev_b32 v252, 2, v252
  v_mfma_f32_16x16x32_bf16 v[168:171], a[184:187], a[224:227], v[168:171]
  v_mfma_f32_16x16x32_bf16 v[172:175], a[188:191], a[224:227], v[172:175]
  ds_read_b64_tr_b16 a[204:205], v239 offset:12288
  s_lshl_b32 s75, s3, 7
  v_mfma_f32_16x16x32_bf16 v[176:179], a[176:179], a[228:231], v[176:179]
  ds_read_b64_tr_b16 a[206:207], v239 offset:13312
  s_add_u32 s75, s75, 32
  v_mfma_f32_16x16x32_bf16 v[180:183], a[180:183], a[228:231], v[180:183]
  v_mfma_f32_16x16x32_bf16 v[184:187], a[184:187], a[228:231], v[184:187]
  v_add_u32 v252, s75, v252
  v_mfma_f32_16x16x32_bf16 v[188:191], a[188:191], a[228:231], v[188:191]
  s_waitcnt lgkmcnt(6)
  v_mfma_f32_16x16x32_bf16 v[96:99], a[192:195], a[232:235], v[96:99]
  buffer_load_dword v255, v252, s[56:59], 0 offen sc1
  s_waitcnt lgkmcnt(4)
  v_mfma_f32_16x16x32_bf16 v[100:103], a[196:199], a[232:235], v[100:103]
  s_waitcnt lgkmcnt(2)
  v_mfma_f32_16x16x32_bf16 v[104:107], a[200:203], a[232:235], v[104:107]
  s_waitcnt lgkmcnt(0)
  v_mfma_f32_16x16x32_bf16 v[108:111], a[204:207], a[232:235], v[108:111]
  v_mfma_f32_16x16x32_bf16 v[112:115], a[192:195], a[236:239], v[112:115]
  v_mfma_f32_16x16x32_bf16 v[116:119], a[196:199], a[236:239], v[116:119]
  v_mfma_f32_16x16x32_bf16 v[120:123], a[200:203], a[236:239], v[120:123]
  v_mfma_f32_16x16x32_bf16 v[124:127], a[204:207], a[236:239], v[124:127]
  v_mfma_f32_16x16x32_bf16 v[128:131], a[192:195], a[240:243], v[128:131]
  v_mfma_f32_16x16x32_bf16 v[132:135], a[196:199], a[240:243], v[132:135]
  v_mfma_f32_16x16x32_bf16 v[136:139], a[200:203], a[240:243], v[136:139]
  v_mfma_f32_16x16x32_bf16 v[140:143], a[204:207], a[240:243], v[140:143]
  v_mfma_f32_16x16x32_bf16 v[144:147], a[192:195], a[244:247], v[144:147]
  v_mfma_f32_16x16x32_bf16 v[148:151], a[196:199], a[244:247], v[148:151]
  v_mfma_f32_16x16x32_bf16 v[152:155], a[200:203], a[244:247], v[152:155]
  v_mfma_f32_16x16x32_bf16 v[156:159], a[204:207], a[244:247], v[156:159]
  v_mfma_f32_16x16x32_bf16 v[160:163], a[192:195], a[248:251], v[160:163]
  v_mfma_f32_16x16x32_bf16 v[164:167], a[196:199], a[248:251], v[164:167]
  v_mfma_f32_16x16x32_bf16 v[168:171], a[200:203], a[248:251], v[168:171]
  v_mfma_f32_16x16x32_bf16 v[172:175], a[204:207], a[248:251], v[172:175]
  v_mfma_f32_16x16x32_bf16 v[176:179], a[192:195], a[252:255], v[176:179]
  v_mfma_f32_16x16x32_bf16 v[180:183], a[196:199], a[252:255], v[180:183]
  v_mfma_f32_16x16x32_bf16 v[184:187], a[200:203], a[252:255], v[184:187]
  v_mfma_f32_16x16x32_bf16 v[188:191], a[204:207], a[252:255], v[188:191]
  s_mov_b32 s89, 0
L_poll_cf:
  s_waitcnt vmcnt(0)
  v_cmp_eq_u32 vcc, 1, v255
  s_add_u32 s89, s89, 1
  s_nop 1
  s_cmp_eq_u64 vcc, -1
  s_cbranch_scc1 L_got_cf
  s_cmp_gt_u32 s89, 200000
  s_cbranch_scc1 L_got_cf
  buffer_load_dword v255, v252, s[56:59], 0 offen sc1
  s_waitcnt vmcnt(0)
  s_branch L_poll_cf
L_got_cf:
  s_lshl_b32 s77, s3, 2
  s_add_u32 s77, s77, s68
  s_mul_i32 s77, s77, 12288
  s_cmp_eq_u32 s68, 0
  s_cselect_b32 s77, 0x7ff00000, s77
  v_cvt_pk_bf16_f32 v96, v96, v97
  v_cvt_pk_bf16_f32 v97, v98, v99
  v_cvt_pk_bf16_f32 v98, v100, v101
  v_cvt_pk_bf16_f32 v99, v102, v103
  buffer_store_dwordx4 v[96:99], v241, s[52:55], s77 offen
  v_cvt_pk_bf16_f32 v104, v104, v105
  v_cvt_pk_bf16_f32 v105, v106, v107
  v_cvt_pk_bf16_f32 v106, v108, v109
  v_cvt_pk_bf16_f32 v107, v110, v111
  buffer_store_dwordx4 v[104:107], v241, s[52:55], s77 offen offset:1024
  v_cvt_pk_bf16_f32 v112, v112, v113
  v_cvt_pk_bf16_f32 v113, v114, v115
  v_cvt_pk_bf16_f32 v114, v116, v117
  v_cvt_pk_bf16_f32 v115, v118, v119
  buffer_store_dwordx4 v[112:115], v241, s[52:55], s77 offen offset:2048
  v_cvt_pk_bf16_f32 v120, v120, v121
  v_cvt_pk_bf16_f32 v121, v122, v123
  v_cvt_pk_bf16_f32 v122, v124, v125
  v_cvt_pk_bf16_f32 v123, v126, v127
  buffer_store_dwordx4 v[120:123], v241, s[52:55], s77 offen offset:3072
  v_cvt_pk_bf16_f32 v128, v128, v129
  v_cvt_pk_bf16_f32 v129, v130, v131
  v_cvt_pk_bf16_f32 v130, v132, v133
  v_cvt_pk_bf16_f32 v131, v134, v135
  s_add_u32 s77, s77, 4096
  buffer_store_dwordx4 v[128:131], v241, s[52:55], s77 offen
  v_cvt_pk_bf16_f32 v136, v136, v137
  v_cvt_pk_bf16_f32 v137, v138, v139
  v_cvt_pk_bf16_f32 v138, v140, v141
  v_cvt_pk_bf16_f32 v139, v142, v143
  buffer_store_dwordx4 v[136:139], v241, s[52:55], s77 offen offset:1024
  v_cvt_pk_bf16_f32 v144, v144, v145
  v_cvt_pk_bf16_f32 v145, v146, v147
  v_cvt_pk_bf16_f32 v146, v148, v149
  v_cvt_pk_bf16_f32 v147, v150, v151
  buffer_store_dwordx4 v[144:147], v241, s[52:55], s77 offen offset:2048
  v_cvt_pk_bf16_f32 v152, v152, v153
  v_cvt_pk_bf16_f32 v153, v154, v155
  v_cvt_pk_bf16_f32 v154, v156, v157
  v_cvt_pk_bf16_f32 v155, v158, v159
  buffer_store_dwordx4 v[152:155], v241, s[52:55], s77 offen offset:3072
  v_cvt_pk_bf16_f32 v160, v160, v161
  v_cvt_pk_bf16_f32 v161, v162, v163
  v_cvt_pk_bf16_f32 v162, v164, v165
  v_cvt_pk_bf16_f32 v163, v166, v167
  s_add_u32 s77, s77, 4096
  buffer_store_dwordx4 v[160:163], v241, s[52:55], s77 offen
  v_cvt_pk_bf16_f32 v168, v168, v169
  v_cvt_pk_bf16_f32 v169, v170, v171
  v_cvt_pk_bf16_f32 v170, v172, v173
  v_cvt_pk_bf16_f32 v171, v174, v175
  buffer_store_dwordx4 v[168:171], v241, s[52:55], s77 offen offset:1024
  v_cvt_pk_bf16_f32 v176, v176, v177
  v_cvt_pk_bf16_f32 v177, v178, v179
  v_cvt_pk_bf16_f32 v178, v180, v181
  v_cvt_pk_bf16_f32 v179, v182, v183
  buffer_store_dwordx4 v[176:179], v241, s[52:55], s77 offen offset:2048
  v_cvt_pk_bf16_f32 v184, v184, v185
  v_cvt_pk_bf16_f32 v185, v186, v187
  v_cvt_pk_bf16_f32 v186, v188, v189
  v_cvt_pk_bf16_f32 v187, v190, v191
  buffer_store_dwordx4 v[184:187], v241, s[52:55], s77 offen offset:3072
  s_cmp_eq_u32 s68, 0
  s_cbranch_scc0 L_noown_f
  v_add_u32 v253, 98304, v241
  ds_write_b128 v253, v[96:99]
  ds_write_b128 v253, v[104:107] offset:1024
  ds_write_b128 v253, v[112:115] offset:2048
  ds_write_b128 v253, v[120:123] offset:3072
  ds_write_b128 v253, v[128:131] offset:4096
  ds_write_b128 v253, v[136:139] offset:5120
  ds_write_b128 v253, v[144:147] offset:6144
  ds_write_b128 v253, v[152:155] offset:7168
  ds_write_b128 v253, v[160:163] offset:8192
  ds_write_b128 v253, v[168:171] offset:9216
  ds_write_b128 v253, v[176:179] offset:10240
  ds_write_b128 v253, v[184:187] offset:11264
L_noown_f:
  s_waitcnt lgkmcnt(0)
  s_barrier
  s_mul_i32 s75, s68, 3072
  s_add_u32 s75, s75, 98304
  v_add_u32 v253, s75, v241
  ds_read_b128 a[48:51], v253
  ds_read_b128 a[52:55], v253 offset:1024
  ds_read_b128 a[56:59], v253 offset:2048
  v_mfma_f32_16x16x32_bf16 v[0:3], v[192:195], a[0:3], 0
  v_mfma_f32_16x16x32_bf16 v[4:7], v[196:199], a[0:3], 0
  v_mfma_f32_16x16x32_bf16 v[8:11], v[192:195], a[4:7], 0
  v_mfma_f32_16x16x32_bf16 v[12:15], v[196:199], a[4:7], 0
  v_mfma_f32_16x16x32_bf16 v[16:19], v[192:195], a[8:11], 0
  v_mfma_f32_16x16x32_bf16 v[20:23], v[196:199], a[8:11], 0
  v_mfma_f32_16x16x32_bf16 v[0:3], v[192:195], a[12:15], v[0:3]
  v_mfma_f32_16x16x32_bf16 v[4:7], v[196:199], a[12:15], v[4:7]
  v_mfma_f32_16x16x32_bf16 v[8:11], v[192:195], a[16:19], v[8:11]
  v_mfma_f32_16x16x32_bf16 v[12:15], v[196:199], a[16:19], v[12:15]
  v_mfma_f32_16x16x32_bf16 v[16:19], v[192:195], a[20:23], v[16:19]
  v_mfma_f32_16x16x32_bf16 v[20:23], v[196:199], a[20:23], v[20:23]
  v_mfma_f32_16x16x32_bf16 v[0:3], v[192:195], a[24:27], v[0:3]
  v_mfma_f32_16x16x32_bf16 v[4:7], v[196:199], a[24:27], v[4:7]
  v_mfma_f32_16x16x32_bf16 v[8:11], v[192:195], a[28:31], v[8:11]
  v_mfma_f32_16x16x32_bf16 v[12:15], v[196:199], a[28:31], v[12:15]
  v_mfma_f32_16x16x32_bf16 v[16:19], v[192:195], a[32:35], v[16:19]
  v_mfma_f32_16x16x32_bf16 v[20:23], v[196:199], a[32:35], v[20:23]
  v_mfma_f32_16x16x32_bf16 v[0:3], v[192:195], a[36:39], v[0:3]
  v_mfma_f32_16x16x32_bf16 v[4:7], v[196:199], a[36:39], v[4:7]
  v_mfma_f32_16x16x32_bf16 v[8:11], v[192:195], a[40:43], v[8:11]
  v_mfma_f32_16x16x32_bf16 v[12:15], v[196:199], a[40:43], v[12:15]
  v_mfma_f32_16x16x32_bf16 v[16:19], v[192:195], a[44:47], v[16:19]
  v_mfma_f32_16x16x32_bf16 v[20:23], v[196:199], a[44:47], v[20:23]
  v_bfe_u32 v252, v241, 4, 2
  v_max_u32 v252, 1, v252
  v_lshlrev_b32 v252, 2, v252
  s_lshl_b32 s75, s70, 7
  s_add_u32 s75, s75, 16
  v_add_u32 v252, s75, v252
  s_lshl_b32 s75, s3, 7
  s_lshl_b32 s78, s68, 2
  s_add_u32 s75, s75, s78
  s_add_u32 s75, s75, 16
  s_cmp_eq_u32 s68, 0
  s_cselect_b32 s75, 0x7ff00000, s75
  v_cmp_eq_u32 vcc, 0, v241
  v_mov_b32 v253, s75
  v_mov_b32 v254, 0x7ffffff0
  v_cndmask_b32 v253, v254, v253, vcc
  v_mov_b32 v254, 1
  s_waitcnt vmcnt(0)
  buffer_store_dword v254, v253, s[56:59], 0 offen
  buffer_load_dword v255, v252, s[56:59], 0 offen sc1
  s_mov_b32 s89, 0
L_poll_bf:
  s_waitcnt vmcnt(0)
  v_cmp_eq_u32 vcc, 1, v255
  s_add_u32 s89, s89, 1
  s_nop 1
  s_cmp_eq_u64 vcc, -1
  s_cbranch_scc1 L_got_bf
  s_cmp_gt_u32 s89, 200000
  s_cbranch_scc1 L_got_bf
  buffer_load_dword v255, v252, s[56:59], 0 offen sc1
  s_waitcnt vmcnt(0)
  s_branch L_poll_bf
L_got_bf:
  s_mul_i32 s78, s68, 3072
  s_mul_i32 s75, s70, 49152
  s_add_u32 s84, s75, s78
  s_add_u32 s84, s84, 12288
  buffer_load_dwordx4 a[60:63], v241, s[52:55], s84 offen sc1
  buffer_load_dwordx4 a[64:67], v241, s[52:55], s84 offen offset:1024 sc1
  buffer_load_dwordx4 a[68:71], v241, s[52:55], s84 offen offset:2048 sc1
  s_add_u32 s84, s84, 12288
  buffer_load_dwordx4 a[72:75], v241, s[52:55], s84 offen sc1
  buffer_load_dwordx4 a[76:79], v241, s[52:55], s84 offen offset:1024 sc1
  buffer_load_dwordx4 a[80:83], v241, s[52:55], s84 offen offset:2048 sc1
  s_add_u32 s84, s84, 12288
  buffer_load_dwordx4 a[84:87], v241, s[52:55], s84 offen sc1
  buffer_load_dwordx4 a[88:91], v241, s[52:55], s84 offen offset:1024 sc1
  buffer_load_dwordx4 a[92:95], v241, s[52:55], s84 offen offset:2048 sc1
  s_mul_i32 s75, s69, 196608
  s_lshl_b32 s76, s71, 10
  s_add_u32 s75, s75, s76
  s_lshl_b32 s76, s70, 7
  s_add_u32 s75, s75, s76
  s_waitcnt lgkmcnt(2)
  v_mfma_f32_16x16x32_bf16 v[0:3], v[192:195], a[48:51], v[0:3]
  v_mfma_f32_16x16x32_bf16 v[4:7], v[196:199], a[48:51], v[4:7]
  s_waitcnt lgkmcnt(1)
  v_mfma_f32_16x16x32_bf16 v[8:11], v[192:195], a[52:55], v[8:11]
  v_mfma_f32_16x16x32_bf16 v[12:15], v[196:199], a[52:55], v[12:15]
  s_waitcnt lgkmcnt(0)
  v_mfma_f32_16x16x32_bf16 v[16:19], v[192:195], a[56:59], v[16:19]
  v_mfma_f32_16x16x32_bf16 v[20:23], v[196:199], a[56:59], v[20:23]
  s_waitcnt vmcnt(8)
  v_mfma_f32_16x16x32_bf16 v[0:3], v[192:195], a[60:63], v[0:3]
  v_mfma_f32_16x16x32_bf16 v[4:7], v[196:199], a[60:63], v[4:7]
  s_waitcnt vmcnt(7)
  v_mfma_f32_16x16x32_bf16 v[8:11], v[192:195], a[64:67], v[8:11]
  v_mfma_f32_16x16x32_bf16 v[12:15], v[196:199], a[64:67], v[12:15]
  s_waitcnt vmcnt(6)
  v_mfma_f32_16x16x32_bf16 v[16:19], v[192:195], a[68:71], v[16:19]
  v_mfma_f32_16x16x32_bf16 v[20:23], v[196:199], a[68:71], v[20:23]
  s_waitcnt vmcnt(5)
  v_mfma_f32_16x16x32_bf16 v[0:3], v[192:195], a[72:75], v[0:3]
  v_mfma_f32_16x16x32_bf16 v[4:7], v[196:199], a[72:75], v[4:7]
  s_waitcnt vmcnt(4)
  v_mfma_f32_16x16x32_bf16 v[8:11], v[192:195], a[76:79], v[8:11]
  v_mfma_f32_16x16x32_bf16 v[12:15], v[196:199], a[76:79], v[12:15]
  s_waitcnt vmcnt(3)
  v_mfma_f32_16x16x32_bf16 v[16:19], v[192:195], a[80:83], v[16:19]
  v_mfma_f32_16x16x32_bf16 v[20:23], v[196:199], a[80:83], v[20:23]
  s_waitcnt vmcnt(2)
  v_mfma_f32_16x16x32_bf16 v[0:3], v[192:195], a[84:87], v[0:3]
  v_mfma_f32_16x16x32_bf16 v[4:7], v[196:199], a[84:87], v[4:7]
  s_waitcnt vmcnt(1)
  v_mfma_f32_16x16x32_bf16 v[8:11], v[192:195], a[88:91], v[8:11]
  v_mfma_f32_16x16x32_bf16 v[12:15], v[196:199], a[88:91], v[12:15]
  s_waitcnt vmcnt(0)
  v_mfma_f32_16x16x32_bf16 v[16:19], v[192:195], a[92:95], v[16:19]
  v_mfma_f32_16x16x32_bf16 v[20:23], v[196:199], a[92:95], v[20:23]
  s_mul_i32 s76, s68, 3
  s_add_u32 s76, s76, 0
  s_lshr_b32 s77, s76, 1
  s_lshl_b32 s77, s77, 15
  s_and_b32 s76, s76, 1
  s_lshl_b32 s76, s76, 6
  s_add_u32 s77, s77, s76
  s_add_u32 s77, s77, s75
  v_cvt_pk_bf16_f32 v0, v0, v1
  v_cvt_pk_bf16_f32 v1, v2, v3
  v_cvt_pk_bf16_f32 v2, v4, v5
  v_cvt_pk_bf16_f32 v3, v6, v7
  buffer_store_dwordx4 v[0:3], v206, s[64:67], s77 offen
  s_mul_i32 s76, s68, 3
  s_add_u32 s76, s76, 1
  s_lshr_b32 s77, s76, 1
  s_lshl_b32 s77, s77, 15
  s_and_b32 s76, s76, 1
  s_lshl_b32 s76, s76, 6
  s_add_u32 s77, s77, s76
  s_add_u32 s77, s77, s75
  v_cvt_pk_bf16_f32 v8, v8, v9
  v_cvt_pk_bf16_f32 v9, v10, v11
  v_cvt_pk_bf16_f32 v10, v12, v13
  v_cvt_pk_bf16_f32 v11, v14, v15
  buffer_store_dwordx4 v[8:11], v206, s[64:67], s77 offen
  s_mul_i32 s76, s68, 3
  s_add_u32 s76, s76, 2
  s_lshr_b32 s77, s76, 1
  s_lshl_b32 s77, s77, 15
  s_and_b32 s76, s76, 1
  s_lshl_b32 s76, s76, 6
  s_add_u32 s77, s77, s76
  s_add_u32 s77, s77, s75
  v_cvt_pk_bf16_f32 v16, v16, v17
  v_cvt_pk_bf16_f32 v17, v18, v19
  v_cvt_pk_bf16_f32 v18, v20, v21
  v_cvt_pk_bf16_f32 v19, v22, v23
  buffer_store_dwordx4 v[16:19], v206, s[64:67], s77 offen
  s_endpgm
L_slow:
L_tail_s:
  s_waitcnt lgkmcnt(6)
  v_mfma_f32_16x16x32_bf16 v[96:99], a[176:179], a[208:211], 0
  s_mul_i32 s83, s21, 6144
  s_add_u32 s20, s20, 4
  s_lshl_b32 s76, s31, 2
  s_waitcnt lgkmcnt(4)
  v_mfma_f32_16x16x32_bf16 v[100:103], a[180:183], a[208:211], 0
  v_add_u32 v240, s83, v222
  s_and_b32 s20, s20, 15
  s_add_u32 s76, s76, 3
  s_waitcnt lgkmcnt(2)
  v_mfma_f32_16x16x32_bf16 v[104:107], a[184:187], a[208:211], 0
  ds_read_b128 a[232:235], v240
  s_waitcnt lgkmcnt(1)
  v_mfma_f32_16x16x32_bf16 v[108:111], a[188:191], a[208:211], 0
  ds_read_b128 a[236:239], v240 offset:256
  s_sub_u32 s76, s76, s68
  v_mfma_f32_16x16x32_bf16 v[112:115], a[176:179], a[212:215], 0
  ds_read_b128 a[240:243], v240 offset:1024
  v_mfma_f32_16x16x32_bf16 v[116:119], a[180:183], a[212:215], 0
  ds_read_b128 a[244:247], v240 offset:1280
  s_mul_i32 s76, s76, 12288
  v_mfma_f32_16x16x32_bf16 v[120:123], a[184:187], a[212:215], 0
  ds_read_b128 a[248:251], v240 offset:2048
  v_mfma_f32_16x16x32_bf16 v[124:127], a[188:191], a[212:215], 0
  ds_read_b128 a[252:255], v240 offset:2304
  v_cvt_pk_bf16_f32 v0, v0, v1
  v_mfma_f32_16x16x32_bf16 v[128:131], a[176:179], a[216:219], 0
  s_lshl_b32 s82, s20, 15
  s_add_u32 s82, s82, s25
  v_mfma_f32_16x16x32_bf16 v[132:135], a[180:183], a[216:219], 0
  s_add_u32 m0, s74, 0
  v_cvt_pk_bf16_f32 v1, v2, v3
  v_mfma_f32_16x16x32_bf16 v[136:139], a[184:187], a[216:219], 0
  s_waitcnt vmcnt(8)
  ds_read_b64_tr_b16 a[192:193], v236 offset:4096
  v_mfma_f32_16x16x32_bf16 v[140:143], a[188:191], a[216:219], 0
  ds_read_b64_tr_b16 a[194:195], v236 offset:5120
  v_cvt_pk_bf16_f32 v2, v4, v5
  v_mfma_f32_16x16x32_bf16 v[144:147], a[176:179], a[220:223], 0
  buffer_load_dwordx4 v232, s[48:51], s82 offen lds
  v_mfma_f32_16x16x32_bf16 v[148:151], a[180:183], a[220:223], 0
  ds_read_b64_tr_b16 a[196:197], v237 offset:4096
  v_cvt_pk_bf16_f32 v3, v6, v7
  v_mfma_f32_16x16x32_bf16 v[152:155], a[184:187], a[220:223], 0
  ds_read_b64_tr_b16 a[198:199], v237 offset:5120
  v_mfma_f32_16x16x32_bf16 v[156:159], a[188:191], a[220:223], 0
  buffer_load_dwordx4 v233, s[48:51], s82 offen offset:1024 lds
  v_mfma_f32_16x16x32_bf16 v[160:163], a[176:179], a[224:227], 0
  ds_read_b64_tr_b16 a[200:201], v238 offset:4096
  v_mfma_f32_16x16x32_bf16 v[164:167], a[180:183], a[224:227], 0
  ds_read_b64_tr_b16 a[202:203], v238 offset:5120
  v_mfma_f32_16x16x32_bf16 v[168:171], a[184:187], a[224:227], 0
  buffer_load_dwordx4 v234, s[48:51], s82 offen offset:2048 lds
  v_mfma_f32_16x16x32_bf16 v[172:175], a[188:191], a[224:227], 0
  ds_read_b64_tr_b16 a[204:205], v239 offset:4096
  v_mfma_f32_16x16x32_bf16 v[176:179], a[176:179], a[228:231], 0
  ds_read_b64_tr_b16 a[206:207], v239 offset:5120
  v_mfma_f32_16x16x32_bf16 v[180:183], a[180:183], a[228:231], 0
  buffer_load_dwordx4 v235, s[48:51], s82 offen offset:3072 lds
  v_mfma_f32_16x16x32_bf16 v[184:187], a[184:187], a[228:231], 0
  buffer_store_dwordx4 v[0:3], v241, s[52:55], s76 offen sc0 sc1
  v_mfma_f32_16x16x32_bf16 v[188:191], a[188:191], a[228:231], 0
  v_cvt_pk_bf16_f32 v8, v8, v9
  v_cvt_pk_bf16_f32 v9, v10, v11
  v_cvt_pk_bf16_f32 v10, v12, v13
  v_cvt_pk_bf16_f32 v11, v14, v15
  s_waitcnt lgkmcnt(6)
  v_mfma_f32_16x16x32_bf16 v[96:99], a[192:195], a[232:235], v[96:99]
  s_mul_i32 s83, s22, 6144
  s_add_u32 s21, s21, 4
  s_waitcnt lgkmcnt(4)
  v_mfma_f32_16x16x32_bf16 v[100:103], a[196:199], a[232:235], v[100:103]
  v_add_u32 v240, s83, v222
  s_and_b32 s21, s21, 15
  s_waitcnt lgkmcnt(2)
  v_mfma_f32_16x16x32_bf16 v[104:107], a[200:203], a[232:235], v[104:107]
  ds_read_b128 a[208:211], v240
  s_waitcnt lgkmcnt(1)
  v_mfma_f32_16x16x32_bf16 v[108:111], a[204:207], a[232:235], v[108:111]
  ds_read_b128 a[212:215], v240 offset:256
  v_mfma_f32_16x16x32_bf16 v[112:115], a[192:195], a[236:239], v[112:115]
  ds_read_b128 a[216:219], v240 offset:1024
  v_mfma_f32_16x16x32_bf16 v[116:119], a[196:199], a[236:239], v[116:119]
  ds_read_b128 a[220:223], v240 offset:1280
  v_mfma_f32_16x16x32_bf16 v[120:123], a[200:203], a[236:239], v[120:123]
  ds_read_b128 a[224:227], v240 offset:2048
  v_mfma_f32_16x16x32_bf16 v[124:127], a[204:207], a[236:239], v[124:127]
  ds_read_b128 a[228:231], v240 offset:2304
  v_mfma_f32_16x16x32_bf16 v[128:131], a[192:195], a[240:243], v[128:131]
  s_lshl_b32 s82, s21, 15
  s_add_u32 s82, s82, s25
  v_mfma_f32_16x16x32_bf16 v[132:135], a[196:199], a[240:243], v[132:135]
  s_add_u32 m0, s74, 4096
  buffer_store_dwordx4 v[8:11], v241, s[52:55], s76 offen offset:1024 sc0 sc1
  v_mfma_f32_16x16x32_bf16 v[136:139], a[200:203], a[240:243], v[136:139]
  s_waitcnt vmcnt(10)
  ds_read_b64_tr_b16 a[176:177], v236 offset:8192
  v_cvt_pk_bf16_f32 v16, v16, v17
  v_cvt_pk_bf16_f32 v17, v18, v19
  v_mfma_f32_16x16x32_bf16 v[140:143], a[204:207], a[240:243], v[140:143]
  ds_read_b64_tr_b16 a[178:179], v236 offset:9216
  v_cvt_pk_bf16_f32 v18, v20, v21
  v_cvt_pk_bf16_f32 v19, v22, v23
  v_mfma_f32_16x16x32_bf16 v[144:147], a[192:195], a[244:247], v[144:147]
  buffer_load_dwordx4 v232, s[48:51], s82 offen lds
  v_mfma_f32_16x16x32_bf16 v[148:151], a[196:199], a[244:247], v[148:151]
  ds_read_b64_tr_b16 a[180:181], v237 offset:8192
  v_mfma_f32_16x16x32_bf16 v[152:155], a[200:203], a[244:247], v[152:155]
  ds_read_b64_tr_b16 a[182:183], v237 offset:9216
  v_mfma_f32_16x16x32_bf16 v[156:159], a[204:207], a[244:247], v[156:159]
  buffer_load_dwordx4 v233, s[48:51], s82 offen offset:1024 lds
  v_mfma_f32_16x16x32_bf16 v[160:163], a[192:195], a[248:251], v[160:163]
  ds_read_b64_tr_b16 a[184:185], v238 offset:8192
  v_mfma_f32_16x16x32_bf16 v[164:167], a[196:199], a[248:251], v[164:167]
  ds_read_b64_tr_b16 a[186:187], v238 offset:9216
  v_mfma_f32_16x16x32_bf16 v[168:171], a[200:203], a[248:251], v[168:171]
  buffer_load_dwordx4 v234, s[48:51], s82 offen offset:2048 lds
  v_mfma_f32_16x16x32_bf16 v[172:175], a[204:207], a[248:251], v[172:175]
  ds_read_b64_tr_b16 a[188:189], v239 offset:8192
  v_mfma_f32_16x16x32_bf16 v[176:179], a[192:195], a[252:255], v[176:179]
  ds_read_b64_tr_b16 a[190:191], v239 offset:9216
  v_mfma_f32_16x16x32_bf16 v[180:183], a[196:199], a[252:255], v[180:183]
  buffer_load_dwordx4 v235, s[48:51], s82 offen offset:3072 lds
  v_mfma_f32_16x16x32_bf16 v[184:187], a[200:203], a[252:255], v[184:187]
  buffer_store_dwordx4 v[16:19], v241, s[52:55], s76 offen offset:2048 sc0 sc1
  v_mfma_f32_16x16x32_bf16 v[188:191], a[204:207], a[252:255], v[188:191]
  v_cvt_pk_bf16_f32 v24, v24, v25
  v_cvt_pk_bf16_f32 v25, v26, v27
  v_cvt_pk_bf16_f32 v26, v28, v29
  v_cvt_pk_bf16_f32 v27, v30, v31
  buffer_store_dwordx4 v[24:27], v241, s[52:55], s76 offen offset:3072 sc0 sc1
  v_cvt_pk_bf16_f32 v32, v32, v33
  v_cvt_pk_bf16_f32 v33, v34, v35
  s_waitcnt lgkmcnt(6)
  v_mfma_f32_16x16x32_bf16 v[96:99], a[176:179], a[208:211], v[96:99]
  s_mul_i32 s83, s23, 6144
  s_add_u32 s22, s22, 4
  v_cvt_pk_bf16_f32 v34, v36, v37
  s_waitcnt lgkmcnt(4)
  v_mfma_f32_16x16x32_bf16 v[100:103], a[180:183], a[208:211], v[100:103]
  v_add_u32 v240, s83, v222
  s_and_b32 s22, s22, 15
  v_cvt_pk_bf16_f32 v35, v38, v39
  s_waitcnt lgkmcnt(2)
  v_mfma_f32_16x16x32_bf16 v[104:107], a[184:187], a[208:211], v[104:107]
  ds_read_b128 a[232:235], v240
  s_waitcnt lgkmcnt(1)
  v_mfma_f32_16x16x32_bf16 v[108:111], a[188:191], a[208:211], v[108:111]
  ds_read_b128 a[236:239], v240 offset:256
  s_add_u32 s76, s76, 4096
  v_mfma_f32_16x16x32_bf16 v[112:115], a[176:179], a[212:215], v[112:115]
  ds_read_b128 a[240:243], v240 offset:1024
  v_mfma_f32_16x16x32_bf16 v[116:119], a[180:183], a[212:215], v[116:119]
  ds_read_b128 a[244:247], v240 offset:1280
  v_mfma_f32_16x16x32_bf16 v[120:123], a[184:187], a[212:215], v[120:123]
  ds_read_b128 a[248:251], v240 offset:2048
  v_mfma_f32_16x16x32_bf16 v[124:127], a[188:191], a[212:215], v[124:127]
  ds_read_b128 a[252:255], v240 offset:2304
  v_mfma_f32_16x16x32_bf16 v[128:131], a[176:179], a[216:219], v[128:131]
  s_lshl_b32 s82, s22, 15
  s_add_u32 s82, s82, s25
  v_mfma_f32_16x16x32_bf16 v[132:135], a[180:183], a[216:219], v[132:135]
  s_add_u32 m0, s74, 8192
  buffer_store_dwordx4 v[32:35], v241, s[52:55], s76 offen sc0 sc1
  v_mfma_f32_16x16x32_bf16 v[136:139], a[184:187], a[216:219], v[136:139]
  s_waitcnt vmcnt(13)
  ds_read_b64_tr_b16 a[192:193], v236 offset:12288
  v_cvt_pk_bf16_f32 v40, v40, v41
  v_cvt_pk_bf16_f32 v41, v42, v43
  v_mfma_f32_16x16x32_bf16 v[140:143], a[188:191], a[216:219], v[140:143]
  ds_read_b64_tr_b16 a[194:195], v236 offset:13312
  v_cvt_pk_bf16_f32 v42, v44, v45
  v_mfma_f32_16x16x32_bf16 v[144:147], a[176:179], a[220:223], v[144:147]
  buffer_load_dwordx4 v232, s[48:51], s82 offen lds
  v_mfma_f32_16x16x32_bf16 v[148:151], a[180:183], a[220:223], v[148:151]
  ds_read_b64_tr_b16 a[196:197], v237 offset:12288
  v_cvt_pk_bf16_f32 v43, v46, v47
  v_mfma_f32_16x16x32_bf16 v[152:155], a[184:187], a[220:223], v[152:155]
  ds_read_b64_tr_b16 a[198:199], v237 offset:13312
  v_mfma_f32_16x16x32_bf16 v[156:159], a[188:191], a[220:223], v[156:159]
  buffer_load_dwordx4 v233, s[48:51], s82 offen offset:1024 lds
  v_mfma_f32_16x16x32_bf16 v[160:163], a[176:179], a[224:227], v[160:163]
  ds_read_b64_tr_b16 a[200:201], v238 offset:12288
  v_mfma_f32_16x16x32_bf16 v[164:167], a[180:183], a[224:227], v[164:167]
  ds_read_b64_tr_b16 a[202:203], v238 offset:13312
  v_mfma_f32_16x16x32_bf16 v[168:171], a[184:187], a[224:227], v[168:171]
  buffer_load_dwordx4 v234, s[48:51], s82 offen offset:2048 lds
  v_mfma_f32_16x16x32_bf16 v[172:175], a[188:191], a[224:227], v[172:175]
  ds_read_b64_tr_b16 a[204:205], v239 offset:12288
  v_mfma_f32_16x16x32_bf16 v[176:179], a[176:179], a[228:231], v[176:179]
  ds_read_b64_tr_b16 a[206:207], v239 offset:13312
  v_mfma_f32_16x16x32_bf16 v[180:183], a[180:183], a[228:231], v[180:183]
  buffer_load_dwordx4 v235, s[48:51], s82 offen offset:3072 lds
  v_mfma_f32_16x16x32_bf16 v[184:187], a[184:187], a[228:231], v[184:187]
  buffer_store_dwordx4 v[40:43], v241, s[52:55], s76 offen offset:1024 sc0 sc1
  v_mfma_f32_16x16x32_bf16 v[188:191], a[188:191], a[228:231], v[188:191]
  v_cvt_pk_bf16_f32 v48, v48, v49
  v_cvt_pk_bf16_f32 v49, v50, v51
  v_cvt_pk_bf16_f32 v50, v52, v53
  v_cvt_pk_bf16_f32 v51, v54, v55
  s_waitcnt lgkmcnt(6)
  v_mfma_f32_16x16x32_bf16 v[96:99], a[192:195], a[232:235], v[96:99]
  s_mul_i32 s83, s20, 6144
  s_add_u32 s23, s23, 4
  s_waitcnt lgkmcnt(4)
  v_mfma_f32_16x16x32_bf16 v[100:103], a[196:199], a[232:235], v[100:103]
  v_add_u32 v240, s83, v222
  s_and_b32 s23, s23, 15
  s_waitcnt lgkmcnt(2)
  v_mfma_f32_16x16x32_bf16 v[104:107], a[200:203], a[232:235], v[104:107]
  ds_read_b128 a[208:211], v240
  s_waitcnt lgkmcnt(1)
  v_mfma_f32_16x16x32_bf16 v[108:111], a[204:207], a[232:235], v[108:111]
  ds_read_b128 a[212:215], v240 offset:256
  v_mfma_f32_16x16x32_bf16 v[112:115], a[192:195], a[236:239], v[112:115]
  ds_read_b128 a[216:219], v240 offset:1024
  v_mfma_f32_16x16x32_bf16 v[116:119], a[196:199], a[236:239], v[116:119]
  ds_read_b128 a[220:223], v240 offset:1280
  v_mfma_f32_16x16x32_bf16 v[120:123], a[200:203], a[236:239], v[120:123]
  ds_read_b128 a[224:227], v240 offset:2048
  v_mfma_f32_16x16x32_bf16 v[124:127], a[204:207], a[236:239], v[124:127]
  ds_read_b128 a[228:231], v240 offset:2304
  v_mfma_f32_16x16x32_bf16 v[128:131], a[192:195], a[240:243], v[128:131]
  s_lshl_b32 s82, s23, 15
  s_add_u32 s82, s82, s25
  v_mfma_f32_16x16x32_bf16 v[132:135], a[196:199], a[240:243], v[132:135]
  s_add_u32 m0, s74, 12288
  buffer_store_dwordx4 v[48:51], v241, s[52:55], s76 offen offset:2048 sc0 sc1
  v_mfma_f32_16x16x32_bf16 v[136:139], a[200:203], a[240:243], v[136:139]
  s_waitcnt vmcnt(15)
  ds_read_b64_tr_b16 a[176:177], v236
  v_cvt_pk_bf16_f32 v56, v56, v57
  v_cvt_pk_bf16_f32 v57, v58, v59
  v_mfma_f32_16x16x32_bf16 v[140:143], a[204:207], a[240:243], v[140:143]
  ds_read_b64_tr_b16 a[178:179], v236 offset:1024
  v_cvt_pk_bf16_f32 v58, v60, v61
  v_cvt_pk_bf16_f32 v59, v62, v63
  v_mfma_f32_16x16x32_bf16 v[144:147], a[192:195], a[244:247], v[144:147]
  buffer_load_dwordx4 v232, s[48:51], s82 offen lds
  v_mfma_f32_16x16x32_bf16 v[148:151], a[196:199], a[244:247], v[148:151]
  ds_read_b64_tr_b16 a[180:181], v237
  v_mfma_f32_16x16x32_bf16 v[152:155], a[200:203], a[244:247], v[152:155]
  ds_read_b64_tr_b16 a[182:183], v237 offset:1024
  v_mfma_f32_16x16x32_bf16 v[156:159], a[204:207], a[244:247], v[156:159]
  buffer_load_dwordx4 v233, s[48:51], s82 offen offset:1024 lds
  v_mfma_f32_16x16x32_bf16 v[160:163], a[192:195], a[248:251], v[160:163]
  ds_read_b64_tr_b16 a[184:185], v238
  v_mfma_f32_16x16x32_bf16 v[164:167], a[196:199], a[248:251], v[164:167]
  ds_read_b64_tr_b16 a[186:187], v238 offset:1024
  v_mfma_f32_16x16x32_bf16 v[168:171], a[200:203], a[248:251], v[168:171]
  buffer_load_dwordx4 v234, s[48:51], s82 offen offset:2048 lds
  v_mfma_f32_16x16x32_bf16 v[172:175], a[204:207], a[248:251], v[172:175]
  ds_read_b64_tr_b16 a[188:189], v239
  v_mfma_f32_16x16x32_bf16 v[176:179], a[192:195], a[252:255], v[176:179]
  ds_read_b64_tr_b16 a[190:191], v239 offset:1024
  v_mfma_f32_16x16x32_bf16 v[180:183], a[196:199], a[252:255], v[180:183]
  buffer_load_dwordx4 v235, s[48:51], s82 offen offset:3072 lds
  v_mfma_f32_16x16x32_bf16 v[184:187], a[200:203], a[252:255], v[184:187]
  buffer_store_dwordx4 v[56:59], v241, s[52:55], s76 offen offset:3072 sc0 sc1
  v_mfma_f32_16x16x32_bf16 v[188:191], a[204:207], a[252:255], v[188:191]
  v_cvt_pk_bf16_f32 v64, v64, v65
  v_cvt_pk_bf16_f32 v65, v66, v67
  v_cvt_pk_bf16_f32 v66, v68, v69
  v_cvt_pk_bf16_f32 v67, v70, v71
  s_add_u32 s76, s76, 4096
  buffer_store_dwordx4 v[64:67], v241, s[52:55], s76 offen sc0 sc1
  v_cvt_pk_bf16_f32 v72, v72, v73
  s_waitcnt lgkmcnt(6)
  v_mfma_f32_16x16x32_bf16 v[96:99], a[176:179], a[208:211], v[96:99]
  s_mul_i32 s83, s21, 6144
  s_add_u32 s20, s20, 4
  v_cvt_pk_bf16_f32 v73, v74, v75
  s_waitcnt lgkmcnt(4)
  v_mfma_f32_16x16x32_bf16 v[100:103], a[180:183], a[208:211], v[100:103]
  v_add_u32 v240, s83, v222
  s_and_b32 s20, s20, 15
  v_cvt_pk_bf16_f32 v74, v76, v77
  s_waitcnt lgkmcnt(2)
  v_mfma_f32_16x16x32_bf16 v[104:107], a[184:187], a[208:211], v[104:107]
  ds_read_b128 a[232:235], v240
  s_waitcnt lgkmcnt(1)
  v_mfma_f32_16x16x32_bf16 v[108:111], a[188:191], a[208:211], v[108:111]
  ds_read_b128 a[236:239], v240 offset:256
  v_cvt_pk_bf16_f32 v75, v78, v79
  v_mfma_f32_16x16x32_bf16 v[112:115], a[176:179], a[212:215], v[112:115]
  ds_read_b128 a[240:243], v240 offset:1024
  v_mfma_f32_16x16x32_bf16 v[116:119], a[180:183], a[212:215], v[116:119]
  ds_read_b128 a[244:247], v240 offset:1280
  v_mfma_f32_16x16x32_bf16 v[120:123], a[184:187], a[212:215], v[120:123]
  ds_read_b128 a[248:251], v240 offset:2048
  v_mfma_f32_16x16x32_bf16 v[124:127], a[188:191], a[212:215], v[124:127]
  ds_read_b128 a[252:255], v240 offset:2304
  v_mfma_f32_16x16x32_bf16 v[128:131], a[176:179], a[216:219], v[128:131]
  s_lshl_b32 s82, s20, 15
  s_add_u32 s82, s82, s25
  v_mfma_f32_16x16x32_bf16 v[132:135], a[180:183], a[216:219], v[132:135]
  s_add_u32 m0, s74, 0
  buffer_store_dwordx4 v[72:75], v241, s[52:55], s76 offen offset:1024 sc0 sc1
  v_mfma_f32_16x16x32_bf16 v[136:139], a[184:187], a[216:219], v[136:139]
  s_waitcnt vmcnt(16)
  ds_read_b64_tr_b16 a[192:193], v236 offset:4096
  v_cvt_pk_bf16_f32 v80, v80, v81
  v_cvt_pk_bf16_f32 v81, v82, v83
  v_mfma_f32_16x16x32_bf16 v[140:143], a[188:191], a[216:219], v[140:143]
  ds_read_b64_tr_b16 a[194:195], v236 offset:5120
  v_cvt_pk_bf16_f32 v82, v84, v85
  v_mfma_f32_16x16x32_bf16 v[144:147], a[176:179], a[220:223], v[144:147]
  buffer_load_dwordx4 v232, s[48:51], s82 offen lds
  v_mfma_f32_16x16x32_bf16 v[148:151], a[180:183], a[220:223], v[148:151]
  ds_read_b64_tr_b16 a[196:197], v237 offset:4096
  v_cvt_pk_bf16_f32 v83, v86, v87
  v_mfma_f32_16x16x32_bf16 v[152:155], a[184:187], a[220:223], v[152:155]
  ds_read_b64_tr_b16 a[198:199], v237 offset:5120
  v_mfma_f32_16x16x32_bf16 v[156:159], a[188:191], a[220:223], v[156:159]
  buffer_load_dwordx4 v233, s[48:51], s82 offen offset:1024 lds
  v_mfma_f32_16x16x32_bf16 v[160:163], a[176:179], a[224:227], v[160:163]
  ds_read_b64_tr_b16 a[200:201], v238 offset:4096
  v_mfma_f32_16x16x32_bf16 v[164:167], a[180:183], a[224:227], v[164:167]
  ds_read_b64_tr_b16 a[202:203], v238 offset:5120
  v_mfma_f32_16x16x32_bf16 v[168:171], a[184:187], a[224:227], v[168:171]
  buffer_load_dwordx4 v234, s[48:51], s82 offen offset:2048 lds
  v_mfma_f32_16x16x32_bf16 v[172:175], a[188:191], a[224:227], v[172:175]
  ds_read_b64_tr_b16 a[204:205], v239 offset:4096
  v_mfma_f32_16x16x32_bf16 v[176:179], a[176:179], a[228:231], v[176:179]
  ds_read_b64_tr_b16 a[206:207], v239 offset:5120
  v_mfma_f32_16x16x32_bf16 v[180:183], a[180:183], a[228:231], v[180:183]
  buffer_load_dwordx4 v235, s[48:51], s82 offen offset:3072 lds
  v_mfma_f32_16x16x32_bf16 v[184:187], a[184:187], a[228:231], v[184:187]
  buffer_store_dwordx4 v[80:83], v241, s[52:55], s76 offen offset:2048 sc0 sc1
  v_mfma_f32_16x16x32_bf16 v[188:191], a[188:191], a[228:231], v[188:191]
  v_cvt_pk_bf16_f32 v88, v88, v89
  v_cvt_pk_bf16_f32 v89, v90, v91
  v_cvt_pk_bf16_f32 v90, v92, v93
  v_cvt_pk_bf16_f32 v91, v94, v95
  buffer_store_dwordx4 v[88:91], v241, s[52:55], s76 offen offset:3072 sc0 sc1
  s_waitcnt lgkmcnt(6)
  v_mfma_f32_16x16x32_bf16 v[96:99], a[192:195], a[232:235], v[96:99]
  s_mul_i32 s83, s22, 6144
  s_add_u32 s21, s21, 4
  v_lshrrev_b32 v200, 4, v241
  s_waitcnt lgkmcnt(4)
  v_mfma_f32_16x16x32_bf16 v[100:103], a[196:199], a[232:235], v[100:103]
  v_add_u32 v240, s83, v222
  s_and_b32 s21, s21, 15
  v_and_b32 v201, 3, v200
  s_waitcnt lgkmcnt(2)
  v_mfma_f32_16x16x32_bf16 v[104:107], a[200:203], a[232:235], v[104:107]
  ds_read_b128 a[208:211], v240
  v_bfe_u32 v202, v200, 3, 1
  s_waitcnt lgkmcnt(1)
  v_mfma_f32_16x16x32_bf16 v[108:111], a[204:207], a[232:235], v[108:111]
  ds_read_b128 a[212:215], v240 offset:256
  v_lshlrev_b32 v202, 2, v202
  v_mfma_f32_16x16x32_bf16 v[112:115], a[192:195], a[236:239], v[112:115]
  ds_read_b128 a[216:219], v240 offset:1024
  v_add_u32 v201, v201, v202
  v_mfma_f32_16x16x32_bf16 v[116:119], a[196:199], a[236:239], v[116:119]
  ds_read_b128 a[220:223], v240 offset:1280
  v_mfma_f32_16x16x32_bf16 v[120:123], a[200:203], a[236:239], v[120:123]
  ds_read_b128 a[224:227], v240 offset:2048
  v_bfe_u32 v202, v200, 2, 1
  v_mfma_f32_16x16x32_bf16 v[124:127], a[204:207], a[236:239], v[124:127]
  ds_read_b128 a[228:231], v240 offset:2304
  v_lshlrev_b32 v202, 1, v202
  v_mfma_f32_16x16x32_bf16 v[128:131], a[192:195], a[240:243], v[128:131]
  s_lshl_b32 s82, s21, 15
  s_add_u32 s82, s82, s25
  v_lshrrev_b32 v203, 4, v200
  v_mfma_f32_16x16x32_bf16 v[132:135], a[196:199], a[240:243], v[132:135]
  s_add_u32 m0, s74, 4096
  v_sub_u32 v202, v203, v202
  v_mfma_f32_16x16x32_bf16 v[136:139], a[200:203], a[240:243], v[136:139]
  s_waitcnt vmcnt(15)
  ds_read_b64_tr_b16 a[176:177], v236 offset:8192
  v_lshlrev_b32 v202, 3, v202
  v_mfma_f32_16x16x32_bf16 v[140:143], a[204:207], a[240:243], v[140:143]
  ds_read_b64_tr_b16 a[178:179], v236 offset:9216
  v_mfma_f32_16x16x32_bf16 v[144:147], a[192:195], a[244:247], v[144:147]
  buffer_load_dwordx4 v232, s[48:51], s82 offen lds
  v_add_u32 v201, v201, v202
  v_mfma_f32_16x16x32_bf16 v[148:151], a[196:199], a[244:247], v[148:151]
  ds_read_b64_tr_b16 a[180:181], v237 offset:8192
  v_mov_b32 v203, 0
  v_mfma_f32_16x16x32_bf16 v[152:155], a[200:203], a[244:247], v[152:155]
  ds_read_b64_tr_b16 a[182:183], v237 offset:9216
  v_mov_b32 v204, 0x3f80
  v_mfma_f32_16x16x32_bf16 v[156:159], a[204:207], a[244:247], v[156:159]
  buffer_load_dwordx4 v233, s[48:51], s82 offen offset:1024 lds
  v_mfma_f32_16x16x32_bf16 v[160:163], a[192:195], a[248:251], v[160:163]
  ds_read_b64_tr_b16 a[184:185], v238 offset:8192
  v_mov_b32 v205, 0x3f800000
  v_cmp_eq_u32 vcc, 0, v201
  v_mfma_f32_16x16x32_bf16 v[164:167], a[196:199], a[248:251], v[164:167]
  ds_read_b64_tr_b16 a[186:187], v238 offset:9216
  v_mfma_f32_16x16x32_bf16 v[168:171], a[200:203], a[248:251], v[168:171]
  buffer_load_dwordx4 v234, s[48:51], s82 offen offset:2048 lds
  v_cndmask_b32 v192, v203, v204, vcc
  v_mfma_f32_16x16x32_bf16 v[172:175], a[204:207], a[248:251], v[172:175]
  ds_read_b64_tr_b16 a[188:189], v239 offset:8192
  v_cmp_eq_u32 vcc, 1, v201
  v_mfma_f32_16x16x32_bf16 v[176:179], a[192:195], a[252:255], v[176:179]
  ds_read_b64_tr_b16 a[190:191], v239 offset:9216
  v_cndmask_b32 v192, v192, v205, vcc
  v_mfma_f32_16x16x32_bf16 v[180:183], a[196:199], a[252:255], v[180:183]
  buffer_load_dwordx4 v235, s[48:51], s82 offen offset:3072 lds
  v_cmp_eq_u32 vcc, 2, v201
  v_mfma_f32_16x16x32_bf16 v[184:187], a[200:203], a[252:255], v[184:187]
  s_nop 0
  v_cndmask_b32 v193, v203, v204, vcc
  v_mfma_f32_16x16x32_bf16 v[188:191], a[204:207], a[252:255], v[188:191]
  s_waitcnt lgkmcnt(6)
  v_mfma_f32_16x16x32_bf16 v[96:99], a[176:179], a[208:211], v[96:99]
  s_mul_i32 s83, s23, 6144
  s_add_u32 s22, s22, 4
  s_lshl_b32 s75, s31, 7
  s_waitcnt lgkmcnt(4)
  v_mfma_f32_16x16x32_bf16 v[100:103], a[180:183], a[208:211], v[100:103]
  v_add_u32 v240, s83, v222
  s_and_b32 s22, s22, 15
  s_waitcnt lgkmcnt(2)
  v_mfma_f32_16x16x32_bf16 v[104:107], a[184:187], a[208:211], v[104:107]
  ds_read_b128 a[232:235], v240
  s_lshl_b32 s78, s68, 2
  s_waitcnt lgkmcnt(1)
  v_mfma_f32_16x16x32_bf16 v[108:111], a[188:191], a[208:211], v[108:111]
  ds_read_b128 a[236:239], v240 offset:256
  v_mfma_f32_16x16x32_bf16 v[112:115], a[176:179], a[212:215], v[112:115]
  ds_read_b128 a[240:243], v240 offset:1024
  s_sub_u32 s75, s75, s78
  v_mfma_f32_16x16x32_bf16 v[116:119], a[180:183], a[212:215], v[116:119]
  ds_read_b128 a[244:247], v240 offset:1280
  v_mfma_f32_16x16x32_bf16 v[120:123], a[184:187], a[212:215], v[120:123]
  ds_read_b128 a[248:251], v240 offset:2048
  v_mfma_f32_16x16x32_bf16 v[124:127], a[188:191], a[212:215], v[124:127]
  ds_read_b128 a[252:255], v240 offset:2304
  s_add_u32 s75, s75, 12
  v_mfma_f32_16x16x32_bf16 v[128:131], a[176:179], a[216:219], v[128:131]
  s_lshl_b32 s82, s22, 15
  s_add_u32 s82, s82, s25
  v_mfma_f32_16x16x32_bf16 v[132:135], a[180:183], a[216:219], v[132:135]
  s_add_u32 m0, s74, 8192
  v_cmp_eq_u32 vcc, 0, v241
  v_mfma_f32_16x16x32_bf16 v[136:139], a[184:187], a[216:219], v[136:139]
  s_waitcnt vmcnt(13)
  ds_read_b64_tr_b16 a[192:193], v236 offset:12288
  v_mfma_f32_16x16x32_bf16 v[140:143], a[188:191], a[216:219], v[140:143]
  ds_read_b64_tr_b16 a[194:195], v236 offset:13312
  v_mfma_f32_16x16x32_bf16 v[144:147], a[176:179], a[220:223], v[144:147]
  buffer_load_dwordx4 v232, s[48:51], s82 offen lds
  v_mov_b32 v253, s75
  v_mfma_f32_16x16x32_bf16 v[148:151], a[180:183], a[220:223], v[148:151]
  ds_read_b64_tr_b16 a[196:197], v237 offset:12288
  v_mfma_f32_16x16x32_bf16 v[152:155], a[184:187], a[220:223], v[152:155]
  ds_read_b64_tr_b16 a[198:199], v237 offset:13312
  v_mov_b32 v254, 0x7ffffff0
  v_mfma_f32_16x16x32_bf16 v[156:159], a[188:191], a[220:223], v[156:159]
  buffer_load_dwordx4 v233, s[48:51], s82 offen offset:1024 lds
  v_mfma_f32_16x16x32_bf16 v[160:163], a[176:179], a[224:227], v[160:163]
  ds_read_b64_tr_b16 a[200:201], v238 offset:12288
  v_cndmask_b32 v253, v254, v253, vcc
  v_mfma_f32_16x16x32_bf16 v[164:167], a[180:183], a[224:227], v[164:167]
  ds_read_b64_tr_b16 a[202:203], v238 offset:13312
  v_mfma_f32_16x16x32_bf16 v[168:171], a[184:187], a[224:227], v[168:171]
  buffer_load_dwordx4 v234, s[48:51], s82 offen offset:2048 lds
  v_mfma_f32_16x16x32_bf16 v[172:175], a[188:191], a[224:227], v[172:175]
  ds_read_b64_tr_b16 a[204:205], v239 offset:12288
  v_mov_b32 v254, 1
  v_mfma_f32_16x16x32_bf16 v[176:179], a[176:179], a[228:231], v[176:179]
  ds_read_b64_tr_b16 a[206:207], v239 offset:13312
  v_mfma_f32_16x16x32_bf16 v[180:183], a[180:183], a[228:231], v[180:183]
  buffer_load_dwordx4 v235, s[48:51], s82 offen offset:3072 lds
  v_mfma_f32_16x16x32_bf16 v[184:187], a[184:187], a[228:231], v[184:187]
  s_waitcnt vmcnt(8)
  buffer_store_dword v254, v253, s[56:59], 0 offen sc0 sc1
  v_mfma_f32_16x16x32_bf16 v[188:191], a[188:191], a[228:231], v[188:191]
  s_waitcnt lgkmcnt(6)
  v_mfma_f32_16x16x32_bf16 v[96:99], a[192:195], a[232:235], v[96:99]
  s_mul_i32 s83, s20, 6144
  s_add_u32 s23, s23, 4
  v_cmp_eq_u32 vcc, 3, v201
  s_nop 1
  v_cndmask_b32 v193, v193, v205, vcc
  s_waitcnt lgkmcnt(4)
  v_mfma_f32_16x16x32_bf16 v[100:103], a[196:199], a[232:235], v[100:103]
  v_add_u32 v240, s83, v222
  s_and_b32 s23, s23, 15
  v_cmp_eq_u32 vcc, 4, v201
  s_waitcnt lgkmcnt(2)
  v_mfma_f32_16x16x32_bf16 v[104:107], a[200:203], a[232:235], v[104:107]
  ds_read_b128 a[208:211], v240
  v_cndmask_b32 v194, v203, v204, vcc
  v_cmp_eq_u32 vcc, 5, v201
  s_waitcnt lgkmcnt(1)
  v_mfma_f32_16x16x32_bf16 v[108:111], a[204:207], a[232:235], v[108:111]
  ds_read_b128 a[212:215], v240 offset:256
  v_cndmask_b32 v194, v194, v205, vcc
  v_mfma_f32_16x16x32_bf16 v[112:115], a[192:195], a[236:239], v[112:115]
  ds_read_b128 a[216:219], v240 offset:1024
  v_cmp_eq_u32 vcc, 6, v201
  s_nop 1
  v_cndmask_b32 v195, v203, v204, vcc
  v_mfma_f32_16x16x32_bf16 v[116:119], a[196:199], a[236:239], v[116:119]
  ds_read_b128 a[220:223], v240 offset:1280
  v_cmp_eq_u32 vcc, 7, v201
  v_mfma_f32_16x16x32_bf16 v[120:123], a[200:203], a[236:239], v[120:123]
  ds_read_b128 a[224:227], v240 offset:2048
  v_cndmask_b32 v195, v195, v205, vcc
  v_cmp_eq_u32 vcc, 8, v201
  v_mfma_f32_16x16x32_bf16 v[124:127], a[204:207], a[236:239], v[124:127]
  ds_read_b128 a[228:231], v240 offset:2304
  v_cndmask_b32 v196, v203, v204, vcc
  v_mfma_f32_16x16x32_bf16 v[128:131], a[192:195], a[240:243], v[128:131]
  s_lshl_b32 s82, s23, 15
  s_add_u32 s82, s82, s25
  v_cmp_eq_u32 vcc, 9, v201
  s_nop 1
  v_cndmask_b32 v196, v196, v205, vcc
  v_mfma_f32_16x16x32_bf16 v[132:135], a[196:199], a[240:243], v[132:135]
  s_add_u32 m0, s74, 12288
  v_cmp_eq_u32 vcc, 10, v201
  v_mfma_f32_16x16x32_bf16 v[136:139], a[200:203], a[240:243], v[136:139]
  ds_read_b64_tr_b16 a[176:177], v236
  v_cndmask_b32 v197, v203, v204, vcc
  v_cmp_eq_u32 vcc, 11, v201
  v_mfma_f32_16x16x32_bf16 v[140:143], a[204:207], a[240:243], v[140:143]
  ds_read_b64_tr_b16 a[178:179], v236 offset:1024
  v_cndmask_b32 v197, v197, v205, vcc
  v_mfma_f32_16x16x32_bf16 v[144:147], a[192:195], a[244:247], v[144:147]
  buffer_load_dwordx4 v232, s[48:51], s82 offen lds
  v_cmp_eq_u32 vcc, 12, v201
  v_mfma_f32_16x16x32_bf16 v[148:151], a[196:199], a[244:247], v[148:151]
  ds_read_b64_tr_b16 a[180:181], v237
  v_cndmask_b32 v198, v203, v204, vcc
  v_cmp_eq_u32 vcc, 13, v201
  v_mfma_f32_16x16x32_bf16 v[152:155], a[200:203], a[244:247], v[152:155]
  ds_read_b64_tr_b16 a[182:183], v237 offset:1024
  v_cndmask_b32 v198, v198, v205, vcc
  v_cmp_eq_u32 vcc, 14, v201
  v_mfma_f32_16x16x32_bf16 v[156:159], a[204:207], a[244:247], v[156:159]
  buffer_load_dwordx4 v233, s[48:51], s82 offen offset:1024 lds
  v_cndmask_b32 v199, v203, v204, vcc
  v_mfma_f32_16x16x32_bf16 v[160:163], a[192:195], a[248:251], v[160:163]
  ds_read_b64_tr_b16 a[184:185], v238
  v_cmp_eq_u32 vcc, 15, v201
  s_nop 1
  v_cndmask_b32 v199, v199, v205, vcc
  v_mfma_f32_16x16x32_bf16 v[164:167], a[196:199], a[248:251], v[164:167]
  ds_read_b64_tr_b16 a[186:187], v238 offset:1024
  v_and_b32 v201, 15, v200
  v_mfma_f32_16x16x32_bf16 v[168:171], a[200:203], a[248:251], v[168:171]
  buffer_load_dwordx4 v234, s[48:51], s82 offen offset:2048 lds
  v_lshlrev_b32 v201, 11, v201
  v_mfma_f32_16x16x32_bf16 v[172:175], a[204:207], a[248:251], v[172:175]
  ds_read_b64_tr_b16 a[188:189], v239
  v_lshrrev_b32 v202, 4, v200
  v_lshlrev_b32 v202, 4, v202
  v_mfma_f32_16x16x32_bf16 v[176:179], a[192:195], a[252:255], v[176:179]
  ds_read_b64_tr_b16 a[190:191], v239 offset:1024
  v_add_u32 v206, v201, v202
  v_bfe_u32 v252, v241, 4, 2
  v_mfma_f32_16x16x32_bf16 v[180:183], a[196:199], a[252:255], v[180:183]
  buffer_load_dwordx4 v235, s[48:51], s82 offen offset:3072 lds
  v_lshlrev_b32 v252, 2, v252
  v_mfma_f32_16x16x32_bf16 v[184:187], a[200:203], a[252:255], v[184:187]
  s_lshl_b32 s75, s70, 7
  s_add_u32 s75, s75, 0
  v_mfma_f32_16x16x32_bf16 v[188:191], a[204:207], a[252:255], v[188:191]
  v_add_u32 v252, s75, v252
  s_waitcnt lgkmcnt(6)
  v_mfma_f32_16x16x32_bf16 v[96:99], a[176:179], a[208:211], v[96:99]
  s_mul_i32 s83, s21, 6144
  s_add_u32 s20, s20, 4
  s_waitcnt lgkmcnt(4)
  v_mfma_f32_16x16x32_bf16 v[100:103], a[180:183], a[208:211], v[100:103]
  v_add_u32 v240, s83, v222
  s_and_b32 s20, s20, 15
  s_waitcnt lgkmcnt(2)
  v_mfma_f32_16x16x32_bf16 v[104:107], a[184:187], a[208:211], v[104:107]
  ds_read_b128 a[232:235], v240
  s_waitcnt lgkmcnt(1)
  v_mfma_f32_16x16x32_bf16 v[108:111], a[188:191], a[208:211], v[108:111]
  ds_read_b128 a[236:239], v240 offset:256
  v_mfma_f32_16x16x32_bf16 v[112:115], a[176:179], a[212:215], v[112:115]
  ds_read_b128 a[240:243], v240 offset:1024
  v_mfma_f32_16x16x32_bf16 v[116:119], a[180:183], a[212:215], v[116:119]
  ds_read_b128 a[244:247], v240 offset:1280
  v_mfma_f32_16x16x32_bf16 v[120:123], a[184:187], a[212:215], v[120:123]
  ds_read_b128 a[248:251], v240 offset:2048
  v_mfma_f32_16x16x32_bf16 v[124:127], a[188:191], a[212:215], v[124:127]
  ds_read_b128 a[252:255], v240 offset:2304
  v_mfma_f32_16x16x32_bf16 v[128:131], a[176:179], a[216:219], v[128:131]
  s_lshl_b32 s82, s20, 15
  s_add_u32 s82, s82, s25
  v_mfma_f32_16x16x32_bf16 v[132:135], a[180:183], a[216:219], v[132:135]
  s_add_u32 m0, s74, 0
  buffer_load_dword v255, v252, s[56:59], 0 offen sc0 sc1
  v_mfma_f32_16x16x32_bf16 v[136:139], a[184:187], a[216:219], v[136:139]
  s_waitcnt vmcnt(10)
  ds_read_b64_tr_b16 a[192:193], v236 offset:4096
  v_mfma_f32_16x16x32_bf16 v[140:143], a[188:191], a[216:219], v[140:143]
  ds_read_b64_tr_b16 a[194:195], v236 offset:5120
  v_mfma_f32_16x16x32_bf16 v[144:147], a[176:179], a[220:223], v[144:147]
  buffer_load_dwordx4 v232, s[48:51], s82 offen lds
  v_mfma_f32_16x16x32_bf16 v[148:151], a[180:183], a[220:223], v[148:151]
  ds_read_b64_tr_b16 a[196:197], v237 offset:4096
  v_mfma_f32_16x16x32_bf16 v[152:155], a[184:187], a[220:223], v[152:155]
  ds_read_b64_tr_b16 a[198:199], v237 offset:5120
  v_mfma_f32_16x16x32_bf16 v[156:159], a[188:191], a[220:223], v[156:159]
  buffer_load_dwordx4 v233, s[48:51], s82 offen offset:1024 lds
  v_mfma_f32_16x16x32_bf16 v[160:163], a[176:179], a[224:227], v[160:163]
  ds_read_b64_tr_b16 a[200:201], v238 offset:4096
  v_mfma_f32_16x16x32_bf16 v[164:167], a[180:183], a[224:227], v[164:167]
  ds_read_b64_tr_b16 a[202:203], v238 offset:5120
  v_mfma_f32_16x16x32_bf16 v[168:171], a[184:187], a[224:227], v[168:171]
  buffer_load_dwordx4 v234, s[48:51], s82 offen offset:2048 lds
  v_mfma_f32_16x16x32_bf16 v[172:175], a[188:191], a[224:227], v[172:175]
  ds_read_b64_tr_b16 a[204:205], v239 offset:4096
  v_mfma_f32_16x16x32_bf16 v[176:179], a[176:179], a[228:231], v[176:179]
  ds_read_b64_tr_b16 a[206:207], v239 offset:5120
  v_mfma_f32_16x16x32_bf16 v[180:183], a[180:183], a[228:231], v[180:183]
  buffer_load_dwordx4 v235, s[48:51], s82 offen offset:3072 lds
  v_mfma_f32_16x16x32_bf16 v[184:187], a[184:187], a[228:231], v[184:187]
  v_mfma_f32_16x16x32_bf16 v[188:191], a[188:191], a[228:231], v[188:191]
  s_waitcnt lgkmcnt(6)
  v_mfma_f32_16x16x32_bf16 v[96:99], a[192:195], a[232:235], v[96:99]
  s_mul_i32 s83, s22, 6144
  s_add_u32 s21, s21, 4
  s_waitcnt lgkmcnt(4)
  v_mfma_f32_16x16x32_bf16 v[100:103], a[196:199], a[232:235], v[100:103]
  v_add_u32 v240, s83, v222
  s_and_b32 s21, s21, 15
  s_waitcnt lgkmcnt(2)
  v_mfma_f32_16x16x32_bf16 v[104:107], a[200:203], a[232:235], v[104:107]
  ds_read_b128 a[208:211], v240
  s_waitcnt lgkmcnt(1)
  v_mfma_f32_16x16x32_bf16 v[108:111], a[204:207], a[232:235], v[108:111]
  ds_read_b128 a[212:215], v240 offset:256
  v_mfma_f32_16x16x32_bf16 v[112:115], a[192:195], a[236:239], v[112:115]
  ds_read_b128 a[216:219], v240 offset:1024
  v_mfma_f32_16x16x32_bf16 v[116:119], a[196:199], a[236:239], v[116:119]
  ds_read_b128 a[220:223], v240 offset:1280
  v_mfma_f32_16x16x32_bf16 v[120:123], a[200:203], a[236:239], v[120:123]
  ds_read_b128 a[224:227], v240 offset:2048
  v_mfma_f32_16x16x32_bf16 v[124:127], a[204:207], a[236:239], v[124:127]
  ds_read_b128 a[228:231], v240 offset:2304
  v_mfma_f32_16x16x32_bf16 v[128:131], a[192:195], a[240:243], v[128:131]
  s_lshl_b32 s82, s21, 15
  s_add_u32 s82, s82, s25
  v_mfma_f32_16x16x32_bf16 v[132:135], a[196:199], a[240:243], v[132:135]
  s_add_u32 m0, s74, 4096
  v_mfma_f32_16x16x32_bf16 v[136:139], a[200:203], a[240:243], v[136:139]
  s_waitcnt vmcnt(10)
  ds_read_b64_tr_b16 a[176:177], v236 offset:8192
  v_mfma_f32_16x16x32_bf16 v[140:143], a[204:207], a[240:243], v[140:143]
  ds_read_b64_tr_b16 a[178:179], v236 offset:9216
  v_mfma_f32_16x16x32_bf16 v[144:147], a[192:195], a[244:247], v[144:147]
  buffer_load_dwordx4 v232, s[48:51], s82 offen lds
  v_mfma_f32_16x16x32_bf16 v[148:151], a[196:199], a[244:247], v[148:151]
  ds_read_b64_tr_b16 a[180:181], v237 offset:8192
  v_mfma_f32_16x16x32_bf16 v[152:155], a[200:203], a[244:247], v[152:155]
  ds_read_b64_tr_b16 a[182:183], v237 offset:9216
  v_mfma_f32_16x16x32_bf16 v[156:159], a[204:207], a[244:247], v[156:159]
  buffer_load_dwordx4 v233, s[48:51], s82 offen offset:1024 lds
  v_mfma_f32_16x16x32_bf16 v[160:163], a[192:195], a[248:251], v[160:163]
  ds_read_b64_tr_b16 a[184:185], v238 offset:8192
  v_mfma_f32_16x16x32_bf16 v[164:167], a[196:199], a[248:251], v[164:167]
  ds_read_b64_tr_b16 a[186:187], v238 offset:9216
  v_mfma_f32_16x16x32_bf16 v[168:171], a[200:203], a[248:251], v[168:171]
  buffer_load_dwordx4 v234, s[48:51], s82 offen offset:2048 lds
  v_mfma_f32_16x16x32_bf16 v[172:175], a[204:207], a[248:251], v[172:175]
  ds_read_b64_tr_b16 a[188:189], v239 offset:8192
  v_mfma_f32_16x16x32_bf16 v[176:179], a[192:195], a[252:255], v[176:179]
  ds_read_b64_tr_b16 a[190:191], v239 offset:9216
  v_mfma_f32_16x16x32_bf16 v[180:183], a[196:199], a[252:255], v[180:183]
  buffer_load_dwordx4 v235, s[48:51], s82 offen offset:3072 lds
  v_mfma_f32_16x16x32_bf16 v[184:187], a[200:203], a[252:255], v[184:187]
  v_mfma_f32_16x16x32_bf16 v[188:191], a[204:207], a[252:255], v[188:191]
  s_mov_b32 s89, 0
L_poll_as:
  s_waitcnt vmcnt(8)
  v_cmp_eq_u32 vcc, 1, v255
  s_add_u32 s89, s89, 1
  s_nop 1
  s_cmp_eq_u64 vcc, -1
  s_cbranch_scc1 L_got_as
  s_cmp_gt_u32 s89, 200000
  s_cbranch_scc1 L_got_as
  buffer_load_dword v255, v252, s[56:59], 0 offen sc0 sc1
  s_waitcnt vmcnt(0)
  s_branch L_poll_as
L_got_as:
  s_waitcnt lgkmcnt(6)
  v_mfma_f32_16x16x32_bf16 v[96:99], a[176:179], a[208:211], v[96:99]
  s_mul_i32 s83, s23, 6144
  s_add_u32 s22, s22, 4
  s_mul_i32 s78, s68, 3072
  s_waitcnt lgkmcnt(4)
  v_mfma_f32_16x16x32_bf16 v[100:103], a[180:183], a[208:211], v[100:103]
  v_add_u32 v240, s83, v222
  s_and_b32 s22, s22, 15
  s_waitcnt lgkmcnt(2)
  v_mfma_f32_16x16x32_bf16 v[104:107], a[184:187], a[208:211], v[104:107]
  ds_read_b128 a[232:235], v240
  s_waitcnt lgkmcnt(1)
  v_mfma_f32_16x16x32_bf16 v[108:111], a[188:191], a[208:211], v[108:111]
  ds_read_b128 a[236:239], v240 offset:256
  s_mul_i32 s75, s70, 49152
  v_mfma_f32_16x16x32_bf16 v[112:115], a[176:179], a[212:215], v[112:115]
  ds_read_b128 a[240:243], v240 offset:1024
  v_mfma_f32_16x16x32_bf16 v[116:119], a[180:183], a[212:215], v[116:119]
  ds_read_b128 a[244:247], v240 offset:1280
  v_mfma_f32_16x16x32_bf16 v[120:123], a[184:187], a[212:215], v[120:123]
  ds_read_b128 a[248:251], v240 offset:2048
  s_add_u32 s84, s75, s78
  v_mfma_f32_16x16x32_bf16 v[124:127], a[188:191], a[212:215], v[124:127]
  ds_read_b128 a[252:255], v240 offset:2304
  v_mfma_f32_16x16x32_bf16 v[128:131], a[176:179], a[216:219], v[128:131]
  s_lshl_b32 s82, s22, 15
  s_add_u32 s82, s82, s25
  v_mfma_f32_16x16x32_bf16 v[132:135], a[180:183], a[216:219], v[132:135]
  s_add_u32 m0, s74, 8192
  buffer_load_dwordx4 a[0:3], v241, s[52:55], s84 offen sc0 sc1
  v_mfma_f32_16x16x32_bf16 v[136:139], a[184:187], a[216:219], v[136:139]
  ds_read_b64_tr_b16 a[192:193], v236 offset:12288
  v_mfma_f32_16x16x32_bf16 v[140:143], a[188:191], a[216:219], v[140:143]
  ds_read_b64_tr_b16 a[194:195], v236 offset:13312
  v_mfma_f32_16x16x32_bf16 v[144:147], a[176:179], a[220:223], v[144:147]
  buffer_load_dwordx4 v232, s[48:51], s82 offen lds
  v_mfma_f32_16x16x32_bf16 v[148:151], a[180:183], a[220:223], v[148:151]
  ds_read_b64_tr_b16 a[196:197], v237 offset:12288
  v_mfma_f32_16x16x32_bf16 v[152:155], a[184:187], a[220:223], v[152:155]
  ds_read_b64_tr_b16 a[198:199], v237 offset:13312
  v_mfma_f32_16x16x32_bf16 v[156:159], a[188:191], a[220:223], v[156:159]
  buffer_load_dwordx4 v233, s[48:51], s82 offen offset:1024 lds
  v_mfma_f32_16x16x32_bf16 v[160:163], a[176:179], a[224:227], v[160:163]
  ds_read_b64_tr_b16 a[200:201], v238 offset:12288
  v_mfma_f32_16x16x32_bf16 v[164:167], a[180:183], a[224:227], v[164:167]
  ds_read_b64_tr_b16 a[202:203], v238 offset:13312
  v_mfma_f32_16x16x32_bf16 v[168:171], a[184:187], a[224:227], v[168:171]
  buffer_load_dwordx4 v234, s[48:51], s82 offen offset:2048 lds
  v_mfma_f32_16x16x32_bf16 v[172:175], a[188:191], a[224:227], v[172:175]
  ds_read_b64_tr_b16 a[204:205], v239 offset:12288
  v_mfma_f32_16x16x32_bf16 v[176:179], a[176:179], a[228:231], v[176:179]
  ds_read_b64_tr_b16 a[206:207], v239 offset:13312
  v_mfma_f32_16x16x32_bf16 v[180:183], a[180:183], a[228:231], v[180:183]
  buffer_load_dwordx4 v235, s[48:51], s82 offen offset:3072 lds
  v_mfma_f32_16x16x32_bf16 v[184:187], a[184:187], a[228:231], v[184:187]
  buffer_load_dwordx4 a[4:7], v241, s[52:55], s84 offen offset:1024 sc0 sc1
  v_mfma_f32_16x16x32_bf16 v[188:191], a[188:191], a[228:231], v[188:191]
  buffer_load_dwordx4 a[8:11], v241, s[52:55], s84 offen offset:2048 sc0 sc1
  s_add_u32 s84, s84, 12288
  buffer_load_dwordx4 a[12:15], v241, s[52:55], s84 offen sc0 sc1
  s_waitcnt lgkmcnt(6)
  v_mfma_f32_16x16x32_bf16 v[96:99], a[192:195], a[232:235], v[96:99]
  s_mul_i32 s83, s20, 6144
  s_add_u32 s23, s23, 4
  s_waitcnt lgkmcnt(4)
  v_mfma_f32_16x16x32_bf16 v[100:103], a[196:199], a[232:235], v[100:103]
  v_add_u32 v240, s83, v222
  s_and_b32 s23, s23, 15
  s_waitcnt lgkmcnt(2)
  v_mfma_f32_16x16x32_bf16 v[104:107], a[200:203], a[232:235], v[104:107]
  ds_read_b128 a[208:211], v240
  s_waitcnt lgkmcnt(1)
  v_mfma_f32_16x16x32_bf16 v[108:111], a[204:207], a[232:235], v[108:111]
  ds_read_b128 a[212:215], v240 offset:256
  v_mfma_f32_16x16x32_bf16 v[112:115], a[192:195], a[236:239], v[112:115]
  ds_read_b128 a[216:219], v240 offset:1024
  v_mfma_f32_16x16x32_bf16 v[116:119], a[196:199], a[236:239], v[116:119]
  ds_read_b128 a[220:223], v240 offset:1280
  v_mfma_f32_16x16x32_bf16 v[120:123], a[200:203], a[236:239], v[120:123]
  ds_read_b128 a[224:227], v240 offset:2048
  v_mfma_f32_16x16x32_bf16 v[124:127], a[204:207], a[236:239], v[124:127]
  ds_read_b128 a[228:231], v240 offset:2304
  v_mfma_f32_16x16x32_bf16 v[128:131], a[192:195], a[240:243], v[128:131]
  s_lshl_b32 s82, s23, 15
  s_add_u32 s82, s82, s25
  v_mfma_f32_16x16x32_bf16 v[132:135], a[196:199], a[240:243], v[132:135]
  s_add_u32 m0, s74, 12288
  buffer_load_dwordx4 a[16:19], v241, s[52:55], s84 offen offset:1024 sc0 sc1
  v_mfma_f32_16x16x32_bf16 v[136:139], a[200:203], a[240:243], v[136:139]
  s_waitcnt vmcnt(13)
  ds_read_b64_tr_b16 a[176:177], v236
  v_mfma_f32_16x16x32_bf16 v[140:143], a[204:207], a[240:243], v[140:143]
  ds_read_b64_tr_b16 a[178:179], v236 offset:1024
  v_mfma_f32_16x16x32_bf16 v[144:147], a[192:195], a[244:247], v[144:147]
  buffer_load_dwordx4 v232, s[48:51], s82 offen lds
  v_mfma_f32_16x16x32_bf16 v[148:151], a[196:199], a[244:247], v[148:151]
  ds_read_b64_tr_b16 a[180:181], v237
  v_mfma_f32_16x16x32_bf16 v[152:155], a[200:203], a[244:247], v[152:155]
  ds_read_b64_tr_b16 a[182:183], v237 offset:1024
  v_mfma_f32_16x16x32_bf16 v[156:159], a[204:207], a[244:247], v[156:159]
  buffer_load_dwordx4 v233, s[48:51], s82 offen offset:1024 lds
  v_mfma_f32_16x16x32_bf16 v[160:163], a[192:195], a[248:251], v[160:163]
  ds_read_b64_tr_b16 a[184:185], v238
  v_mfma_f32_16x16x32_bf16 v[164:167], a[196:199], a[248:251], v[164:167]
  ds_read_b64_tr_b16 a[186:187], v238 offset:1024
  v_mfma_f32_16x16x32_bf16 v[168:171], a[200:203], a[248:251], v[168:171]
  buffer_load_dwordx4 v234, s[48:51], s82 offen offset:2048 lds
  v_mfma_f32_16x16x32_bf16 v[172:175], a[204:207], a[248:251], v[172:175]
  ds_read_b64_tr_b16 a[188:189], v239
  v_mfma_f32_16x16x32_bf16 v[176:179], a[192:195], a[252:255], v[176:179]
  ds_read_b64_tr_b16 a[190:191], v239 offset:1024
  v_mfma_f32_16x16x32_bf16 v[180:183], a[196:199], a[252:255], v[180:183]
  buffer_load_dwordx4 v235, s[48:51], s82 offen offset:3072 lds
  v_mfma_f32_16x16x32_bf16 v[184:187], a[200:203], a[252:255], v[184:187]
  buffer_load_dwordx4 a[20:23], v241, s[52:55], s84 offen offset:2048 sc0 sc1
  s_add_u32 s84, s84, 12288
  v_mfma_f32_16x16x32_bf16 v[188:191], a[204:207], a[252:255], v[188:191]
  buffer_load_dwordx4 a[24:27], v241, s[52:55], s84 offen sc0 sc1
  buffer_load_dwordx4 a[28:31], v241, s[52:55], s84 offen offset:1024 sc0 sc1
  s_waitcnt lgkmcnt(6)
  v_mfma_f32_16x16x32_bf16 v[96:99], a[176:179], a[208:211], v[96:99]
  s_mul_i32 s83, s21, 6144
  buffer_load_dwordx4 a[32:35], v241, s[52:55], s84 offen offset:2048 sc0 sc1
  s_waitcnt lgkmcnt(4)
  v_mfma_f32_16x16x32_bf16 v[100:103], a[180:183], a[208:211], v[100:103]
  v_add_u32 v240, s83, v222
  s_waitcnt lgkmcnt(2)
  v_mfma_f32_16x16x32_bf16 v[104:107], a[184:187], a[208:211], v[104:107]
  ds_read_b128 a[232:235], v240
  s_waitcnt lgkmcnt(1)
  v_mfma_f32_16x16x32_bf16 v[108:111], a[188:191], a[208:211], v[108:111]
  ds_read_b128 a[236:239], v240 offset:256
  v_mfma_f32_16x16x32_bf16 v[112:115], a[176:179], a[212:215], v[112:115]
  ds_read_b128 a[240:243], v240 offset:1024
  s_add_u32 s84, s84, 12288
  v_mfma_f32_16x16x32_bf16 v[116:119], a[180:183], a[212:215], v[116:119]
  ds_read_b128 a[244:247], v240 offset:1280
  v_mfma_f32_16x16x32_bf16 v[120:123], a[184:187], a[212:215], v[120:123]
  ds_read_b128 a[248:251], v240 offset:2048
  v_mfma_f32_16x16x32_bf16 v[124:127], a[188:191], a[212:215], v[124:127]
  ds_read_b128 a[252:255], v240 offset:2304
  v_mfma_f32_16x16x32_bf16 v[128:131], a[176:179], a[216:219], v[128:131]
  v_mfma_f32_16x16x32_bf16 v[132:135], a[180:183], a[216:219], v[132:135]
  buffer_load_dwordx4 a[36:39], v241, s[52:55], s84 offen sc0 sc1
  v_mfma_f32_16x16x32_bf16 v[136:139], a[184:187], a[216:219], v[136:139]
  s_waitcnt vmcnt(18)
  ds_read_b64_tr_b16 a[192:193], v236 offset:4096
  v_mfma_f32_16x16x32_bf16 v[140:143], a[188:191], a[216:219], v[140:143]
  ds_read_b64_tr_b16 a[194:195], v236 offset:5120
  v_mfma_f32_16x16x32_bf16 v[144:147], a[176:179], a[220:223], v[144:147]
  v_mfma_f32_16x16x32_bf16 v[148:151], a[180:183], a[220:223], v[148:151]
  ds_read_b64_tr_b16 a[196:197], v237 offset:4096
  v_mfma_f32_16x16x32_bf16 v[152:155], a[184:187], a[220:223], v[152:155]
  ds_read_b64_tr_b16 a[198:199], v237 offset:5120
  v_mfma_f32_16x16x32_bf16 v[156:159], a[188:191], a[220:223], v[156:159]
  buffer_load_dwordx4 a[40:43], v241, s[52:55], s84 offen offset:1024 sc0 sc1
  v_mfma_f32_16x16x32_bf16 v[160:163], a[176:179], a[224:227], v[160:163]
  ds_read_b64_tr_b16 a[200:201], v238 offset:4096
  v_mfma_f32_16x16x32_bf16 v[164:167], a[180:183], a[224:227], v[164:167]
  ds_read_b64_tr_b16 a[202:203], v238 offset:5120
  v_mfma_f32_16x16x32_bf16 v[168:171], a[184:187], a[224:227], v[168:171]
  v_mfma_f32_16x16x32_bf16 v[172:175], a[188:191], a[224:227], v[172:175]
  ds_read_b64_tr_b16 a[204:205], v239 offset:4096
  v_mfma_f32_16x16x32_bf16 v[176:179], a[176:179], a[228:231], v[176:179]
  ds_read_b64_tr_b16 a[206:207], v239 offset:5120
  v_mfma_f32_16x16x32_bf16 v[180:183], a[180:183], a[228:231], v[180:183]
  buffer_load_dwordx4 a[44:47], v241, s[52:55], s84 offen offset:2048 sc0 sc1
  v_mfma_f32_16x16x32_bf16 v[184:187], a[184:187], a[228:231], v[184:187]
  v_mfma_f32_16x16x32_bf16 v[188:191], a[188:191], a[228:231], v[188:191]
  s_waitcnt lgkmcnt(6)
  v_mfma_f32_16x16x32_bf16 v[96:99], a[192:195], a[232:235], v[96:99]
  s_mul_i32 s83, s22, 6144
  s_waitcnt lgkmcnt(4)
  v_mfma_f32_16x16x32_bf16 v[100:103], a[196:199], a[232:235], v[100:103]
  v_add_u32 v240, s83, v222
  s_waitcnt lgkmcnt(2)
  v_mfma_f32_16x16x32_bf16 v[104:107], a[200:203], a[232:235], v[104:107]
  ds_read_b128 a[208:211], v240
  s_waitcnt lgkmcnt(1)
  v_mfma_f32_16x16x32_bf16 v[108:111], a[204:207], a[232:235], v[108:111]
  ds_read_b128 a[212:215], v240 offset:256
  v_mfma_f32_16x16x32_bf16 v[112:115], a[192:195], a[236:239], v[112:115]
  ds_read_b128 a[216:219], v240 offset:1024
  v_mfma_f32_16x16x32_bf16 v[116:119], a[196:199], a[236:239], v[116:119]
  ds_read_b128 a[220:223], v240 offset:1280
  v_mfma_f32_16x16x32_bf16 v[120:123], a[200:203], a[236:239], v[120:123]
  ds_read_b128 a[224:227], v240 offset:2048
  v_mfma_f32_16x16x32_bf16 v[124:127], a[204:207], a[236:239], v[124:127]
  ds_read_b128 a[228:231], v240 offset:2304
  v_mfma_f32_16x16x32_bf16 v[128:131], a[192:195], a[240:243], v[128:131]
  v_mfma_f32_16x16x32_bf16 v[132:135], a[196:199], a[240:243], v[132:135]
  v_mfma_f32_16x16x32_bf16 v[136:139], a[200:203], a[240:243], v[136:139]
  s_waitcnt vmcnt(15)
  ds_read_b64_tr_b16 a[176:177], v236 offset:8192
  v_mfma_f32_16x16x32_bf16 v[140:143], a[204:207], a[240:243], v[140:143]
  ds_read_b64_tr_b16 a[178:179], v236 offset:9216
  v_mfma_f32_16x16x32_bf16 v[144:147], a[192:195], a[244:247], v[144:147]
  v_mfma_f32_16x16x32_bf16 v[148:151], a[196:199], a[244:247], v[148:151]
  ds_read_b64_tr_b16 a[180:181], v237 offset:8192
  v_mfma_f32_16x16x32_bf16 v[152:155], a[200:203], a[244:247], v[152:155]
  ds_read_b64_tr_b16 a[182:183], v237 offset:9216
  v_mfma_f32_16x16x32_bf16 v[156:159], a[204:207], a[244:247], v[156:159]
  v_mfma_f32_16x16x32_bf16 v[160:163], a[192:195], a[248:251], v[160:163]
  ds_read_b64_tr_b16 a[184:185], v238 offset:8192
  v_mfma_f32_16x16x32_bf16 v[164:167], a[196:199], a[248:251], v[164:167]
  ds_read_b64_tr_b16 a[186:187], v238 offset:9216
  v_mfma_f32_16x16x32_bf16 v[168:171], a[200:203], a[248:251], v[168:171]
  v_mfma_f32_16x16x32_bf16 v[172:175], a[204:207], a[248:251], v[172:175]
  ds_read_b64_tr_b16 a[188:189], v239 offset:8192
  v_mfma_f32_16x16x32_bf16 v[176:179], a[192:195], a[252:255], v[176:179]
  ds_read_b64_tr_b16 a[190:191], v239 offset:9216
  v_mfma_f32_16x16x32_bf16 v[180:183], a[196:199], a[252:255], v[180:183]
  v_mfma_f32_16x16x32_bf16 v[184:187], a[200:203], a[252:255], v[184:187]
  v_mfma_f32_16x16x32_bf16 v[188:191], a[204:207], a[252:255], v[188:191]
  s_waitcnt lgkmcnt(6)
  v_mfma_f32_16x16x32_bf16 v[96:99], a[176:179], a[208:211], v[96:99]
  s_mul_i32 s83, s23, 6144
  s_lshl_b32 s75, s70, 7
  s_waitcnt lgkmcnt(4)
  v_mfma_f32_16x16x32_bf16 v[100:103], a[180:183], a[208:211], v[100:103]
  v_add_u32 v240, s83, v222
  s_lshl_b32 s78, s68, 2
  s_waitcnt lgkmcnt(2)
  v_mfma_f32_16x16x32_bf16 v[104:107], a[184:187], a[208:211], v[104:107]
  ds_read_b128 a[232:235], v240
  s_waitcnt lgkmcnt(1)
  v_mfma_f32_16x16x32_bf16 v[108:111], a[188:191], a[208:211], v[108:111]
  ds_read_b128 a[236:239], v240 offset:256
  s_add_u32 s75, s75, s78
  v_mfma_f32_16x16x32_bf16 v[112:115], a[176:179], a[212:215], v[112:115]
  ds_read_b128 a[240:243], v240 offset:1024
  s_add_u32 s75, s75, 32
  v_mfma_f32_16x16x32_bf16 v[116:119], a[180:183], a[212:215], v[116:119]
  ds_read_b128 a[244:247], v240 offset:1280
  v_mfma_f32_16x16x32_bf16 v[120:123], a[184:187], a[212:215], v[120:123]
  ds_read_b128 a[248:251], v240 offset:2048
  v_cmp_eq_u32 vcc, 0, v241
  v_mfma_f32_16x16x32_bf16 v[124:127], a[188:191], a[212:215], v[124:127]
  ds_read_b128 a[252:255], v240 offset:2304
  v_mfma_f32_16x16x32_bf16 v[128:131], a[176:179], a[216:219], v[128:131]
  v_mov_b32 v253, s75
  v_mfma_f32_16x16x32_bf16 v[132:135], a[180:183], a[216:219], v[132:135]
  v_mov_b32 v254, 0x7ffffff0
  v_mfma_f32_16x16x32_bf16 v[136:139], a[184:187], a[216:219], v[136:139]
  s_waitcnt vmcnt(7)
  ds_read_b64_tr_b16 a[192:193], v236 offset:12288
  v_mfma_f32_16x16x32_bf16 v[140:143], a[188:191], a[216:219], v[140:143]
  ds_read_b64_tr_b16 a[194:195], v236 offset:13312
  v_cndmask_b32 v253, v254, v253, vcc
  v_mfma_f32_16x16x32_bf16 v[144:147], a[176:179], a[220:223], v[144:147]
  v_mov_b32 v254, 1
  v_mfma_f32_16x16x32_bf16 v[148:151], a[180:183], a[220:223], v[148:151]
  ds_read_b64_tr_b16 a[196:197], v237 offset:12288
  v_mfma_f32_16x16x32_bf16 v[152:155], a[184:187], a[220:223], v[152:155]
  ds_read_b64_tr_b16 a[198:199], v237 offset:13312
  v_mfma_f32_16x16x32_bf16 v[156:159], a[188:191], a[220:223], v[156:159]
  s_waitcnt vmcnt(0)
  buffer_store_dword v254, v253, s[56:59], 0 offen sc0 sc1
  v_mfma_f32_16x16x32_bf16 v[160:163], a[176:179], a[224:227], v[160:163]
  ds_read_b64_tr_b16 a[200:201], v238 offset:12288
  v_bfe_u32 v252, v241, 4, 2
  v_mfma_f32_16x16x32_bf16 v[164:167], a[180:183], a[224:227], v[164:167]
  ds_read_b64_tr_b16 a[202:203], v238 offset:13312
  v_lshlrev_b32 v252, 2, v252
  v_mfma_f32_16x16x32_bf16 v[168:171], a[184:187], a[224:227], v[168:171]
  v_mfma_f32_16x16x32_bf16 v[172:175], a[188:191], a[224:227], v[172:175]
  ds_read_b64_tr_b16 a[204:205], v239 offset:12288
  s_lshl_b32 s75, s3, 7
  v_mfma_f32_16x16x32_bf16 v[176:179], a[176:179], a[228:231], v[176:179]
  ds_read_b64_tr_b16 a[206:207], v239 offset:13312
  s_add_u32 s75, s75, 32
  v_mfma_f32_16x16x32_bf16 v[180:183], a[180:183], a[228:231], v[180:183]
  v_mfma_f32_16x16x32_bf16 v[184:187], a[184:187], a[228:231], v[184:187]
  v_add_u32 v252, s75, v252
  v_mfma_f32_16x16x32_bf16 v[188:191], a[188:191], a[228:231], v[188:191]
  s_waitcnt lgkmcnt(6)
  v_mfma_f32_16x16x32_bf16 v[96:99], a[192:195], a[232:235], v[96:99]
  buffer_load_dword v255, v252, s[56:59], 0 offen sc0 sc1
  s_waitcnt lgkmcnt(4)
  v_mfma_f32_16x16x32_bf16 v[100:103], a[196:199], a[232:235], v[100:103]
  s_waitcnt lgkmcnt(2)
  v_mfma_f32_16x16x32_bf16 v[104:107], a[200:203], a[232:235], v[104:107]
  s_waitcnt lgkmcnt(0)
  v_mfma_f32_16x16x32_bf16 v[108:111], a[204:207], a[232:235], v[108:111]
  v_mfma_f32_16x16x32_bf16 v[112:115], a[192:195], a[236:239], v[112:115]
  v_mfma_f32_16x16x32_bf16 v[116:119], a[196:199], a[236:239], v[116:119]
  v_mfma_f32_16x16x32_bf16 v[120:123], a[200:203], a[236:239], v[120:123]
  v_mfma_f32_16x16x32_bf16 v[124:127], a[204:207], a[236:239], v[124:127]
  v_mfma_f32_16x16x32_bf16 v[128:131], a[192:195], a[240:243], v[128:131]
  v_mfma_f32_16x16x32_bf16 v[132:135], a[196:199], a[240:243], v[132:135]
  v_mfma_f32_16x16x32_bf16 v[136:139], a[200:203], a[240:243], v[136:139]
  v_mfma_f32_16x16x32_bf16 v[140:143], a[204:207], a[240:243], v[140:143]
  v_mfma_f32_16x16x32_bf16 v[144:147], a[192:195], a[244:247], v[144:147]
  v_mfma_f32_16x16x32_bf16 v[148:151], a[196:199], a[244:247], v[148:151]
  v_mfma_f32_16x16x32_bf16 v[152:155], a[200:203], a[244:247], v[152:155]
  v_mfma_f32_16x16x32_bf16 v[156:159], a[204:207], a[244:247], v[156:159]
  v_mfma_f32_16x16x32_bf16 v[160:163], a[192:195], a[248:251], v[160:163]
  v_mfma_f32_16x16x32_bf16 v[164:167], a[196:199], a[248:251], v[164:167]
  v_mfma_f32_16x16x32_bf16 v[168:171], a[200:203], a[248:251], v[168:171]
  v_mfma_f32_16x16x32_bf16 v[172:175], a[204:207], a[248:251], v[172:175]
  v_mfma_f32_16x16x32_bf16 v[176:179], a[192:195], a[252:255], v[176:179]
  v_mfma_f32_16x16x32_bf16 v[180:183], a[196:199], a[252:255], v[180:183]
  v_mfma_f32_16x16x32_bf16 v[184:187], a[200:203], a[252:255], v[184:187]
  v_mfma_f32_16x16x32_bf16 v[188:191], a[204:207], a[252:255], v[188:191]
  s_mov_b32 s89, 0
L_poll_cs:
  s_waitcnt vmcnt(0)
  v_cmp_eq_u32 vcc, 1, v255
  s_add_u32 s89, s89, 1
  s_nop 1
  s_cmp_eq_u64 vcc, -1
  s_cbranch_scc1 L_got_cs
  s_cmp_gt_u32 s89, 200000
  s_cbranch_scc1 L_got_cs
  buffer_load_dword v255, v252, s[56:59], 0 offen sc0 sc1
  s_waitcnt vmcnt(0)
  s_branch L_poll_cs
L_got_cs:
  s_lshl_b32 s77, s3, 2
  s_add_u32 s77, s77, s68
  s_mul_i32 s77, s77, 12288
  s_cmp_eq_u32 s68, 0
  s_cselect_b32 s77, 0x7ff00000, s77
  v_cvt_pk_bf16_f32 v96, v96, v97
  v_cvt_pk_bf16_f32 v97, v98, v99
  v_cvt_pk_bf16_f32 v98, v100, v101
  v_cvt_pk_bf16_f32 v99, v102, v103
  buffer_store_dwordx4 v[96:99], v241, s[52:55], s77 offen sc0 sc1
  v_cvt_pk_bf16_f32 v104, v104, v105
  v_cvt_pk_bf16_f32 v105, v106, v107
  v_cvt_pk_bf16_f32 v106, v108, v109
  v_cvt_pk_bf16_f32 v107, v110, v111
  buffer_store_dwordx4 v[104:107], v241, s[52:55], s77 offen offset:1024 sc0 sc1
  v_cvt_pk_bf16_f32 v112, v112, v113
  v_cvt_pk_bf16_f32 v113, v114, v115
  v_cvt_pk_bf16_f32 v114, v116, v117
  v_cvt_pk_bf16_f32 v115, v118, v119
  buffer_store_dwordx4 v[112:115], v241, s[52:55], s77 offen offset:2048 sc0 sc1
  v_cvt_pk_bf16_f32 v120, v120, v121
  v_cvt_pk_bf16_f32 v121, v122, v123
  v_cvt_pk_bf16_f32 v122, v124, v125
  v_cvt_pk_bf16_f32 v123, v126, v127
  buffer_store_dwordx4 v[120:123], v241, s[52:55], s77 offen offset:3072 sc0 sc1
  v_cvt_pk_bf16_f32 v128, v128, v129
  v_cvt_pk_bf16_f32 v129, v130, v131
  v_cvt_pk_bf16_f32 v130, v132, v133
  v_cvt_pk_bf16_f32 v131, v134, v135
  s_add_u32 s77, s77, 4096
  buffer_store_dwordx4 v[128:131], v241, s[52:55], s77 offen sc0 sc1
  v_cvt_pk_bf16_f32 v136, v136, v137
  v_cvt_pk_bf16_f32 v137, v138, v139
  v_cvt_pk_bf16_f32 v138, v140, v141
  v_cvt_pk_bf16_f32 v139, v142, v143
  buffer_store_dwordx4 v[136:139], v241, s[52:55], s77 offen offset:1024 sc0 sc1
  v_cvt_pk_bf16_f32 v144, v144, v145
  v_cvt_pk_bf16_f32 v145, v146, v147
  v_cvt_pk_bf16_f32 v146, v148, v149
  v_cvt_pk_bf16_f32 v147, v150, v151
  buffer_store_dwordx4 v[144:147], v241, s[52:55], s77 offen offset:2048 sc0 sc1
  v_cvt_pk_bf16_f32 v152, v152, v153
  v_cvt_pk_bf16_f32 v153, v154, v155
  v_cvt_pk_bf16_f32 v154, v156, v157
  v_cvt_pk_bf16_f32 v155, v158, v159
  buffer_store_dwordx4 v[152:155], v241, s[52:55], s77 offen offset:3072 sc0 sc1
  v_cvt_pk_bf16_f32 v160, v160, v161
  v_cvt_pk_bf16_f32 v161, v162, v163
  v_cvt_pk_bf16_f32 v162, v164, v165
  v_cvt_pk_bf16_f32 v163, v166, v167
  s_add_u32 s77, s77, 4096
  buffer_store_dwordx4 v[160:163], v241, s[52:55], s77 offen sc0 sc1
  v_cvt_pk_bf16_f32 v168, v168, v169
  v_cvt_pk_bf16_f32 v169, v170, v171
  v_cvt_pk_bf16_f32 v170, v172, v173
  v_cvt_pk_bf16_f32 v171, v174, v175
  buffer_store_dwordx4 v[168:171], v241, s[52:55], s77 offen offset:1024 sc0 sc1
  v_cvt_pk_bf16_f32 v176, v176, v177
  v_cvt_pk_bf16_f32 v177, v178, v179
  v_cvt_pk_bf16_f32 v178, v180, v181
  v_cvt_pk_bf16_f32 v179, v182, v183
  buffer_store_dwordx4 v[176:179], v241, s[52:55], s77 offen offset:2048 sc0 sc1
  v_cvt_pk_bf16_f32 v184, v184, v185
  v_cvt_pk_bf16_f32 v185, v186, v187
  v_cvt_pk_bf16_f32 v186, v188, v189
  v_cvt_pk_bf16_f32 v187, v190, v191
  buffer_store_dwordx4 v[184:187], v241, s[52:55], s77 offen offset:3072 sc0 sc1
  s_cmp_eq_u32 s68, 0
  s_cbranch_scc0 L_noown_s
  v_add_u32 v253, 98304, v241
  ds_write_b128 v253, v[96:99]
  ds_write_b128 v253, v[104:107] offset:1024
  ds_write_b128 v253, v[112:115] offset:2048
  ds_write_b128 v253, v[120:123] offset:3072
  ds_write_b128 v253, v[128:131] offset:4096
  ds_write_b128 v253, v[136:139] offset:5120
  ds_write_b128 v253, v[144:147] offset:6144
  ds_write_b128 v253, v[152:155] offset:7168
  ds_write_b128 v253, v[160:163] offset:8192
  ds_write_b128 v253, v[168:171] offset:9216
  ds_write_b128 v253, v[176:179] offset:10240
  ds_write_b128 v253, v[184:187] offset:11264
L_noown_s:
  s_waitcnt lgkmcnt(0)
  s_barrier
  s_mul_i32 s75, s68, 3072
  s_add_u32 s75, s75, 98304
  v_add_u32 v253, s75, v241
  ds_read_b128 a[48:51], v253
  ds_read_b128 a[52:55], v253 offset:1024
  ds_read_b128 a[56:59], v253 offset:2048
  v_mfma_f32_16x16x32_bf16 v[0:3], v[192:195], a[0:3], 0
  v_mfma_f32_16x16x32_bf16 v[4:7], v[196:199], a[0:3], 0
  v_mfma_f32_16x16x32_bf16 v[8:11], v[192:195], a[4:7], 0
  v_mfma_f32_16x16x32_bf16 v[12:15], v[196:199], a[4:7], 0
  v_mfma_f32_16x16x32_bf16 v[16:19], v[192:195], a[8:11], 0
  v_mfma_f32_16x16x32_bf16 v[20:23], v[196:199], a[8:11], 0
  v_mfma_f32_16x16x32_bf16 v[0:3], v[192:195], a[12:15], v[0:3]
  v_mfma_f32_16x16x32_bf16 v[4:7], v[196:199], a[12:15], v[4:7]
  v_mfma_f32_16x16x32_bf16 v[8:11], v[192:195], a[16:19], v[8:11]
  v_mfma_f32_16x16x32_bf16 v[12:15], v[196:199], a[16:19], v[12:15]
  v_mfma_f32_16x16x32_bf16 v[16:19], v[192:195], a[20:23], v[16:19]
  v_mfma_f32_16x16x32_bf16 v[20:23], v[196:199], a[20:23], v[20:23]
  v_mfma_f32_16x16x32_bf16 v[0:3], v[192:195], a[24:27], v[0:3]
  v_mfma_f32_16x16x32_bf16 v[4:7], v[196:199], a[24:27], v[4:7]
  v_mfma_f32_16x16x32_bf16 v[8:11], v[192:195], a[28:31], v[8:11]
  v_mfma_f32_16x16x32_bf16 v[12:15], v[196:199], a[28:31], v[12:15]
  v_mfma_f32_16x16x32_bf16 v[16:19], v[192:195], a[32:35], v[16:19]
  v_mfma_f32_16x16x32_bf16 v[20:23], v[196:199], a[32:35], v[20:23]
  v_mfma_f32_16x16x32_bf16 v[0:3], v[192:195], a[36:39], v[0:3]
  v_mfma_f32_16x16x32_bf16 v[4:7], v[196:199], a[36:39], v[4:7]
  v_mfma_f32_16x16x32_bf16 v[8:11], v[192:195], a[40:43], v[8:11]
  v_mfma_f32_16x16x32_bf16 v[12:15], v[196:199], a[40:43], v[12:15]
  v_mfma_f32_16x16x32_bf16 v[16:19], v[192:195], a[44:47], v[16:19]
  v_mfma_f32_16x16x32_bf16 v[20:23], v[196:199], a[44:47], v[20:23]
  v_bfe_u32 v252, v241, 4, 2
  v_max_u32 v252, 1, v252
  v_lshlrev_b32 v252, 2, v252
  s_lshl_b32 s75, s70, 7
  s_add_u32 s75, s75, 16
  v_add_u32 v252, s75, v252
  s_lshl_b32 s75, s3, 7
  s_lshl_b32 s78, s68, 2
  s_add_u32 s75, s75, s78
  s_add_u32 s75, s75, 16
  s_cmp_eq_u32 s68, 0
  s_cselect_b32 s75, 0x7ff00000, s75
  v_cmp_eq_u32 vcc, 0, v241
  v_mov_b32 v253, s75
  v_mov_b32 v254, 0x7ffffff0
  v_cndmask_b32 v253, v254, v253, vcc
  v_mov_b32 v254, 1
  s_waitcnt vmcnt(0)
  buffer_store_dword v254, v253, s[56:59], 0 offen sc0 sc1
  buffer_load_dword v255, v252, s[56:59], 0 offen sc0 sc1
  s_mov_b32 s89, 0
L_poll_bs:
  s_waitcnt vmcnt(0)
  v_cmp_eq_u32 vcc, 1, v255
  s_add_u32 s89, s89, 1
  s_nop 1
  s_cmp_eq_u64 vcc, -1
  s_cbranch_scc1 L_got_bs
  s_cmp_gt_u32 s89, 200000
  s_cbranch_scc1 L_got_bs
  buffer_load_dword v255, v252, s[56:59], 0 offen sc0 sc1
  s_waitcnt vmcnt(0)
  s_branch L_poll_bs
L_got_bs:
  s_mul_i32 s78, s68, 3072
  s_mul_i32 s75, s70, 49152
  s_add_u32 s84, s75, s78
  s_add_u32 s84, s84, 12288
  buffer_load_dwordx4 a[60:63], v241, s[52:55], s84 offen sc0 sc1
  buffer_load_dwordx4 a[64:67], v241, s[52:55], s84 offen offset:1024 sc0 sc1
  buffer_load_dwordx4 a[68:71], v241, s[52:55], s84 offen offset:2048 sc0 sc1
  s_add_u32 s84, s84, 12288
  buffer_load_dwordx4 a[72:75], v241, s[52:55], s84 offen sc0 sc1
  buffer_load_dwordx4 a[76:79], v241, s[52:55], s84 offen offset:1024 sc0 sc1
  buffer_load_dwordx4 a[80:83], v241, s[52:55], s84 offen offset:2048 sc0 sc1
  s_add_u32 s84, s84, 12288
  buffer_load_dwordx4 a[84:87], v241, s[52:55], s84 offen sc0 sc1
  buffer_load_dwordx4 a[88:91], v241, s[52:55], s84 offen offset:1024 sc0 sc1
  buffer_load_dwordx4 a[92:95], v241, s[52:55], s84 offen offset:2048 sc0 sc1
  s_mul_i32 s75, s69, 196608
  s_lshl_b32 s76, s71, 10
  s_add_u32 s75, s75, s76
  s_lshl_b32 s76, s70, 7
  s_add_u32 s75, s75, s76
  s_waitcnt lgkmcnt(2)
  v_mfma_f32_16x16x32_bf16 v[0:3], v[192:195], a[48:51], v[0:3]
  v_mfma_f32_16x16x32_bf16 v[4:7], v[196:199], a[48:51], v[4:7]
  s_waitcnt lgkmcnt(1)
  v_mfma_f32_16x16x32_bf16 v[8:11], v[192:195], a[52:55], v[8:11]
  v_mfma_f32_16x16x32_bf16 v[12:15], v[196:199], a[52:55], v[12:15]
  s_waitcnt lgkmcnt(0)
  v_mfma_f32_16x16x32_bf16 v[16:19], v[192:195], a[56:59], v[16:19]
  v_mfma_f32_16x16x32_bf16 v[20:23], v[196:199], a[56:59], v[20:23]
  s_waitcnt vmcnt(8)
  v_mfma_f32_16x16x32_bf16 v[0:3], v[192:195], a[60:63], v[0:3]
  v_mfma_f32_16x16x32_bf16 v[4:7], v[196:199], a[60:63], v[4:7]
  s_waitcnt vmcnt(7)
  v_mfma_f32_16x16x32_bf16 v[8:11], v[192:195], a[64:67], v[8:11]
  v_mfma_f32_16x16x32_bf16 v[12:15], v[196:199], a[64:67], v[12:15]
  s_waitcnt vmcnt(6)
  v_mfma_f32_16x16x32_bf16 v[16:19], v[192:195], a[68:71], v[16:19]
  v_mfma_f32_16x16x32_bf16 v[20:23], v[196:199], a[68:71], v[20:23]
  s_waitcnt vmcnt(5)
  v_mfma_f32_16x16x32_bf16 v[0:3], v[192:195], a[72:75], v[0:3]
  v_mfma_f32_16x16x32_bf16 v[4:7], v[196:199], a[72:75], v[4:7]
  s_waitcnt vmcnt(4)
  v_mfma_f32_16x16x32_bf16 v[8:11], v[192:195], a[76:79], v[8:11]
  v_mfma_f32_16x16x32_bf16 v[12:15], v[196:199], a[76:79], v[12:15]
  s_waitcnt vmcnt(3)
  v_mfma_f32_16x16x32_bf16 v[16:19], v[192:195], a[80:83], v[16:19]
  v_mfma_f32_16x16x32_bf16 v[20:23], v[196:199], a[80:83], v[20:23]
  s_waitcnt vmcnt(2)
  v_mfma_f32_16x16x32_bf16 v[0:3], v[192:195], a[84:87], v[0:3]
  v_mfma_f32_16x16x32_bf16 v[4:7], v[196:199], a[84:87], v[4:7]
  s_waitcnt vmcnt(1)
  v_mfma_f32_16x16x32_bf16 v[8:11], v[192:195], a[88:91], v[8:11]
  v_mfma_f32_16x16x32_bf16 v[12:15], v[196:199], a[88:91], v[12:15]
  s_waitcnt vmcnt(0)
  v_mfma_f32_16x16x32_bf16 v[16:19], v[192:195], a[92:95], v[16:19]
  v_mfma_f32_16x16x32_bf16 v[20:23], v[196:199], a[92:95], v[20:23]
  s_mul_i32 s76, s68, 3
  s_add_u32 s76, s76, 0
  s_lshr_b32 s77, s76, 1
  s_lshl_b32 s77, s77, 15
  s_and_b32 s76, s76, 1
  s_lshl_b32 s76, s76, 6
  s_add_u32 s77, s77, s76
  s_add_u32 s77, s77, s75
  v_cvt_pk_bf16_f32 v0, v0, v1
  v_cvt_pk_bf16_f32 v1, v2, v3
  v_cvt_pk_bf16_f32 v2, v4, v5
  v_cvt_pk_bf16_f32 v3, v6, v7
  buffer_store_dwordx4 v[0:3], v206, s[64:67], s77 offen
  s_mul_i32 s76, s68, 3
  s_add_u32 s76, s76, 1
  s_lshr_b32 s77, s76, 1
  s_lshl_b32 s77, s77, 15
  s_and_b32 s76, s76, 1
  s_lshl_b32 s76, s76, 6
  s_add_u32 s77, s77, s76
  s_add_u32 s77, s77, s75
  v_cvt_pk_bf16_f32 v8, v8, v9
  v_cvt_pk_bf16_f32 v9, v10, v11
  v_cvt_pk_bf16_f32 v10, v12, v13
  v_cvt_pk_bf16_f32 v11, v14, v15
  buffer_store_dwordx4 v[8:11], v206, s[64:67], s77 offen
  s_mul_i32 s76, s68, 3
  s_add_u32 s76, s76, 2
  s_lshr_b32 s77, s76, 1
  s_lshl_b32 s77, s77, 15
  s_and_b32 s76, s76, 1
  s_lshl_b32 s76, s76, 6
  s_add_u32 s77, s77, s76
  s_add_u32 s77, s77, s75
  v_cvt_pk_bf16_f32 v16, v16, v17
  v_cvt_pk_bf16_f32 v17, v18, v19
  v_cvt_pk_bf16_f32 v18, v20, v21
  v_cvt_pk_bf16_f32 v19, v22, v23
  buffer_store_dwordx4 v[16:19], v206, s[64:67], s77 offen
L_done:
  s_endpgm
.section .rodata,"a"
.p2align 6
.amdhsa_kernel concat_heads__mha_block_cached__mha_block_cached__near_ridge_kernel
  .amdhsa_next_free_vgpr 512
  .amdhsa_next_free_sgpr 102
  .amdhsa_accum_offset 256
  .amdhsa_group_segment_fixed_size 0
  .amdhsa_kernarg_size 104
  .amdhsa_user_sgpr_count 2
  .amdhsa_user_sgpr_kernarg_segment_ptr 1
  .amdhsa_system_sgpr_workgroup_id_x 1
  .amdhsa_float_denorm_mode_32 3
.end_amdhsa_kernel
```
